```python
import torch

def _softmax(x, axis=-1):
    return torch.softmax(x, dim=axis)

def _gelu(x):
    return torch.nn.functional.gelu(x, approximate='tanh')

def _silu(x):
    return torch.nn.functional.silu(x)

def _sigmoid(x):
    return torch.sigmoid(x)

def _layernorm(x, axis=-1, eps=1e-05):
    m = x.mean(dim=axis, keepdim=True)
    v = x.var(dim=axis, keepdim=True, unbiased=False)
    return (x - m) / torch.sqrt(v + eps)

def _scatter_add(tgt, idx, src, axis=0):
    return tgt.clone().index_add_(axis, idx, src)

def _segment_sum(src, seg, n):
    out = torch.zeros((n,) + src.shape[1:], dtype=src.dtype)
    return out.index_add_(0, seg, src)

def _pad(x, pw):
    flat = tuple((v for pair in reversed(pw) for v in pair))
    return torch.nn.functional.pad(x, flat)
kernel_name = 'gated_mix__memory_aug_recurrent_mem_tr__moe_arch_mod__prompt'

def setup_inputs():

    _w = lambda a: (lambda t: t.to(torch.bfloat16) if t.is_floating_point() else t)(torch.as_tensor(a))

    def _A_setup():
        B, S, Dm = (1, 2048, 512)
        H, Dh = (32, 128)
        M, seg = (8, 32)
        seg = min(seg, S)
        S = S // seg * seg
        return {'x': _w((lambda *s: torch.randn(*s, dtype=torch.bfloat16) * 0.05)(B, S, Dm)), 'mem0': _w((lambda *s: torch.randn(*s, dtype=torch.bfloat16) * 0.8)(B, M, Dm)), 'Wq': _w((lambda *s: torch.randn(*s, dtype=torch.bfloat16) * 3.2)(Dm, H, Dh) * Dm ** (-0.5)), 'Wk': _w((lambda *s: torch.randn(*s, dtype=torch.bfloat16) * 3.2)(Dm, H, Dh) * Dm ** (-0.5)), 'Wv': _w((lambda *s: torch.randn(*s, dtype=torch.bfloat16) * 0.8)(Dm, H, Dh) * Dm ** (-0.5)), 'Wo': _w((lambda *s: torch.randn(*s, dtype=torch.bfloat16) * 0.8)(H, Dh, Dm) * (H * Dh) ** (-0.5)), 'seg_len': seg}
    _A_in = _A_setup()

    def _B_setup():
        B, S, D, F, C = (1, 2048, 512, 1792, 8)
        return {'x': _w((lambda *s: torch.randn(*s, dtype=torch.bfloat16) * 0.05)(B, S, D)), 'w_r': _w((lambda *s: torch.randn(*s, dtype=torch.bfloat16) * 1.6)(D)), 'w_gate': _w((lambda *s: torch.randn(*s, dtype=torch.bfloat16) * 0.2)(D, F)), 'w_up': _w((lambda *s: torch.randn(*s, dtype=torch.bfloat16) * 0.2)(D, F)), 'w_down': _w((lambda *s: torch.randn(*s, dtype=torch.bfloat16) * 0.2)(F, D))}
    _B_in = _B_setup()
    return {'A_x': _A_in['x'], 'A_mem0': _A_in['mem0'], 'A_Wq': _A_in['Wq'], 'A_Wk': _A_in['Wk'], 'A_Wv': _A_in['Wv'], 'A_Wo': _A_in['Wo'], 'A_seg_len': _A_in['seg_len'], 'B_x': _B_in['x'], 'B_w_r': _B_in['w_r'], 'B_w_gate': _B_in['w_gate'], 'B_w_up': _B_in['w_up'], 'B_w_down': _B_in['w_down'], 'gate_w': _w((lambda *s: torch.randn(*s, dtype=torch.bfloat16) * 0.05)(512) * 16.0)}

def reference(A_x, A_mem0, A_Wq, A_Wk, A_Wv, A_Wo, A_seg_len, B_x, B_w_r, B_w_gate, B_w_up, B_w_down, gate_w):

    def _A_ref(x, mem0, Wq, Wk, Wv, Wo, seg_len):
        B, S, Dm = x.shape
        H, Dh = (Wq.shape[1], Wq.shape[2])
        M = mem0.shape[1]
        scale = Dh ** (-0.5)
        n_seg = S // seg_len
        L = M + seg_len
        idx = torch.arange(L)
        mask = (idx[:, None] < M) | (idx[:, None] >= idx[None, :])
        mem = mem0
        outs = []
        for s in range(n_seg):
            xs = x[:, s * seg_len:(s + 1) * seg_len, :].clone()
            h = torch.concatenate([mem, xs], axis=1)
            q = torch.einsum('btd,dhe->bhte', h, Wq)
            k = torch.einsum('btd,dhe->bhte', h, Wk)
            v = torch.einsum('btd,dhe->bhte', h, Wv)
            scores = torch.einsum('bhqe,bhke->bhqk', q, k) * scale
            scores = torch.where(mask[None, None], scores, -1000000000.0)
            p = _softmax(scores, axis=-1)
            o = torch.einsum('bhqk,bhke->bhqe', p, v)
            o = torch.einsum('bhte,hed->btd', o, Wo)
            mem = o[:, :M, :].clone()
            outs.append(o[:, M:, :])
        return torch.concatenate(outs, axis=1)

    def _B_ref(x, w_r, w_gate, w_up, w_down):
        B, S, D = x.shape
        C = 8
        r = x @ w_r
        idx = torch.argsort(-r, axis=-1)[:, :C]
        idx_e = (lambda x, n, axis: torch.repeat_interleave(x, n, dim=axis))(idx.reshape(B, C, 1), D, axis=2)
        x_sel = (lambda x, i, axis: torch.take_along_dim(x, i, dim=axis))(x, idx_e, axis=1)
        g = _silu(x_sel @ w_gate)
        u = x_sel @ w_up
        y = g * u @ w_down
        r_sel = _sigmoid((lambda x, i, axis: torch.take_along_dim(x, i, dim=axis))(r, idx, axis=1))
        y = y * r_sel.reshape(B, C, 1)
        b_off = (torch.arange(B) * S).reshape(B, 1)
        flat_idx = (idx + b_off).reshape(B * C)
        zero = (x * 0.0).reshape(B * S, D)
        upd = _scatter_add(zero, flat_idx, y.reshape(B * C, D), axis=0)
        return x + upd.reshape(B, S, D)
    x = A_x
    g = _sigmoid((x * gate_w).sum(-1, keepdims=True))
    a = _A_ref(x, A_mem0, A_Wq, A_Wk, A_Wv, A_Wo, A_seg_len)
    b = _B_ref(x, B_w_r, B_w_gate, B_w_up, B_w_down)
    return g * a + (1 - g) * b
```

```asm
; @launch grid=(256,1,1) block=(256,1,1) lds=163840
.amdgcn_target "amdgcn-amd-amdhsa--gfx950"
.text
.globl gated_mix__memory_aug_recurrent_mem_tr__moe_arch_mod__prompt_kernel
.p2align 8
.type gated_mix__memory_aug_recurrent_mem_tr__moe_arch_mod__prompt_kernel,@function
gated_mix__memory_aug_recurrent_mem_tr__moe_arch_mod__prompt_kernel:
    s_load_dwordx4 s[4:7], s[0:1], 0
    s_load_dwordx4 s[56:59], s[0:1], 16
    s_load_dwordx4 s[60:63], s[0:1], 32
    s_load_dwordx2 s[68:69], s[0:1], 104
    s_load_dwordx4 s[72:75], s[0:1], 112
    s_getreg_b32 s3, hwreg(HW_REG_XCC_ID, 0, 4)
    v_lshrrev_b32 v1, 6, v0
    s_nop 0
    v_readfirstlane_b32 s25, v1
    s_waitcnt lgkmcnt(0)
    s_mov_b32 s8, s74
    s_and_b32 s9, s75, 0xffff
    s_mov_b32 s10, 0x10000000
    s_mov_b32 s11, 0x20000
    s_mov_b32 s12, s72
    s_and_b32 s13, s73, 0xffff
    s_mov_b32 s14, 0x100
    s_mov_b32 s15, 0x20000
    s_mov_b32 s16, s56
    s_and_b32 s17, s57, 0xffff
    s_mov_b32 s18, 0x400000
    s_mov_b32 s19, 0x20000
    s_mov_b32 s20, s6
    s_and_b32 s21, s7, 0xffff
    s_mov_b32 s22, 0x2000
    s_mov_b32 s23, 0x20000
    s_mov_b32 s72, s68
    s_and_b32 s73, s69, 0xffff
    s_mov_b32 s74, 0x200000
    s_mov_b32 s75, 0x20000
    s_cmp_lg_u32 s3, 0
    s_cbranch_scc1 L_bulk
    v_cmp_eq_u32 vcc, 0, v0
    s_nop 0
    s_and_saveexec_b64 s[46:47], vcc
    s_cbranch_execz L_nt_rec
    v_mov_b32 v1, 1
    v_mov_b32 v2, 0
    buffer_atomic_add v1, v2, s[12:15], 0 offen sc0
    s_waitcnt vmcnt(0)
    v_mov_b32 v2, 14336
    ds_write_b32 v2, v1
    s_waitcnt lgkmcnt(0)
L_nt_rec:
    s_mov_b64 exec, -1
    s_barrier
    v_mov_b32 v2, 14336
    ds_read_b32 v1, v2
    s_waitcnt lgkmcnt(0)
    v_readfirstlane_b32 s24, v1
    s_nop 3
    s_barrier
    s_cmp_ge_u32 s24, 32
    s_cbranch_scc1 L_bulk
    v_and_b32 v16, 63, v0
    v_and_b32 v17, 15, v0
    v_bfe_u32 v18, v0, 4, 2
    v_lshlrev_b32 v1, 4, v16
    s_lshl_b32 s31, s25, 11
    v_add_u32 v2, s31, v1
    v_lshrrev_b32 v19, 2, v17
    v_xor_b32 v19, v19, v18
    v_lshlrev_b32 v19, 3, v19
    v_lshl_add_u32 v19, v17, 5, v19
    s_lshl_b32 s31, s25, 10
    s_add_u32 s31, s31, 8192
    v_add_u32 v3, s31, v19
    v_lshrrev_b32 v19, 2, v17
    v_lshl_add_u32 v19, v18, 2, v19
    v_lshlrev_b32 v19, 5, v19
    v_and_b32 v20, 3, v17
    v_xor_b32 v20, v20, v18
    v_lshl_add_u32 v19, v20, 3, v19
    v_add_u32 v4, 8192, v19
    v_add_u32 v5, 16384, v1
    v_and_b32 v19, 13, v17
    v_lshl_add_u32 v19, v18, 4, v19
    v_lshlrev_b32 v19, 4, v19
    s_lshr_b32 s31, s25, 1
    s_lshl_b32 s31, s31, 10
    s_and_b32 s45, s25, 1
    s_lshl_b32 s45, s45, 5
    s_add_u32 s31, s31, s45
    s_add_u32 s31, s31, 12288
    v_add_u32 v6, s31, v19
    s_lshl_b32 s31, s25, 14
    s_add_u32 s31, s31, 32768
    v_add_u32 v7, s31, v1
    v_add_u32 v8, 0x10000, v7
    v_lshrrev_b32 v19, 2, v17
    v_lshlrev_b32 v19, 13, v19
    v_lshl_add_u32 v19, v18, 6, v19
    v_and_b32 v20, 3, v17
    v_lshl_add_u32 v19, v20, 4, v19
    s_lshl_b32 s31, s25, 15
    s_lshl_b32 s45, s24, 8
    s_add_u32 s31, s31, s45
    v_add_u32 v9, s31, v19
    v_lshrrev_b32 v19, 3, v16
    v_lshlrev_b32 v19, 8, v19
    v_and_b32 v20, 7, v16
    v_lshl_add_u32 v19, v20, 4, v19
    s_and_b32 s31, s25, 1
    s_lshl_b32 s31, s31, 7
    v_add_u32 v10, s31, v19
    v_and_b32 v19, 3, v16
    v_lshlrev_b32 v19, 2, v19
    v_lshl_add_u32 v19, v18, 5, v19
    v_bfe_u32 v20, v16, 2, 1
    v_lshl_add_u32 v19, v20, 6, v19
    v_bfe_u32 v20, v16, 3, 1
    v_lshl_add_u32 v19, v20, 4, v19
    s_lshl_b32 s31, s24, 8
    s_and_b32 s45, s25, 1
    s_lshl_b32 s45, s45, 7
    s_add_u32 s31, s31, s45
    v_add_u32 v11, s31, v19
    s_mov_b32 s6, 0xff00ff00
    s_mov_b32 s7, 0xff00ff00
    v_and_b32 v19, 2, v17
    v_cmp_eq_u32 vcc, 0, v19
    v_mov_b32 v19, 0xeeeeeeee
    v_mov_b32 v20, 0x44444444
    v_cndmask_b32 v13, v19, v20, vcc
    v_mov_b32 v15, 0
    s_mov_b32 s48, 0x3e0293ee
    s_mov_b32 s49, 0x3e0293ee
    s_mov_b32 s50, 0xbe0293ee
    s_mov_b32 s52, 0xcccccccc
    s_mov_b32 s53, 0xcccccccc
    s_cmp_eq_u32 s25, 2
    s_cselect_b64 s[4:5], 1, 0
    s_cmp_lt_u32 s25, 2
    s_cselect_b32 s54, -1, 0
    s_mov_b32 s55, 0
    s_mov_b32 s32, 0x3c00000
    s_mov_b32 s33, 0x3c20000
    s_lshl_b32 s31, s24, 13
    s_add_u32 s34, s31, 0x3c00000
    s_add_u32 s35, s31, 0x3c01000
    s_mov_b32 s28, 0x3d00000
    s_mov_b32 s29, 0x3d02000
    s_mov_b32 s30, 0x3d04000
    s_lshl_b32 s31, s24, 13
    s_add_u32 s40, s31, 0x1000000
    s_add_u32 s41, s31, 0x2000000
    s_lshl_b32 s31, s24, 12
    s_lshl_b32 s45, s25, 10
    s_add_u32 s31, s31, s45
    s_add_u32 s42, s31, 0x3000000
    s_lshl_b32 s31, s25, 11
    s_add_u32 s44, s31, 16384
    s_lshl_b32 s31, s24, 8
    s_add_u32 s64, s31, 0x5200000
    s_lshl_b32 s31, s24, 7
    s_add_u32 s66, s31, 0x5202000
    s_mov_b32 s26, 0
    s_mov_b32 s27, 1
    s_mov_b32 s65, 400000
    v_and_b32 v19, 1, v17
    v_cmp_eq_u32 vcc, 0, v19
    v_mov_b32 v19, 0x3f800000
    v_mov_b32 v20, 0x3f80
    v_cndmask_b32 v19, v19, v20, vcc
    v_lshrrev_b32 v20, 1, v17
    v_cmp_eq_u32 vcc, 0, v20
    s_nop 1
    v_cndmask_b32 v24, v15, v19, vcc
    v_cmp_eq_u32 vcc, 1, v20
    s_nop 1
    v_cndmask_b32 v25, v15, v19, vcc
    v_cmp_eq_u32 vcc, 2, v20
    s_nop 1
    v_cndmask_b32 v26, v15, v19, vcc
    v_cmp_eq_u32 vcc, 3, v20
    s_nop 1
    v_cndmask_b32 v27, v15, v19, vcc
    ds_write_b128 v1, v[24:27] offset:15360
    s_waitcnt lgkmcnt(0)
    v_mov_b32 v24, 0
    v_mov_b32 v25, 0
    v_mov_b32 v26, 0
    v_mov_b32 v27, 0
    v_mov_b32 v28, -1
    s_lshl_b32 s31, s25, 11
    s_add_u32 s31, s31, s34
    buffer_store_dwordx4 v[24:27], v1, s[8:11], s31 offen offset:0
    buffer_store_dwordx4 v[24:27], v1, s[8:11], s31 offen offset:1024
    s_mov_b64 exec, s[54:55]
    buffer_store_dword v28, v11, s[8:11], s28 offen
    buffer_store_dword v28, v11, s[8:11], s29 offen
    buffer_store_dword v28, v11, s[8:11], s30 offen
    s_mov_b64 exec, -1
    s_waitcnt vmcnt(0)
    s_barrier
    v_cmp_eq_u32 vcc, 0, v0
    s_nop 0
    s_and_saveexec_b64 s[46:47], vcc
    v_mov_b32 v24, 1
    v_mov_b32 v25, 32
    buffer_atomic_add v24, v25, s[12:15], 0 offen
    s_mov_b64 exec, -1
    v_lshrrev_b32 v19, 1, v18
    v_lshlrev_b32 v19, 1, v19
    v_xor_b32 v19, v19, v17
    v_lshlrev_b32 v19, 4, v19
    v_lshl_add_u32 v19, v18, 13, v19
    s_lshl_b32 s31, s24, 8
    v_add_u32 v28, s31, v19
    v_xor_b32 v29, 64, v28
    v_xor_b32 v30, 128, v28
    v_xor_b32 v31, 192, v28
    v_lshrrev_b32 v32, 2, v17
    v_and_b32 v33, 3, v17
    v_lshrrev_b32 v19, 1, v18
    v_lshlrev_b32 v34, 4, v19
    v_and_b32 v19, 1, v18
    v_lshl_add_u32 v34, v19, 1, v34
    v_lshl_or_b32 v35, v32, 1, v19
    v_lshl_add_u32 v34, v32, 2, v34
    v_lshrrev_b32 v19, 1, v33
    s_lshl_b32 s31, s25, 2
    v_add_u32 v19, s31, v19
    v_lshlrev_b32 v20, 1, v35
    v_xor_b32 v19, v19, v20
    v_lshlrev_b32 v19, 4, v19
    v_lshl_add_u32 v19, v34, 8, v19
    v_and_b32 v20, 1, v33
    v_lshl_add_u32 v19, v20, 3, v19
    v_add_u32 v36, 32768, v19
    v_xor_b32 v37, 32, v36
    v_add_u32 v38, 0x10000, v36
    v_add_u32 v39, 0x10000, v37
    v_and_b32 v19, 1, v18
    v_lshlrev_b32 v34, 4, v19
    v_lshlrev_b32 v35, 3, v19
    v_lshrrev_b32 v19, 1, v18
    v_lshl_add_u32 v34, v19, 2, v34
    v_and_b32 v19, 1, v32
    v_add_u32 v34, v34, v19
    v_or_b32 v35, v35, v19
    v_lshrrev_b32 v19, 1, v32
    v_lshl_add_u32 v34, v19, 5, v34
    v_lshlrev_b32 v19, 1, v33
    s_lshl_b32 s31, s25, 3
    v_add_u32 v19, s31, v19
    v_xor_b32 v19, v19, v35
    v_lshlrev_b32 v19, 4, v19
    v_lshl_add_u32 v19, v34, 10, v19
    v_add_u32 v40, 32768, v19
    v_xor_b32 v41, 16, v40
    v_add_u32 v42, 0x10000, v40
    v_add_u32 v43, 0x10000, v41
    s_mov_b32 s16, s56
    s_and_b32 s17, s57, 0xffff
    s_mov_b32 s18, 0x400000
    s_mov_b32 s19, 0x20000
    s_lshl_b32 s31, s25, 19
    s_add_u32 s31, s31, 0x0
    s_lshl_b32 s45, s25, 14
    s_add_u32 s45, s45, 0x8000
    s_mov_b32 m0, s45
    s_nop 0
    buffer_load_dwordx4 v28, s[16:19], s31 offen lds
    s_add_u32 s31, s31, 0x8000
    s_add_u32 s45, s45, 0x400
    s_mov_b32 m0, s45
    s_nop 0
    buffer_load_dwordx4 v29, s[16:19], s31 offen lds
    s_add_u32 s31, s31, 0x8000
    s_add_u32 s45, s45, 0x400
    s_mov_b32 m0, s45
    s_nop 0
    buffer_load_dwordx4 v30, s[16:19], s31 offen lds
    s_add_u32 s31, s31, 0x8000
    s_add_u32 s45, s45, 0x400
    s_mov_b32 m0, s45
    s_nop 0
    buffer_load_dwordx4 v31, s[16:19], s31 offen lds
    s_add_u32 s31, s31, 0x8000
    s_add_u32 s45, s45, 0x400
    s_mov_b32 m0, s45
    s_nop 0
    buffer_load_dwordx4 v28, s[16:19], s31 offen lds
    s_add_u32 s31, s31, 0x8000
    s_add_u32 s45, s45, 0x400
    s_mov_b32 m0, s45
    s_nop 0
    buffer_load_dwordx4 v29, s[16:19], s31 offen lds
    s_add_u32 s31, s31, 0x8000
    s_add_u32 s45, s45, 0x400
    s_mov_b32 m0, s45
    s_nop 0
    buffer_load_dwordx4 v30, s[16:19], s31 offen lds
    s_add_u32 s31, s31, 0x8000
    s_add_u32 s45, s45, 0x400
    s_mov_b32 m0, s45
    s_nop 0
    buffer_load_dwordx4 v31, s[16:19], s31 offen lds
    s_add_u32 s31, s31, 0x8000
    s_add_u32 s45, s45, 0x400
    s_mov_b32 m0, s45
    s_nop 0
    buffer_load_dwordx4 v28, s[16:19], s31 offen lds
    s_add_u32 s31, s31, 0x8000
    s_add_u32 s45, s45, 0x400
    s_mov_b32 m0, s45
    s_nop 0
    buffer_load_dwordx4 v29, s[16:19], s31 offen lds
    s_add_u32 s31, s31, 0x8000
    s_add_u32 s45, s45, 0x400
    s_mov_b32 m0, s45
    s_nop 0
    buffer_load_dwordx4 v30, s[16:19], s31 offen lds
    s_add_u32 s31, s31, 0x8000
    s_add_u32 s45, s45, 0x400
    s_mov_b32 m0, s45
    s_nop 0
    buffer_load_dwordx4 v31, s[16:19], s31 offen lds
    s_add_u32 s31, s31, 0x8000
    s_add_u32 s45, s45, 0x400
    s_mov_b32 m0, s45
    s_nop 0
    buffer_load_dwordx4 v28, s[16:19], s31 offen lds
    s_add_u32 s31, s31, 0x8000
    s_add_u32 s45, s45, 0x400
    s_mov_b32 m0, s45
    s_nop 0
    buffer_load_dwordx4 v29, s[16:19], s31 offen lds
    s_add_u32 s31, s31, 0x8000
    s_add_u32 s45, s45, 0x400
    s_mov_b32 m0, s45
    s_nop 0
    buffer_load_dwordx4 v30, s[16:19], s31 offen lds
    s_add_u32 s31, s31, 0x8000
    s_add_u32 s45, s45, 0x400
    s_mov_b32 m0, s45
    s_nop 0
    buffer_load_dwordx4 v31, s[16:19], s31 offen lds
    s_add_u32 s31, s31, 0x8000
    s_add_u32 s45, s45, 0x400
    s_mov_b32 s16, s56
    s_and_b32 s17, s57, 0xffff
    s_mov_b32 s18, 0x400000
    s_mov_b32 s19, 0x20000
    s_lshl_b32 s31, s25, 19
    s_add_u32 s31, s31, 0x200000
    s_lshl_b32 s45, s25, 14
    s_add_u32 s45, s45, 0x18000
    s_mov_b32 m0, s45
    s_nop 0
    buffer_load_dwordx4 v28, s[16:19], s31 offen lds
    s_add_u32 s31, s31, 0x8000
    s_add_u32 s45, s45, 0x400
    s_mov_b32 m0, s45
    s_nop 0
    buffer_load_dwordx4 v29, s[16:19], s31 offen lds
    s_add_u32 s31, s31, 0x8000
    s_add_u32 s45, s45, 0x400
    s_mov_b32 m0, s45
    s_nop 0
    buffer_load_dwordx4 v30, s[16:19], s31 offen lds
    s_add_u32 s31, s31, 0x8000
    s_add_u32 s45, s45, 0x400
    s_mov_b32 m0, s45
    s_nop 0
    buffer_load_dwordx4 v31, s[16:19], s31 offen lds
    s_add_u32 s31, s31, 0x8000
    s_add_u32 s45, s45, 0x400
    s_mov_b32 m0, s45
    s_nop 0
    buffer_load_dwordx4 v28, s[16:19], s31 offen lds
    s_add_u32 s31, s31, 0x8000
    s_add_u32 s45, s45, 0x400
    s_mov_b32 m0, s45
    s_nop 0
    buffer_load_dwordx4 v29, s[16:19], s31 offen lds
    s_add_u32 s31, s31, 0x8000
    s_add_u32 s45, s45, 0x400
    s_mov_b32 m0, s45
    s_nop 0
    buffer_load_dwordx4 v30, s[16:19], s31 offen lds
    s_add_u32 s31, s31, 0x8000
    s_add_u32 s45, s45, 0x400
    s_mov_b32 m0, s45
    s_nop 0
    buffer_load_dwordx4 v31, s[16:19], s31 offen lds
    s_add_u32 s31, s31, 0x8000
    s_add_u32 s45, s45, 0x400
    s_mov_b32 m0, s45
    s_nop 0
    buffer_load_dwordx4 v28, s[16:19], s31 offen lds
    s_add_u32 s31, s31, 0x8000
    s_add_u32 s45, s45, 0x400
    s_mov_b32 m0, s45
    s_nop 0
    buffer_load_dwordx4 v29, s[16:19], s31 offen lds
    s_add_u32 s31, s31, 0x8000
    s_add_u32 s45, s45, 0x400
    s_mov_b32 m0, s45
    s_nop 0
    buffer_load_dwordx4 v30, s[16:19], s31 offen lds
    s_add_u32 s31, s31, 0x8000
    s_add_u32 s45, s45, 0x400
    s_mov_b32 m0, s45
    s_nop 0
    buffer_load_dwordx4 v31, s[16:19], s31 offen lds
    s_add_u32 s31, s31, 0x8000
    s_add_u32 s45, s45, 0x400
    s_mov_b32 m0, s45
    s_nop 0
    buffer_load_dwordx4 v28, s[16:19], s31 offen lds
    s_add_u32 s31, s31, 0x8000
    s_add_u32 s45, s45, 0x400
    s_mov_b32 m0, s45
    s_nop 0
    buffer_load_dwordx4 v29, s[16:19], s31 offen lds
    s_add_u32 s31, s31, 0x8000
    s_add_u32 s45, s45, 0x400
    s_mov_b32 m0, s45
    s_nop 0
    buffer_load_dwordx4 v30, s[16:19], s31 offen lds
    s_add_u32 s31, s31, 0x8000
    s_add_u32 s45, s45, 0x400
    s_mov_b32 m0, s45
    s_nop 0
    buffer_load_dwordx4 v31, s[16:19], s31 offen lds
    s_add_u32 s31, s31, 0x8000
    s_add_u32 s45, s45, 0x400
    s_waitcnt vmcnt(16)
    s_barrier
    ds_read_b64_tr_b16 a[0:1], v36 offset:0
    ds_read_b64_tr_b16 a[2:3], v36 offset:256
    ds_read_b64_tr_b16 a[4:5], v36 offset:8192
    ds_read_b64_tr_b16 a[6:7], v36 offset:8448
    ds_read_b64_tr_b16 a[8:9], v36 offset:16384
    ds_read_b64_tr_b16 a[10:11], v36 offset:16640
    ds_read_b64_tr_b16 a[12:13], v36 offset:24576
    ds_read_b64_tr_b16 a[14:15], v36 offset:24832
    ds_read_b64_tr_b16 a[16:17], v36 offset:32768
    ds_read_b64_tr_b16 a[18:19], v36 offset:33024
    ds_read_b64_tr_b16 a[20:21], v36 offset:40960
    ds_read_b64_tr_b16 a[22:23], v36 offset:41216
    s_waitcnt lgkmcnt(4)
    ds_read_b64_tr_b16 a[24:25], v36 offset:49152
    ds_read_b64_tr_b16 a[26:27], v36 offset:49408
    ds_read_b64_tr_b16 a[28:29], v36 offset:57344
    ds_read_b64_tr_b16 a[30:31], v36 offset:57600
    ds_read_b64_tr_b16 a[64:65], v37 offset:0
    ds_read_b64_tr_b16 a[66:67], v37 offset:256
    ds_read_b64_tr_b16 a[68:69], v37 offset:8192
    ds_read_b64_tr_b16 a[70:71], v37 offset:8448
    ds_read_b64_tr_b16 a[72:73], v37 offset:16384
    ds_read_b64_tr_b16 a[74:75], v37 offset:16640
    ds_read_b64_tr_b16 a[76:77], v37 offset:24576
    ds_read_b64_tr_b16 a[78:79], v37 offset:24832
    s_waitcnt lgkmcnt(4)
    ds_read_b64_tr_b16 a[80:81], v37 offset:32768
    ds_read_b64_tr_b16 a[82:83], v37 offset:33024
    ds_read_b64_tr_b16 a[84:85], v37 offset:40960
    ds_read_b64_tr_b16 a[86:87], v37 offset:41216
    ds_read_b64_tr_b16 a[88:89], v37 offset:49152
    ds_read_b64_tr_b16 a[90:91], v37 offset:49408
    ds_read_b64_tr_b16 a[92:93], v37 offset:57344
    ds_read_b64_tr_b16 a[94:95], v37 offset:57600
    s_waitcnt lgkmcnt(0)
    s_barrier
    s_mov_b32 s16, s58
    s_and_b32 s17, s59, 0xffff
    s_mov_b32 s18, 0x400000
    s_mov_b32 s19, 0x20000
    s_lshl_b32 s31, s25, 19
    s_add_u32 s31, s31, 0x0
    s_lshl_b32 s45, s25, 14
    s_add_u32 s45, s45, 0x8000
    s_mov_b32 m0, s45
    s_nop 0
    buffer_load_dwordx4 v28, s[16:19], s31 offen lds
    s_add_u32 s31, s31, 0x8000
    s_add_u32 s45, s45, 0x400
    s_mov_b32 m0, s45
    s_nop 0
    buffer_load_dwordx4 v29, s[16:19], s31 offen lds
    s_add_u32 s31, s31, 0x8000
    s_add_u32 s45, s45, 0x400
    s_mov_b32 m0, s45
    s_nop 0
    buffer_load_dwordx4 v30, s[16:19], s31 offen lds
    s_add_u32 s31, s31, 0x8000
    s_add_u32 s45, s45, 0x400
    s_mov_b32 m0, s45
    s_nop 0
    buffer_load_dwordx4 v31, s[16:19], s31 offen lds
    s_add_u32 s31, s31, 0x8000
    s_add_u32 s45, s45, 0x400
    s_mov_b32 m0, s45
    s_nop 0
    buffer_load_dwordx4 v28, s[16:19], s31 offen lds
    s_add_u32 s31, s31, 0x8000
    s_add_u32 s45, s45, 0x400
    s_mov_b32 m0, s45
    s_nop 0
    buffer_load_dwordx4 v29, s[16:19], s31 offen lds
    s_add_u32 s31, s31, 0x8000
    s_add_u32 s45, s45, 0x400
    s_mov_b32 m0, s45
    s_nop 0
    buffer_load_dwordx4 v30, s[16:19], s31 offen lds
    s_add_u32 s31, s31, 0x8000
    s_add_u32 s45, s45, 0x400
    s_mov_b32 m0, s45
    s_nop 0
    buffer_load_dwordx4 v31, s[16:19], s31 offen lds
    s_add_u32 s31, s31, 0x8000
    s_add_u32 s45, s45, 0x400
    s_mov_b32 m0, s45
    s_nop 0
    buffer_load_dwordx4 v28, s[16:19], s31 offen lds
    s_add_u32 s31, s31, 0x8000
    s_add_u32 s45, s45, 0x400
    s_mov_b32 m0, s45
    s_nop 0
    buffer_load_dwordx4 v29, s[16:19], s31 offen lds
    s_add_u32 s31, s31, 0x8000
    s_add_u32 s45, s45, 0x400
    s_mov_b32 m0, s45
    s_nop 0
    buffer_load_dwordx4 v30, s[16:19], s31 offen lds
    s_add_u32 s31, s31, 0x8000
    s_add_u32 s45, s45, 0x400
    s_mov_b32 m0, s45
    s_nop 0
    buffer_load_dwordx4 v31, s[16:19], s31 offen lds
    s_add_u32 s31, s31, 0x8000
    s_add_u32 s45, s45, 0x400
    s_mov_b32 m0, s45
    s_nop 0
    buffer_load_dwordx4 v28, s[16:19], s31 offen lds
    s_add_u32 s31, s31, 0x8000
    s_add_u32 s45, s45, 0x400
    s_mov_b32 m0, s45
    s_nop 0
    buffer_load_dwordx4 v29, s[16:19], s31 offen lds
    s_add_u32 s31, s31, 0x8000
    s_add_u32 s45, s45, 0x400
    s_mov_b32 m0, s45
    s_nop 0
    buffer_load_dwordx4 v30, s[16:19], s31 offen lds
    s_add_u32 s31, s31, 0x8000
    s_add_u32 s45, s45, 0x400
    s_mov_b32 m0, s45
    s_nop 0
    buffer_load_dwordx4 v31, s[16:19], s31 offen lds
    s_add_u32 s31, s31, 0x8000
    s_add_u32 s45, s45, 0x400
    s_waitcnt vmcnt(16)
    s_barrier
    ds_read_b64_tr_b16 a[32:33], v38 offset:0
    ds_read_b64_tr_b16 a[34:35], v38 offset:256
    ds_read_b64_tr_b16 a[36:37], v38 offset:8192
    ds_read_b64_tr_b16 a[38:39], v38 offset:8448
    ds_read_b64_tr_b16 a[40:41], v38 offset:16384
    ds_read_b64_tr_b16 a[42:43], v38 offset:16640
    ds_read_b64_tr_b16 a[44:45], v38 offset:24576
    ds_read_b64_tr_b16 a[46:47], v38 offset:24832
    ds_read_b64_tr_b16 a[48:49], v38 offset:32768
    ds_read_b64_tr_b16 a[50:51], v38 offset:33024
    ds_read_b64_tr_b16 a[52:53], v38 offset:40960
    ds_read_b64_tr_b16 a[54:55], v38 offset:41216
    s_waitcnt lgkmcnt(4)
    ds_read_b64_tr_b16 a[56:57], v38 offset:49152
    ds_read_b64_tr_b16 a[58:59], v38 offset:49408
    ds_read_b64_tr_b16 a[60:61], v38 offset:57344
    ds_read_b64_tr_b16 a[62:63], v38 offset:57600
    ds_read_b64_tr_b16 a[96:97], v39 offset:0
    ds_read_b64_tr_b16 a[98:99], v39 offset:256
    ds_read_b64_tr_b16 a[100:101], v39 offset:8192
    ds_read_b64_tr_b16 a[102:103], v39 offset:8448
    ds_read_b64_tr_b16 a[104:105], v39 offset:16384
    ds_read_b64_tr_b16 a[106:107], v39 offset:16640
    ds_read_b64_tr_b16 a[108:109], v39 offset:24576
    ds_read_b64_tr_b16 a[110:111], v39 offset:24832
    s_waitcnt lgkmcnt(4)
    ds_read_b64_tr_b16 a[112:113], v39 offset:32768
    ds_read_b64_tr_b16 a[114:115], v39 offset:33024
    ds_read_b64_tr_b16 a[116:117], v39 offset:40960
    ds_read_b64_tr_b16 a[118:119], v39 offset:41216
    ds_read_b64_tr_b16 a[120:121], v39 offset:49152
    ds_read_b64_tr_b16 a[122:123], v39 offset:49408
    ds_read_b64_tr_b16 a[124:125], v39 offset:57344
    ds_read_b64_tr_b16 a[126:127], v39 offset:57600
    s_waitcnt lgkmcnt(0)
    s_barrier
    s_mov_b32 s16, s58
    s_and_b32 s17, s59, 0xffff
    s_mov_b32 s18, 0x400000
    s_mov_b32 s19, 0x20000
    s_lshl_b32 s31, s25, 19
    s_add_u32 s31, s31, 0x200000
    s_lshl_b32 s45, s25, 14
    s_add_u32 s45, s45, 0x18000
    s_mov_b32 m0, s45
    s_nop 0
    buffer_load_dwordx4 v28, s[16:19], s31 offen lds
    s_add_u32 s31, s31, 0x8000
    s_add_u32 s45, s45, 0x400
    s_mov_b32 m0, s45
    s_nop 0
    buffer_load_dwordx4 v29, s[16:19], s31 offen lds
    s_add_u32 s31, s31, 0x8000
    s_add_u32 s45, s45, 0x400
    s_mov_b32 m0, s45
    s_nop 0
    buffer_load_dwordx4 v30, s[16:19], s31 offen lds
    s_add_u32 s31, s31, 0x8000
    s_add_u32 s45, s45, 0x400
    s_mov_b32 m0, s45
    s_nop 0
    buffer_load_dwordx4 v31, s[16:19], s31 offen lds
    s_add_u32 s31, s31, 0x8000
    s_add_u32 s45, s45, 0x400
    s_mov_b32 m0, s45
    s_nop 0
    buffer_load_dwordx4 v28, s[16:19], s31 offen lds
    s_add_u32 s31, s31, 0x8000
    s_add_u32 s45, s45, 0x400
    s_mov_b32 m0, s45
    s_nop 0
    buffer_load_dwordx4 v29, s[16:19], s31 offen lds
    s_add_u32 s31, s31, 0x8000
    s_add_u32 s45, s45, 0x400
    s_mov_b32 m0, s45
    s_nop 0
    buffer_load_dwordx4 v30, s[16:19], s31 offen lds
    s_add_u32 s31, s31, 0x8000
    s_add_u32 s45, s45, 0x400
    s_mov_b32 m0, s45
    s_nop 0
    buffer_load_dwordx4 v31, s[16:19], s31 offen lds
    s_add_u32 s31, s31, 0x8000
    s_add_u32 s45, s45, 0x400
    s_mov_b32 m0, s45
    s_nop 0
    buffer_load_dwordx4 v28, s[16:19], s31 offen lds
    s_add_u32 s31, s31, 0x8000
    s_add_u32 s45, s45, 0x400
    s_mov_b32 m0, s45
    s_nop 0
    buffer_load_dwordx4 v29, s[16:19], s31 offen lds
    s_add_u32 s31, s31, 0x8000
    s_add_u32 s45, s45, 0x400
    s_mov_b32 m0, s45
    s_nop 0
    buffer_load_dwordx4 v30, s[16:19], s31 offen lds
    s_add_u32 s31, s31, 0x8000
    s_add_u32 s45, s45, 0x400
    s_mov_b32 m0, s45
    s_nop 0
    buffer_load_dwordx4 v31, s[16:19], s31 offen lds
    s_add_u32 s31, s31, 0x8000
    s_add_u32 s45, s45, 0x400
    s_mov_b32 m0, s45
    s_nop 0
    buffer_load_dwordx4 v28, s[16:19], s31 offen lds
    s_add_u32 s31, s31, 0x8000
    s_add_u32 s45, s45, 0x400
    s_mov_b32 m0, s45
    s_nop 0
    buffer_load_dwordx4 v29, s[16:19], s31 offen lds
    s_add_u32 s31, s31, 0x8000
    s_add_u32 s45, s45, 0x400
    s_mov_b32 m0, s45
    s_nop 0
    buffer_load_dwordx4 v30, s[16:19], s31 offen lds
    s_add_u32 s31, s31, 0x8000
    s_add_u32 s45, s45, 0x400
    s_mov_b32 m0, s45
    s_nop 0
    buffer_load_dwordx4 v31, s[16:19], s31 offen lds
    s_add_u32 s31, s31, 0x8000
    s_add_u32 s45, s45, 0x400
    s_waitcnt vmcnt(16)
    s_barrier
    ds_read_b64_tr_b16 a[128:129], v36 offset:0
    ds_read_b64_tr_b16 a[130:131], v36 offset:256
    ds_read_b64_tr_b16 a[132:133], v36 offset:8192
    ds_read_b64_tr_b16 a[134:135], v36 offset:8448
    ds_read_b64_tr_b16 a[136:137], v36 offset:16384
    ds_read_b64_tr_b16 a[138:139], v36 offset:16640
    ds_read_b64_tr_b16 a[140:141], v36 offset:24576
    ds_read_b64_tr_b16 a[142:143], v36 offset:24832
    ds_read_b64_tr_b16 a[144:145], v36 offset:32768
    ds_read_b64_tr_b16 a[146:147], v36 offset:33024
    ds_read_b64_tr_b16 a[148:149], v36 offset:40960
    ds_read_b64_tr_b16 a[150:151], v36 offset:41216
    s_waitcnt lgkmcnt(4)
    ds_read_b64_tr_b16 a[152:153], v36 offset:49152
    ds_read_b64_tr_b16 a[154:155], v36 offset:49408
    ds_read_b64_tr_b16 a[156:157], v36 offset:57344
    ds_read_b64_tr_b16 a[158:159], v36 offset:57600
    ds_read_b64_tr_b16 a[192:193], v37 offset:0
    ds_read_b64_tr_b16 a[194:195], v37 offset:256
    ds_read_b64_tr_b16 a[196:197], v37 offset:8192
    ds_read_b64_tr_b16 a[198:199], v37 offset:8448
    ds_read_b64_tr_b16 a[200:201], v37 offset:16384
    ds_read_b64_tr_b16 a[202:203], v37 offset:16640
    ds_read_b64_tr_b16 a[204:205], v37 offset:24576
    ds_read_b64_tr_b16 a[206:207], v37 offset:24832
    s_waitcnt lgkmcnt(4)
    ds_read_b64_tr_b16 a[208:209], v37 offset:32768
    ds_read_b64_tr_b16 a[210:211], v37 offset:33024
    ds_read_b64_tr_b16 a[212:213], v37 offset:40960
    ds_read_b64_tr_b16 a[214:215], v37 offset:41216
    ds_read_b64_tr_b16 a[216:217], v37 offset:49152
    ds_read_b64_tr_b16 a[218:219], v37 offset:49408
    ds_read_b64_tr_b16 a[220:221], v37 offset:57344
    ds_read_b64_tr_b16 a[222:223], v37 offset:57600
    s_waitcnt lgkmcnt(0)
    s_barrier
    s_mov_b32 s16, s60
    s_and_b32 s17, s61, 0xffff
    s_mov_b32 s18, 0x400000
    s_mov_b32 s19, 0x20000
    s_lshl_b32 s31, s25, 19
    s_add_u32 s31, s31, 0x0
    s_lshl_b32 s45, s25, 14
    s_add_u32 s45, s45, 0x8000
    s_mov_b32 m0, s45
    s_nop 0
    buffer_load_dwordx4 v28, s[16:19], s31 offen lds
    s_add_u32 s31, s31, 0x8000
    s_add_u32 s45, s45, 0x400
    s_mov_b32 m0, s45
    s_nop 0
    buffer_load_dwordx4 v29, s[16:19], s31 offen lds
    s_add_u32 s31, s31, 0x8000
    s_add_u32 s45, s45, 0x400
    s_mov_b32 m0, s45
    s_nop 0
    buffer_load_dwordx4 v30, s[16:19], s31 offen lds
    s_add_u32 s31, s31, 0x8000
    s_add_u32 s45, s45, 0x400
    s_mov_b32 m0, s45
    s_nop 0
    buffer_load_dwordx4 v31, s[16:19], s31 offen lds
    s_add_u32 s31, s31, 0x8000
    s_add_u32 s45, s45, 0x400
    s_mov_b32 m0, s45
    s_nop 0
    buffer_load_dwordx4 v28, s[16:19], s31 offen lds
    s_add_u32 s31, s31, 0x8000
    s_add_u32 s45, s45, 0x400
    s_mov_b32 m0, s45
    s_nop 0
    buffer_load_dwordx4 v29, s[16:19], s31 offen lds
    s_add_u32 s31, s31, 0x8000
    s_add_u32 s45, s45, 0x400
    s_mov_b32 m0, s45
    s_nop 0
    buffer_load_dwordx4 v30, s[16:19], s31 offen lds
    s_add_u32 s31, s31, 0x8000
    s_add_u32 s45, s45, 0x400
    s_mov_b32 m0, s45
    s_nop 0
    buffer_load_dwordx4 v31, s[16:19], s31 offen lds
    s_add_u32 s31, s31, 0x8000
    s_add_u32 s45, s45, 0x400
    s_mov_b32 m0, s45
    s_nop 0
    buffer_load_dwordx4 v28, s[16:19], s31 offen lds
    s_add_u32 s31, s31, 0x8000
    s_add_u32 s45, s45, 0x400
    s_mov_b32 m0, s45
    s_nop 0
    buffer_load_dwordx4 v29, s[16:19], s31 offen lds
    s_add_u32 s31, s31, 0x8000
    s_add_u32 s45, s45, 0x400
    s_mov_b32 m0, s45
    s_nop 0
    buffer_load_dwordx4 v30, s[16:19], s31 offen lds
    s_add_u32 s31, s31, 0x8000
    s_add_u32 s45, s45, 0x400
    s_mov_b32 m0, s45
    s_nop 0
    buffer_load_dwordx4 v31, s[16:19], s31 offen lds
    s_add_u32 s31, s31, 0x8000
    s_add_u32 s45, s45, 0x400
    s_mov_b32 m0, s45
    s_nop 0
    buffer_load_dwordx4 v28, s[16:19], s31 offen lds
    s_add_u32 s31, s31, 0x8000
    s_add_u32 s45, s45, 0x400
    s_mov_b32 m0, s45
    s_nop 0
    buffer_load_dwordx4 v29, s[16:19], s31 offen lds
    s_add_u32 s31, s31, 0x8000
    s_add_u32 s45, s45, 0x400
    s_mov_b32 m0, s45
    s_nop 0
    buffer_load_dwordx4 v30, s[16:19], s31 offen lds
    s_add_u32 s31, s31, 0x8000
    s_add_u32 s45, s45, 0x400
    s_mov_b32 m0, s45
    s_nop 0
    buffer_load_dwordx4 v31, s[16:19], s31 offen lds
    s_add_u32 s31, s31, 0x8000
    s_add_u32 s45, s45, 0x400
    s_waitcnt vmcnt(16)
    s_barrier
    ds_read_b64_tr_b16 a[160:161], v38 offset:0
    ds_read_b64_tr_b16 a[162:163], v38 offset:256
    ds_read_b64_tr_b16 a[164:165], v38 offset:8192
    ds_read_b64_tr_b16 a[166:167], v38 offset:8448
    ds_read_b64_tr_b16 a[168:169], v38 offset:16384
    ds_read_b64_tr_b16 a[170:171], v38 offset:16640
    ds_read_b64_tr_b16 a[172:173], v38 offset:24576
    ds_read_b64_tr_b16 a[174:175], v38 offset:24832
    ds_read_b64_tr_b16 a[176:177], v38 offset:32768
    ds_read_b64_tr_b16 a[178:179], v38 offset:33024
    ds_read_b64_tr_b16 a[180:181], v38 offset:40960
    ds_read_b64_tr_b16 a[182:183], v38 offset:41216
    s_waitcnt lgkmcnt(4)
    ds_read_b64_tr_b16 a[184:185], v38 offset:49152
    ds_read_b64_tr_b16 a[186:187], v38 offset:49408
    ds_read_b64_tr_b16 a[188:189], v38 offset:57344
    ds_read_b64_tr_b16 a[190:191], v38 offset:57600
    ds_read_b64_tr_b16 a[224:225], v39 offset:0
    ds_read_b64_tr_b16 a[226:227], v39 offset:256
    ds_read_b64_tr_b16 a[228:229], v39 offset:8192
    ds_read_b64_tr_b16 a[230:231], v39 offset:8448
    ds_read_b64_tr_b16 a[232:233], v39 offset:16384
    ds_read_b64_tr_b16 a[234:235], v39 offset:16640
    ds_read_b64_tr_b16 a[236:237], v39 offset:24576
    ds_read_b64_tr_b16 a[238:239], v39 offset:24832
    s_waitcnt lgkmcnt(4)
    ds_read_b64_tr_b16 a[240:241], v39 offset:32768
    ds_read_b64_tr_b16 a[242:243], v39 offset:33024
    ds_read_b64_tr_b16 a[244:245], v39 offset:40960
    ds_read_b64_tr_b16 a[246:247], v39 offset:41216
    ds_read_b64_tr_b16 a[248:249], v39 offset:49152
    ds_read_b64_tr_b16 a[250:251], v39 offset:49408
    ds_read_b64_tr_b16 a[252:253], v39 offset:57344
    ds_read_b64_tr_b16 a[254:255], v39 offset:57600
    s_waitcnt lgkmcnt(0)
    s_barrier
    s_mov_b32 s16, s60
    s_and_b32 s17, s61, 0xffff
    s_mov_b32 s18, 0x400000
    s_mov_b32 s19, 0x20000
    s_lshl_b32 s31, s25, 19
    s_add_u32 s31, s31, 0x200000
    s_lshl_b32 s45, s25, 14
    s_add_u32 s45, s45, 0x18000
    s_mov_b32 m0, s45
    s_nop 0
    buffer_load_dwordx4 v28, s[16:19], s31 offen lds
    s_add_u32 s31, s31, 0x8000
    s_add_u32 s45, s45, 0x400
    s_mov_b32 m0, s45
    s_nop 0
    buffer_load_dwordx4 v29, s[16:19], s31 offen lds
    s_add_u32 s31, s31, 0x8000
    s_add_u32 s45, s45, 0x400
    s_mov_b32 m0, s45
    s_nop 0
    buffer_load_dwordx4 v30, s[16:19], s31 offen lds
    s_add_u32 s31, s31, 0x8000
    s_add_u32 s45, s45, 0x400
    s_mov_b32 m0, s45
    s_nop 0
    buffer_load_dwordx4 v31, s[16:19], s31 offen lds
    s_add_u32 s31, s31, 0x8000
    s_add_u32 s45, s45, 0x400
    s_mov_b32 m0, s45
    s_nop 0
    buffer_load_dwordx4 v28, s[16:19], s31 offen lds
    s_add_u32 s31, s31, 0x8000
    s_add_u32 s45, s45, 0x400
    s_mov_b32 m0, s45
    s_nop 0
    buffer_load_dwordx4 v29, s[16:19], s31 offen lds
    s_add_u32 s31, s31, 0x8000
    s_add_u32 s45, s45, 0x400
    s_mov_b32 m0, s45
    s_nop 0
    buffer_load_dwordx4 v30, s[16:19], s31 offen lds
    s_add_u32 s31, s31, 0x8000
    s_add_u32 s45, s45, 0x400
    s_mov_b32 m0, s45
    s_nop 0
    buffer_load_dwordx4 v31, s[16:19], s31 offen lds
    s_add_u32 s31, s31, 0x8000
    s_add_u32 s45, s45, 0x400
    s_mov_b32 m0, s45
    s_nop 0
    buffer_load_dwordx4 v28, s[16:19], s31 offen lds
    s_add_u32 s31, s31, 0x8000
    s_add_u32 s45, s45, 0x400
    s_mov_b32 m0, s45
    s_nop 0
    buffer_load_dwordx4 v29, s[16:19], s31 offen lds
    s_add_u32 s31, s31, 0x8000
    s_add_u32 s45, s45, 0x400
    s_mov_b32 m0, s45
    s_nop 0
    buffer_load_dwordx4 v30, s[16:19], s31 offen lds
    s_add_u32 s31, s31, 0x8000
    s_add_u32 s45, s45, 0x400
    s_mov_b32 m0, s45
    s_nop 0
    buffer_load_dwordx4 v31, s[16:19], s31 offen lds
    s_add_u32 s31, s31, 0x8000
    s_add_u32 s45, s45, 0x400
    s_mov_b32 m0, s45
    s_nop 0
    buffer_load_dwordx4 v28, s[16:19], s31 offen lds
    s_add_u32 s31, s31, 0x8000
    s_add_u32 s45, s45, 0x400
    s_mov_b32 m0, s45
    s_nop 0
    buffer_load_dwordx4 v29, s[16:19], s31 offen lds
    s_add_u32 s31, s31, 0x8000
    s_add_u32 s45, s45, 0x400
    s_mov_b32 m0, s45
    s_nop 0
    buffer_load_dwordx4 v30, s[16:19], s31 offen lds
    s_add_u32 s31, s31, 0x8000
    s_add_u32 s45, s45, 0x400
    s_mov_b32 m0, s45
    s_nop 0
    buffer_load_dwordx4 v31, s[16:19], s31 offen lds
    s_add_u32 s31, s31, 0x8000
    s_add_u32 s45, s45, 0x400
    s_waitcnt vmcnt(16)
    s_barrier
    ds_read_b64_tr_b16 v[128:129], v36 offset:0
    ds_read_b64_tr_b16 v[130:131], v36 offset:256
    ds_read_b64_tr_b16 v[132:133], v36 offset:8192
    ds_read_b64_tr_b16 v[134:135], v36 offset:8448
    ds_read_b64_tr_b16 v[136:137], v36 offset:16384
    ds_read_b64_tr_b16 v[138:139], v36 offset:16640
    ds_read_b64_tr_b16 v[140:141], v36 offset:24576
    ds_read_b64_tr_b16 v[142:143], v36 offset:24832
    ds_read_b64_tr_b16 v[144:145], v36 offset:32768
    ds_read_b64_tr_b16 v[146:147], v36 offset:33024
    ds_read_b64_tr_b16 v[148:149], v36 offset:40960
    ds_read_b64_tr_b16 v[150:151], v36 offset:41216
    s_waitcnt lgkmcnt(4)
    ds_read_b64_tr_b16 v[152:153], v36 offset:49152
    ds_read_b64_tr_b16 v[154:155], v36 offset:49408
    ds_read_b64_tr_b16 v[156:157], v36 offset:57344
    ds_read_b64_tr_b16 v[158:159], v36 offset:57600
    ds_read_b64_tr_b16 v[192:193], v37 offset:0
    ds_read_b64_tr_b16 v[194:195], v37 offset:256
    ds_read_b64_tr_b16 v[196:197], v37 offset:8192
    ds_read_b64_tr_b16 v[198:199], v37 offset:8448
    ds_read_b64_tr_b16 v[200:201], v37 offset:16384
    ds_read_b64_tr_b16 v[202:203], v37 offset:16640
    ds_read_b64_tr_b16 v[204:205], v37 offset:24576
    ds_read_b64_tr_b16 v[206:207], v37 offset:24832
    s_waitcnt lgkmcnt(4)
    ds_read_b64_tr_b16 v[208:209], v37 offset:32768
    ds_read_b64_tr_b16 v[210:211], v37 offset:33024
    ds_read_b64_tr_b16 v[212:213], v37 offset:40960
    ds_read_b64_tr_b16 v[214:215], v37 offset:41216
    ds_read_b64_tr_b16 v[216:217], v37 offset:49152
    ds_read_b64_tr_b16 v[218:219], v37 offset:49408
    ds_read_b64_tr_b16 v[220:221], v37 offset:57344
    ds_read_b64_tr_b16 v[222:223], v37 offset:57600
    s_waitcnt lgkmcnt(0)
    s_barrier
    s_mov_b32 s16, s62
    s_and_b32 s17, s63, 0xffff
    s_mov_b32 s18, 0x400000
    s_mov_b32 s19, 0x20000
    s_lshl_b32 s31, s24, 17
    s_lshl_b32 s45, s25, 14
    s_add_u32 s31, s31, s45
    s_add_u32 s31, s31, 0x0
    s_add_u32 s45, s45, 0x8000
    s_and_b32 s46, s25, 1
    s_lshl_b32 s46, s46, 7
    v_xor_b32 v44, s46, v1
    v_xor_b32 v45, 16, v44
    s_mov_b32 m0, s45
    s_nop 0
    buffer_load_dwordx4 v44, s[16:19], s31 offen lds
    s_add_u32 s31, s31, 0x400
    s_add_u32 s45, s45, 0x400
    s_mov_b32 m0, s45
    s_nop 0
    buffer_load_dwordx4 v45, s[16:19], s31 offen lds
    s_add_u32 s31, s31, 0x400
    s_add_u32 s45, s45, 0x400
    s_mov_b32 m0, s45
    s_nop 0
    buffer_load_dwordx4 v44, s[16:19], s31 offen lds
    s_add_u32 s31, s31, 0x400
    s_add_u32 s45, s45, 0x400
    s_mov_b32 m0, s45
    s_nop 0
    buffer_load_dwordx4 v45, s[16:19], s31 offen lds
    s_add_u32 s31, s31, 0x400
    s_add_u32 s45, s45, 0x400
    s_mov_b32 m0, s45
    s_nop 0
    buffer_load_dwordx4 v44, s[16:19], s31 offen lds
    s_add_u32 s31, s31, 0x400
    s_add_u32 s45, s45, 0x400
    s_mov_b32 m0, s45
    s_nop 0
    buffer_load_dwordx4 v45, s[16:19], s31 offen lds
    s_add_u32 s31, s31, 0x400
    s_add_u32 s45, s45, 0x400
    s_mov_b32 m0, s45
    s_nop 0
    buffer_load_dwordx4 v44, s[16:19], s31 offen lds
    s_add_u32 s31, s31, 0x400
    s_add_u32 s45, s45, 0x400
    s_mov_b32 m0, s45
    s_nop 0
    buffer_load_dwordx4 v45, s[16:19], s31 offen lds
    s_add_u32 s31, s31, 0x400
    s_add_u32 s45, s45, 0x400
    s_mov_b32 m0, s45
    s_nop 0
    buffer_load_dwordx4 v44, s[16:19], s31 offen lds
    s_add_u32 s31, s31, 0x400
    s_add_u32 s45, s45, 0x400
    s_mov_b32 m0, s45
    s_nop 0
    buffer_load_dwordx4 v45, s[16:19], s31 offen lds
    s_add_u32 s31, s31, 0x400
    s_add_u32 s45, s45, 0x400
    s_mov_b32 m0, s45
    s_nop 0
    buffer_load_dwordx4 v44, s[16:19], s31 offen lds
    s_add_u32 s31, s31, 0x400
    s_add_u32 s45, s45, 0x400
    s_mov_b32 m0, s45
    s_nop 0
    buffer_load_dwordx4 v45, s[16:19], s31 offen lds
    s_add_u32 s31, s31, 0x400
    s_add_u32 s45, s45, 0x400
    s_mov_b32 m0, s45
    s_nop 0
    buffer_load_dwordx4 v44, s[16:19], s31 offen lds
    s_add_u32 s31, s31, 0x400
    s_add_u32 s45, s45, 0x400
    s_mov_b32 m0, s45
    s_nop 0
    buffer_load_dwordx4 v45, s[16:19], s31 offen lds
    s_add_u32 s31, s31, 0x400
    s_add_u32 s45, s45, 0x400
    s_mov_b32 m0, s45
    s_nop 0
    buffer_load_dwordx4 v44, s[16:19], s31 offen lds
    s_add_u32 s31, s31, 0x400
    s_add_u32 s45, s45, 0x400
    s_mov_b32 m0, s45
    s_nop 0
    buffer_load_dwordx4 v45, s[16:19], s31 offen lds
    s_add_u32 s31, s31, 0x400
    s_add_u32 s45, s45, 0x400
    s_waitcnt vmcnt(16)
    s_barrier
    ds_read_b64_tr_b16 v[160:161], v38 offset:0
    ds_read_b64_tr_b16 v[162:163], v38 offset:256
    ds_read_b64_tr_b16 v[164:165], v38 offset:8192
    ds_read_b64_tr_b16 v[166:167], v38 offset:8448
    ds_read_b64_tr_b16 v[168:169], v38 offset:16384
    ds_read_b64_tr_b16 v[170:171], v38 offset:16640
    ds_read_b64_tr_b16 v[172:173], v38 offset:24576
    ds_read_b64_tr_b16 v[174:175], v38 offset:24832
    ds_read_b64_tr_b16 v[176:177], v38 offset:32768
    ds_read_b64_tr_b16 v[178:179], v38 offset:33024
    ds_read_b64_tr_b16 v[180:181], v38 offset:40960
    ds_read_b64_tr_b16 v[182:183], v38 offset:41216
    s_waitcnt lgkmcnt(4)
    ds_read_b64_tr_b16 v[184:185], v38 offset:49152
    ds_read_b64_tr_b16 v[186:187], v38 offset:49408
    ds_read_b64_tr_b16 v[188:189], v38 offset:57344
    ds_read_b64_tr_b16 v[190:191], v38 offset:57600
    ds_read_b64_tr_b16 v[224:225], v39 offset:0
    ds_read_b64_tr_b16 v[226:227], v39 offset:256
    ds_read_b64_tr_b16 v[228:229], v39 offset:8192
    ds_read_b64_tr_b16 v[230:231], v39 offset:8448
    ds_read_b64_tr_b16 v[232:233], v39 offset:16384
    ds_read_b64_tr_b16 v[234:235], v39 offset:16640
    ds_read_b64_tr_b16 v[236:237], v39 offset:24576
    ds_read_b64_tr_b16 v[238:239], v39 offset:24832
    s_waitcnt lgkmcnt(4)
    ds_read_b64_tr_b16 v[240:241], v39 offset:32768
    ds_read_b64_tr_b16 v[242:243], v39 offset:33024
    ds_read_b64_tr_b16 v[244:245], v39 offset:40960
    ds_read_b64_tr_b16 v[246:247], v39 offset:41216
    ds_read_b64_tr_b16 v[248:249], v39 offset:49152
    ds_read_b64_tr_b16 v[250:251], v39 offset:49408
    ds_read_b64_tr_b16 v[252:253], v39 offset:57344
    ds_read_b64_tr_b16 v[254:255], v39 offset:57600
    s_waitcnt lgkmcnt(0)
    s_barrier
    s_mov_b32 s16, s62
    s_and_b32 s17, s63, 0xffff
    s_mov_b32 s18, 0x400000
    s_mov_b32 s19, 0x20000
    s_lshl_b32 s31, s24, 17
    s_lshl_b32 s45, s25, 14
    s_add_u32 s31, s31, s45
    s_add_u32 s31, s31, 0x10000
    s_add_u32 s45, s45, 0x18000
    s_and_b32 s46, s25, 1
    s_lshl_b32 s46, s46, 7
    v_xor_b32 v44, s46, v1
    v_xor_b32 v45, 16, v44
    s_mov_b32 m0, s45
    s_nop 0
    buffer_load_dwordx4 v44, s[16:19], s31 offen lds
    s_add_u32 s31, s31, 0x400
    s_add_u32 s45, s45, 0x400
    s_mov_b32 m0, s45
    s_nop 0
    buffer_load_dwordx4 v45, s[16:19], s31 offen lds
    s_add_u32 s31, s31, 0x400
    s_add_u32 s45, s45, 0x400
    s_mov_b32 m0, s45
    s_nop 0
    buffer_load_dwordx4 v44, s[16:19], s31 offen lds
    s_add_u32 s31, s31, 0x400
    s_add_u32 s45, s45, 0x400
    s_mov_b32 m0, s45
    s_nop 0
    buffer_load_dwordx4 v45, s[16:19], s31 offen lds
    s_add_u32 s31, s31, 0x400
    s_add_u32 s45, s45, 0x400
    s_mov_b32 m0, s45
    s_nop 0
    buffer_load_dwordx4 v44, s[16:19], s31 offen lds
    s_add_u32 s31, s31, 0x400
    s_add_u32 s45, s45, 0x400
    s_mov_b32 m0, s45
    s_nop 0
    buffer_load_dwordx4 v45, s[16:19], s31 offen lds
    s_add_u32 s31, s31, 0x400
    s_add_u32 s45, s45, 0x400
    s_mov_b32 m0, s45
    s_nop 0
    buffer_load_dwordx4 v44, s[16:19], s31 offen lds
    s_add_u32 s31, s31, 0x400
    s_add_u32 s45, s45, 0x400
    s_mov_b32 m0, s45
    s_nop 0
    buffer_load_dwordx4 v45, s[16:19], s31 offen lds
    s_add_u32 s31, s31, 0x400
    s_add_u32 s45, s45, 0x400
    s_mov_b32 m0, s45
    s_nop 0
    buffer_load_dwordx4 v44, s[16:19], s31 offen lds
    s_add_u32 s31, s31, 0x400
    s_add_u32 s45, s45, 0x400
    s_mov_b32 m0, s45
    s_nop 0
    buffer_load_dwordx4 v45, s[16:19], s31 offen lds
    s_add_u32 s31, s31, 0x400
    s_add_u32 s45, s45, 0x400
    s_mov_b32 m0, s45
    s_nop 0
    buffer_load_dwordx4 v44, s[16:19], s31 offen lds
    s_add_u32 s31, s31, 0x400
    s_add_u32 s45, s45, 0x400
    s_mov_b32 m0, s45
    s_nop 0
    buffer_load_dwordx4 v45, s[16:19], s31 offen lds
    s_add_u32 s31, s31, 0x400
    s_add_u32 s45, s45, 0x400
    s_mov_b32 m0, s45
    s_nop 0
    buffer_load_dwordx4 v44, s[16:19], s31 offen lds
    s_add_u32 s31, s31, 0x400
    s_add_u32 s45, s45, 0x400
    s_mov_b32 m0, s45
    s_nop 0
    buffer_load_dwordx4 v45, s[16:19], s31 offen lds
    s_add_u32 s31, s31, 0x400
    s_add_u32 s45, s45, 0x400
    s_mov_b32 m0, s45
    s_nop 0
    buffer_load_dwordx4 v44, s[16:19], s31 offen lds
    s_add_u32 s31, s31, 0x400
    s_add_u32 s45, s45, 0x400
    s_mov_b32 m0, s45
    s_nop 0
    buffer_load_dwordx4 v45, s[16:19], s31 offen lds
    s_add_u32 s31, s31, 0x400
    s_add_u32 s45, s45, 0x400
    s_waitcnt vmcnt(16)
    s_barrier
    ds_read_b64_tr_b16 v[64:65], v40 offset:0
    ds_read_b64_tr_b16 v[66:67], v40 offset:2048
    ds_read_b64_tr_b16 v[68:69], v40 offset:8192
    ds_read_b64_tr_b16 v[70:71], v40 offset:10240
    ds_read_b64_tr_b16 v[72:73], v40 offset:8
    ds_read_b64_tr_b16 v[74:75], v40 offset:2056
    ds_read_b64_tr_b16 v[76:77], v40 offset:8200
    ds_read_b64_tr_b16 v[78:79], v40 offset:10248
    ds_read_b64_tr_b16 v[80:81], v41 offset:0
    ds_read_b64_tr_b16 v[82:83], v41 offset:2048
    ds_read_b64_tr_b16 v[84:85], v41 offset:8192
    ds_read_b64_tr_b16 v[86:87], v41 offset:10240
    s_waitcnt lgkmcnt(4)
    ds_read_b64_tr_b16 v[88:89], v41 offset:8
    ds_read_b64_tr_b16 v[90:91], v41 offset:2056
    ds_read_b64_tr_b16 v[92:93], v41 offset:8200
    ds_read_b64_tr_b16 v[94:95], v41 offset:10248
    ds_read_b64_tr_b16 v[96:97], v40 offset:512
    ds_read_b64_tr_b16 v[98:99], v40 offset:2560
    ds_read_b64_tr_b16 v[100:101], v40 offset:8704
    ds_read_b64_tr_b16 v[102:103], v40 offset:10752
    ds_read_b64_tr_b16 v[104:105], v40 offset:520
    ds_read_b64_tr_b16 v[106:107], v40 offset:2568
    ds_read_b64_tr_b16 v[108:109], v40 offset:8712
    ds_read_b64_tr_b16 v[110:111], v40 offset:10760
    s_waitcnt lgkmcnt(4)
    ds_read_b64_tr_b16 v[112:113], v41 offset:512
    ds_read_b64_tr_b16 v[114:115], v41 offset:2560
    ds_read_b64_tr_b16 v[116:117], v41 offset:8704
    ds_read_b64_tr_b16 v[118:119], v41 offset:10752
    ds_read_b64_tr_b16 v[120:121], v41 offset:520
    ds_read_b64_tr_b16 v[122:123], v41 offset:2568
    ds_read_b64_tr_b16 v[124:125], v41 offset:8712
    ds_read_b64_tr_b16 v[126:127], v41 offset:10760
    s_waitcnt lgkmcnt(0)
    s_barrier
    ds_write_b128 v7, v[64:67] offset:0
    ds_write_b128 v7, v[68:71] offset:1024
    ds_write_b128 v7, v[72:75] offset:2048
    ds_write_b128 v7, v[76:79] offset:3072
    ds_write_b128 v7, v[80:83] offset:4096
    ds_write_b128 v7, v[84:87] offset:5120
    ds_write_b128 v7, v[88:91] offset:6144
    ds_write_b128 v7, v[92:95] offset:7168
    s_waitcnt lgkmcnt(0)
    ds_write_b128 v7, v[96:99] offset:8192
    ds_write_b128 v7, v[100:103] offset:9216
    ds_write_b128 v7, v[104:107] offset:10240
    ds_write_b128 v7, v[108:111] offset:11264
    ds_write_b128 v7, v[112:115] offset:12288
    ds_write_b128 v7, v[116:119] offset:13312
    ds_write_b128 v7, v[120:123] offset:14336
    ds_write_b128 v7, v[124:127] offset:15360
    s_waitcnt lgkmcnt(0)
    s_waitcnt vmcnt(0)
    v_mov_b32 v46, 32
    v_bfe_u32 v47, v1, 4, 4
    v_lshlrev_b32 v47, 2, v47
    buffer_load_dword v48, v46, s[12:15], 0 offen sc1
    buffer_load_dword v49, v46, s[12:15], 0 offen offset:28 sc1
    s_waitcnt vmcnt(0)
    buffer_load_dword v50, v47, s[8:11], s66 offen sc1
    s_barrier
    ds_read_b64_tr_b16 v[64:65], v42 offset:0
    ds_read_b64_tr_b16 v[66:67], v42 offset:2048
    ds_read_b64_tr_b16 v[68:69], v42 offset:8192
    ds_read_b64_tr_b16 v[70:71], v42 offset:10240
    ds_read_b64_tr_b16 v[72:73], v42 offset:8
    ds_read_b64_tr_b16 v[74:75], v42 offset:2056
    ds_read_b64_tr_b16 v[76:77], v42 offset:8200
    ds_read_b64_tr_b16 v[78:79], v42 offset:10248
    ds_read_b64_tr_b16 v[80:81], v43 offset:0
    ds_read_b64_tr_b16 v[82:83], v43 offset:2048
    ds_read_b64_tr_b16 v[84:85], v43 offset:8192
    ds_read_b64_tr_b16 v[86:87], v43 offset:10240
    s_waitcnt lgkmcnt(4)
    ds_read_b64_tr_b16 v[88:89], v43 offset:8
    ds_read_b64_tr_b16 v[90:91], v43 offset:2056
    ds_read_b64_tr_b16 v[92:93], v43 offset:8200
    ds_read_b64_tr_b16 v[94:95], v43 offset:10248
    ds_read_b64_tr_b16 v[96:97], v42 offset:512
    ds_read_b64_tr_b16 v[98:99], v42 offset:2560
    ds_read_b64_tr_b16 v[100:101], v42 offset:8704
    ds_read_b64_tr_b16 v[102:103], v42 offset:10752
    ds_read_b64_tr_b16 v[104:105], v42 offset:520
    ds_read_b64_tr_b16 v[106:107], v42 offset:2568
    ds_read_b64_tr_b16 v[108:109], v42 offset:8712
    ds_read_b64_tr_b16 v[110:111], v42 offset:10760
    s_waitcnt lgkmcnt(4)
    ds_read_b64_tr_b16 v[112:113], v43 offset:512
    ds_read_b64_tr_b16 v[114:115], v43 offset:2560
    ds_read_b64_tr_b16 v[116:117], v43 offset:8704
    ds_read_b64_tr_b16 v[118:119], v43 offset:10752
    ds_read_b64_tr_b16 v[120:121], v43 offset:520
    ds_read_b64_tr_b16 v[122:123], v43 offset:2568
    ds_read_b64_tr_b16 v[124:125], v43 offset:8712
    ds_read_b64_tr_b16 v[126:127], v43 offset:10760
    s_waitcnt lgkmcnt(0)
    s_barrier
    ds_write_b128 v8, v[64:67] offset:0
    ds_write_b128 v8, v[68:71] offset:1024
    ds_write_b128 v8, v[72:75] offset:2048
    ds_write_b128 v8, v[76:79] offset:3072
    ds_write_b128 v8, v[80:83] offset:4096
    ds_write_b128 v8, v[84:87] offset:5120
    ds_write_b128 v8, v[88:91] offset:6144
    ds_write_b128 v8, v[92:95] offset:7168
    s_waitcnt lgkmcnt(0)
    ds_write_b128 v8, v[96:99] offset:8192
    ds_write_b128 v8, v[100:103] offset:9216
    ds_write_b128 v8, v[104:107] offset:10240
    ds_write_b128 v8, v[108:111] offset:11264
    ds_write_b128 v8, v[112:115] offset:12288
    ds_write_b128 v8, v[116:119] offset:13312
    ds_write_b128 v8, v[120:123] offset:14336
    ds_write_b128 v8, v[124:127] offset:15360
    s_waitcnt lgkmcnt(0)
    v_mov_b32 v125, 0
    v_mov_b32 v127, 0
    s_waitcnt vmcnt(0)
    v_cmp_eq_u32 vcc, 0, v49
    s_cbranch_vccnz L_frdy_pre
    v_bfe_u32 v26, v1, 4, 2
    v_lshl_add_u32 v50, v50, 2, v26
    s_nop 1
    v_min_u32_dpp v50, v50, v50 row_ror:8 row_mask:0xf bank_mask:0xf
    s_nop 1
    v_min_u32_dpp v50, v50, v50 row_ror:4 row_mask:0xf bank_mask:0xf
    s_nop 1
    v_min_u32_dpp v50, v50, v50 row_ror:2 row_mask:0xf bank_mask:0xf
    s_nop 1
    v_min_u32_dpp v50, v50, v50 row_ror:1 row_mask:0xf bank_mask:0xf
    s_nop 0
    v_readfirstlane_b32 s67, v50
    s_nop 3
    s_sub_i32 s67, s67, 4
    s_cmp_ge_i32 s67, 1
    s_cbranch_scc1 L_kv0_ok
L_frdy_pre:
    v_mov_b32 v25, 60
L_frdy:
    buffer_load_dword v26, v25, s[12:15], 0 offen sc1
    s_waitcnt vmcnt(0)
    v_cmp_eq_u32 vcc, 0, v26
    s_cbranch_vccz L_frdy_ok
    s_sleep 2
    s_sub_u32 s65, s65, 1
    s_cmp_eq_u32 s65, 0
    s_cbranch_scc0 L_frdy
    s_mov_b32 s31, 4
    s_branch L_abort
L_frdy_ok:
L_kv0:
    buffer_load_dword v50, v47, s[8:11], s66 offen sc1
    s_waitcnt vmcnt(0)
    v_bfe_u32 v26, v1, 4, 2
    v_lshl_add_u32 v50, v50, 2, v26
    s_nop 1
    v_min_u32_dpp v50, v50, v50 row_ror:8 row_mask:0xf bank_mask:0xf
    s_nop 1
    v_min_u32_dpp v50, v50, v50 row_ror:4 row_mask:0xf bank_mask:0xf
    s_nop 1
    v_min_u32_dpp v50, v50, v50 row_ror:2 row_mask:0xf bank_mask:0xf
    s_nop 1
    v_min_u32_dpp v50, v50, v50 row_ror:1 row_mask:0xf bank_mask:0xf
    s_nop 0
    v_readfirstlane_b32 s67, v50
    s_nop 3
    s_sub_i32 s67, s67, 4
    s_cmp_ge_i32 s67, 1
    s_cbranch_scc1 L_kv0_ok
    s_sleep 2
    s_sub_u32 s65, s65, 1
    s_cmp_eq_u32 s65, 0
    s_cbranch_scc0 L_kv0
    s_mov_b32 s31, 5
    s_branch L_abort
L_kv0_ok:
    s_mov_b32 m0, s44
    s_nop 0
    buffer_load_dwordx4 v2, s[8:11], s40 offen sc1 lds
    buffer_load_dwordx4 v2, s[8:11], s40 offen offset:1024 sc1 lds
    s_xor_b32 s44, s44, 8192
    s_add_u32 s40, s40, 0x40000
    v_lshrrev_b32 v19, 2, v17
    v_lshlrev_b32 v19, 11, v19
    v_and_b32 v20, 1, v17
    v_lshl_add_u32 v19, v20, 10, v19
    v_lshl_add_u32 v19, v18, 5, v19
    v_bfe_u32 v20, v17, 1, 1
    v_lshl_add_u32 v24, v20, 4, v19
    s_lshl_b32 s31, s25, 8
    buffer_load_dwordx4 v[32:35], v24, s[20:23], s31 offen
    buffer_load_dwordx4 v[36:39], v24, s[20:23], s31 offen offset:128
    v_mov_b64 v[56:57], 0
    v_mov_b64 v[58:59], 0
    v_mov_b64 v[60:61], 0
    v_mov_b64 v[62:63], 0
    v_mov_b64 v[64:65], 0
    v_mov_b64 v[66:67], 0
    v_mov_b64 v[68:69], 0
    v_mov_b64 v[70:71], 0
    v_mov_b64 v[72:73], 0
    v_mov_b64 v[74:75], 0
    v_mov_b64 v[76:77], 0
    v_mov_b64 v[78:79], 0
    v_mov_b32 v25, 32
    s_waitcnt vmcnt(0)
    v_cmp_gt_u32 vcc, 32, v48
    s_cbranch_vccz L_init_ok
L_initwait:
    buffer_load_dword v26, v25, s[12:15], 0 offen sc1
    s_waitcnt vmcnt(0)
    v_cmp_gt_u32 vcc, 32, v26
    s_cbranch_vccz L_init_ok
    s_sub_u32 s65, s65, 1
    s_cmp_eq_u32 s65, 0
    s_cbranch_scc0 L_initwait
    s_mov_b32 s31, 1
    s_branch L_abort
L_init_ok:
    s_mov_b32 s31, 0x05040100
    s_mov_b32 s45, 0x07060302
    v_perm_b32 v16, v34, v32, s31
    v_perm_b32 v17, v34, v32, s45
    v_perm_b32 v18, v35, v33, s31
    v_perm_b32 v19, v35, v33, s45
    v_perm_b32 v20, v38, v36, s31
    v_perm_b32 v21, v38, v36, s45
    v_perm_b32 v22, v39, v37, s31
    v_perm_b32 v23, v39, v37, s45
    ds_write_b128 v2, v[16:19] offset:0
    ds_write_b128 v2, v[20:23] offset:1024
    v_mov_b64 v[104:105], v[16:17]
    v_mov_b64 v[106:107], v[18:19]
    v_mov_b64 v[108:109], v[20:21]
    v_mov_b64 v[110:111], v[22:23]
    s_waitcnt lgkmcnt(0)
    s_mov_b32 m0, s44
    s_branch L_have_mem
L_step:
    buffer_load_dwordx4 v[104:107], v2, s[8:11], s28 offen offset:0 sc1
    buffer_load_dwordx4 v[108:111], v2, s[8:11], s28 offen offset:1024 sc1
    v_mov_b32 v0, v1
    v_mov_b32 v0, v1
    v_mov_b32 v0, v1
    v_mov_b32 v0, v1
    v_mov_b32 v0, v1
    v_mov_b32 v0, v1
    v_mov_b32 v0, v1
    v_mov_b32 v0, v1
    v_mov_b32 v0, v1
    v_mov_b32 v0, v1
    v_mov_b32 v0, v1
    v_mov_b32 v0, v1
    v_mov_b32 v0, v1
    v_mov_b32 v0, v1
    v_mov_b32 v0, v1
    v_mov_b32 v0, v1
    v_mov_b32 v0, v1
    v_mov_b32 v0, v1
    v_mov_b32 v0, v1
    v_mov_b32 v0, v1
    v_mov_b32 v0, v1
    v_mov_b32 v0, v1
    v_mov_b32 v0, v1
    v_mov_b32 v0, v1
    v_mov_b32 v0, v1
    v_mov_b32 v0, v1
    v_mov_b32 v0, v1
    v_mov_b32 v0, v1
    v_mov_b32 v0, v1
    v_mov_b32 v0, v1
L_poll2:
    buffer_load_dwordx4 v[96:99], v2, s[8:11], s28 offen offset:0 sc1
    buffer_load_dwordx4 v[100:103], v2, s[8:11], s28 offen offset:1024 sc1
    v_mov_b32 v0, v1
    v_mov_b32 v0, v1
    v_mov_b32 v0, v1
    v_mov_b32 v0, v1
    v_mov_b32 v0, v1
    v_mov_b32 v0, v1
    v_mov_b32 v0, v1
    v_mov_b32 v0, v1
    s_waitcnt vmcnt(2)
    ds_write_b128 v2, v[104:107] offset:0
    v_max3_u32 v16, v104, v105, v106
    v_max3_u32 v17, v108, v109, v110
    ds_write_b128 v2, v[108:111] offset:1024
    v_max3_u32 v16, v16, v107, v111
    v_max_u32 v16, v16, v17
    v_cmp_eq_u32 vcc, -1, v16
    v_mov_b32 v0, v1
    v_mov_b32 v0, v1
    v_mov_b32 v0, v1
    s_waitcnt lgkmcnt(0)
    s_cbranch_vccz L_poll2_ok
    buffer_load_dwordx4 v[104:107], v2, s[8:11], s28 offen offset:0 sc1
    buffer_load_dwordx4 v[108:111], v2, s[8:11], s28 offen offset:1024 sc1
    v_mov_b32 v0, v1
    v_mov_b32 v0, v1
    v_mov_b32 v0, v1
    v_mov_b32 v0, v1
    v_mov_b32 v0, v1
    v_mov_b32 v0, v1
    v_mov_b32 v0, v1
    v_mov_b32 v0, v1
    s_waitcnt vmcnt(2)
    ds_write_b128 v2, v[96:99] offset:0
    v_max3_u32 v16, v96, v97, v98
    v_max3_u32 v17, v100, v101, v102
    ds_write_b128 v2, v[100:103] offset:1024
    v_max3_u32 v16, v16, v99, v103
    v_max_u32 v16, v16, v17
    v_cmp_eq_u32 vcc, -1, v16
    v_mov_b32 v0, v1
    v_mov_b32 v0, v1
    v_mov_b32 v0, v1
    s_waitcnt lgkmcnt(0)
    s_cbranch_vccz L_poll2_okB
    s_sub_u32 s65, s65, 1
    s_cmp_eq_u32 s65, 0
    s_cbranch_scc0 L_poll2
    s_mov_b32 s31, 2
    s_branch L_abort
L_poll2_okB:
    v_mov_b64 v[104:105], v[96:97]
    v_mov_b64 v[106:107], v[98:99]
    v_mov_b64 v[108:109], v[100:101]
    v_mov_b64 v[110:111], v[102:103]
L_poll2_ok:
L_have_mem:
    s_barrier
    s_cmp_eq_u32 s25, 1
    s_cbranch_scc1 L_qk1
    s_cmp_eq_u32 s25, 2
    s_cbranch_scc1 L_qk2
    s_cmp_eq_u32 s25, 3
    s_cbranch_scc1 L_qk3
    ds_read_b128 v[32:35], v1 offset:2048
    ds_read_b128 v[36:39], v1 offset:3072
    v_smfmac_f32_16x16x64_bf16 v[56:59], v[104:107], a[0:7], v13
    ds_read_b128 v[40:43], v1 offset:4096
    v_smfmac_f32_16x16x64_bf16 v[60:63], v[104:107], a[64:71], v13
    ds_read_b128 v[44:47], v1 offset:5120
    v_smfmac_f32_16x16x64_bf16 v[64:67], v[104:107], a[128:135], v13
    ds_read_b128 v[48:51], v1 offset:6144
    v_smfmac_f32_16x16x64_bf16 v[68:71], v[104:107], a[192:199], v13
    ds_read_b128 v[52:55], v1 offset:7168
    v_smfmac_f32_16x16x64_bf16 v[56:59], v[108:111], a[8:15], v13
    ds_read_b128 v[24:27], v1 offset:0
    v_smfmac_f32_16x16x64_bf16 v[60:63], v[108:111], a[72:79], v13
    ds_read_b128 v[28:31], v1 offset:1024
    v_smfmac_f32_16x16x64_bf16 v[64:67], v[108:111], a[136:143], v13
    buffer_load_dwordx4 v[112:115], v2, s[8:11], s41 offen offset:0 sc1
    v_smfmac_f32_16x16x64_bf16 v[68:71], v[108:111], a[200:207], v13
    s_waitcnt lgkmcnt(6)
    v_smfmac_f32_16x16x64_bf16 v[56:59], v[32:35], a[16:23], v13
    buffer_load_dwordx4 v[116:119], v2, s[8:11], s41 offen offset:1024 sc1
    v_smfmac_f32_16x16x64_bf16 v[60:63], v[32:35], a[80:87], v13
    s_waitcnt vmcnt(2)
    ds_read_b128 v[80:83], v5 offset:0
    v_smfmac_f32_16x16x64_bf16 v[64:67], v[32:35], a[144:151], v13
    buffer_load_dwordx4 v2, s[8:11], s40 offen offset:0 sc1 lds
    v_smfmac_f32_16x16x64_bf16 v[68:71], v[32:35], a[208:215], v13
    ds_read_b128 v[84:87], v5 offset:1024
    v_smfmac_f32_16x16x64_bf16 v[56:59], v[36:39], a[24:31], v13
    buffer_load_dwordx4 v2, s[8:11], s40 offen offset:1024 sc1 lds
    v_smfmac_f32_16x16x64_bf16 v[60:63], v[36:39], a[88:95], v13
    ds_read_b128 v[88:91], v5 offset:2048
    v_smfmac_f32_16x16x64_bf16 v[64:67], v[36:39], a[152:159], v13
    ds_read_b128 v[92:95], v5 offset:3072
    v_smfmac_f32_16x16x64_bf16 v[68:71], v[36:39], a[216:223], v13
    s_waitcnt lgkmcnt(6)
    v_smfmac_f32_16x16x64_bf16 v[56:59], v[40:43], a[32:39], v13
    ds_read_b128 v[96:99], v5 offset:4096
    v_smfmac_f32_16x16x64_bf16 v[60:63], v[40:43], a[96:103], v13
    ds_read_b128 v[100:103], v5 offset:5120
    v_smfmac_f32_16x16x64_bf16 v[64:67], v[40:43], a[160:167], v13
    ds_read_b128 v[104:107], v5 offset:6144
    v_smfmac_f32_16x16x64_bf16 v[68:71], v[40:43], a[224:231], v13
    ds_read_b128 v[108:111], v5 offset:7168
    v_smfmac_f32_16x16x64_bf16 v[56:59], v[44:47], a[40:47], v13
    v_mov_b32 v22, s26
    v_smfmac_f32_16x16x64_bf16 v[60:63], v[44:47], a[104:111], v13
    v_mov_b32 v0, v1
    v_smfmac_f32_16x16x64_bf16 v[64:67], v[44:47], a[168:175], v13
    v_mov_b32 v0, v1
    v_smfmac_f32_16x16x64_bf16 v[68:71], v[44:47], a[232:239], v13
    v_mov_b32 v0, v1
    v_smfmac_f32_16x16x64_bf16 v[56:59], v[48:51], a[48:55], v13
    v_mov_b32 v0, v1
    v_smfmac_f32_16x16x64_bf16 v[60:63], v[48:51], a[112:119], v13
    v_mov_b32 v0, v1
    v_smfmac_f32_16x16x64_bf16 v[64:67], v[48:51], a[176:183], v13
    v_mov_b32 v0, v1
    v_smfmac_f32_16x16x64_bf16 v[68:71], v[48:51], a[240:247], v13
    v_mov_b32 v0, v1
    v_smfmac_f32_16x16x64_bf16 v[56:59], v[52:55], a[56:63], v13
    v_mov_b32 v0, v1
    v_smfmac_f32_16x16x64_bf16 v[60:63], v[52:55], a[120:127], v13
    v_mov_b32 v0, v1
    v_smfmac_f32_16x16x64_bf16 v[64:67], v[52:55], a[184:191], v13
    v_mov_b32 v0, v1
    v_smfmac_f32_16x16x64_bf16 v[68:71], v[52:55], a[248:255], v13
    s_waitcnt lgkmcnt(8)
    s_branch L_qk_done
L_qk1:
    ds_read_b128 v[24:27], v1 offset:0
    ds_read_b128 v[28:31], v1 offset:1024
    v_smfmac_f32_16x16x64_bf16 v[56:59], v[104:107], a[16:23], v13
    ds_read_b128 v[40:43], v1 offset:4096
    v_smfmac_f32_16x16x64_bf16 v[60:63], v[104:107], a[80:87], v13
    ds_read_b128 v[44:47], v1 offset:5120
    v_smfmac_f32_16x16x64_bf16 v[64:67], v[104:107], a[144:151], v13
    ds_read_b128 v[48:51], v1 offset:6144
    v_smfmac_f32_16x16x64_bf16 v[68:71], v[104:107], a[208:215], v13
    ds_read_b128 v[52:55], v1 offset:7168
    v_smfmac_f32_16x16x64_bf16 v[56:59], v[108:111], a[24:31], v13
    ds_read_b128 v[32:35], v1 offset:2048
    v_smfmac_f32_16x16x64_bf16 v[60:63], v[108:111], a[88:95], v13
    ds_read_b128 v[36:39], v1 offset:3072
    v_smfmac_f32_16x16x64_bf16 v[64:67], v[108:111], a[152:159], v13
    buffer_load_dwordx4 v[112:115], v2, s[8:11], s41 offen offset:0 sc1
    v_smfmac_f32_16x16x64_bf16 v[68:71], v[108:111], a[216:223], v13
    s_waitcnt lgkmcnt(6)
    v_smfmac_f32_16x16x64_bf16 v[56:59], v[24:27], a[0:7], v13
    buffer_load_dwordx4 v[116:119], v2, s[8:11], s41 offen offset:1024 sc1
    v_smfmac_f32_16x16x64_bf16 v[60:63], v[24:27], a[64:71], v13
    s_waitcnt vmcnt(2)
    ds_read_b128 v[80:83], v5 offset:0
    v_smfmac_f32_16x16x64_bf16 v[64:67], v[24:27], a[128:135], v13
    buffer_load_dwordx4 v2, s[8:11], s40 offen offset:0 sc1 lds
    v_smfmac_f32_16x16x64_bf16 v[68:71], v[24:27], a[192:199], v13
    ds_read_b128 v[84:87], v5 offset:1024
    v_smfmac_f32_16x16x64_bf16 v[56:59], v[28:31], a[8:15], v13
    buffer_load_dwordx4 v2, s[8:11], s40 offen offset:1024 sc1 lds
    v_smfmac_f32_16x16x64_bf16 v[60:63], v[28:31], a[72:79], v13
    ds_read_b128 v[88:91], v5 offset:2048
    v_smfmac_f32_16x16x64_bf16 v[64:67], v[28:31], a[136:143], v13
    ds_read_b128 v[92:95], v5 offset:3072
    v_smfmac_f32_16x16x64_bf16 v[68:71], v[28:31], a[200:207], v13
    s_waitcnt lgkmcnt(6)
    v_smfmac_f32_16x16x64_bf16 v[56:59], v[40:43], a[32:39], v13
    ds_read_b128 v[96:99], v5 offset:4096
    v_smfmac_f32_16x16x64_bf16 v[60:63], v[40:43], a[96:103], v13
    ds_read_b128 v[100:103], v5 offset:5120
    v_smfmac_f32_16x16x64_bf16 v[64:67], v[40:43], a[160:167], v13
    ds_read_b128 v[104:107], v5 offset:6144
    v_smfmac_f32_16x16x64_bf16 v[68:71], v[40:43], a[224:231], v13
    ds_read_b128 v[108:111], v5 offset:7168
    v_smfmac_f32_16x16x64_bf16 v[56:59], v[44:47], a[40:47], v13
    v_mov_b32 v22, s26
    v_smfmac_f32_16x16x64_bf16 v[60:63], v[44:47], a[104:111], v13
    v_mov_b32 v0, v1
    v_smfmac_f32_16x16x64_bf16 v[64:67], v[44:47], a[168:175], v13
    v_mov_b32 v0, v1
    v_smfmac_f32_16x16x64_bf16 v[68:71], v[44:47], a[232:239], v13
    v_mov_b32 v0, v1
    v_smfmac_f32_16x16x64_bf16 v[56:59], v[48:51], a[48:55], v13
    v_mov_b32 v0, v1
    v_smfmac_f32_16x16x64_bf16 v[60:63], v[48:51], a[112:119], v13
    v_mov_b32 v0, v1
    v_smfmac_f32_16x16x64_bf16 v[64:67], v[48:51], a[176:183], v13
    v_mov_b32 v0, v1
    v_smfmac_f32_16x16x64_bf16 v[68:71], v[48:51], a[240:247], v13
    v_mov_b32 v0, v1
    v_smfmac_f32_16x16x64_bf16 v[56:59], v[52:55], a[56:63], v13
    v_mov_b32 v0, v1
    v_smfmac_f32_16x16x64_bf16 v[60:63], v[52:55], a[120:127], v13
    v_mov_b32 v0, v1
    v_smfmac_f32_16x16x64_bf16 v[64:67], v[52:55], a[184:191], v13
    v_mov_b32 v0, v1
    v_smfmac_f32_16x16x64_bf16 v[68:71], v[52:55], a[248:255], v13
    s_waitcnt lgkmcnt(8)
    s_branch L_qk_done
L_qk2:
    ds_read_b128 v[24:27], v1 offset:0
    ds_read_b128 v[28:31], v1 offset:1024
    v_smfmac_f32_16x16x64_bf16 v[56:59], v[104:107], a[32:39], v13
    ds_read_b128 v[32:35], v1 offset:2048
    v_smfmac_f32_16x16x64_bf16 v[60:63], v[104:107], a[96:103], v13
    ds_read_b128 v[36:39], v1 offset:3072
    v_smfmac_f32_16x16x64_bf16 v[64:67], v[104:107], a[160:167], v13
    ds_read_b128 v[48:51], v1 offset:6144
    v_smfmac_f32_16x16x64_bf16 v[68:71], v[104:107], a[224:231], v13
    ds_read_b128 v[52:55], v1 offset:7168
    v_smfmac_f32_16x16x64_bf16 v[56:59], v[108:111], a[40:47], v13
    ds_read_b128 v[40:43], v1 offset:4096
    v_smfmac_f32_16x16x64_bf16 v[60:63], v[108:111], a[104:111], v13
    ds_read_b128 v[44:47], v1 offset:5120
    v_smfmac_f32_16x16x64_bf16 v[64:67], v[108:111], a[168:175], v13
    buffer_load_dwordx4 v[112:115], v2, s[8:11], s41 offen offset:0 sc1
    v_smfmac_f32_16x16x64_bf16 v[68:71], v[108:111], a[232:239], v13
    s_waitcnt lgkmcnt(6)
    v_smfmac_f32_16x16x64_bf16 v[56:59], v[24:27], a[0:7], v13
    buffer_load_dwordx4 v[116:119], v2, s[8:11], s41 offen offset:1024 sc1
    v_smfmac_f32_16x16x64_bf16 v[60:63], v[24:27], a[64:71], v13
    s_waitcnt vmcnt(2)
    ds_read_b128 v[80:83], v5 offset:0
    v_smfmac_f32_16x16x64_bf16 v[64:67], v[24:27], a[128:135], v13
    buffer_load_dwordx4 v2, s[8:11], s40 offen offset:0 sc1 lds
    v_smfmac_f32_16x16x64_bf16 v[68:71], v[24:27], a[192:199], v13
    ds_read_b128 v[84:87], v5 offset:1024
    v_smfmac_f32_16x16x64_bf16 v[56:59], v[28:31], a[8:15], v13
    buffer_load_dwordx4 v2, s[8:11], s40 offen offset:1024 sc1 lds
    v_smfmac_f32_16x16x64_bf16 v[60:63], v[28:31], a[72:79], v13
    ds_read_b128 v[88:91], v5 offset:2048
    v_smfmac_f32_16x16x64_bf16 v[64:67], v[28:31], a[136:143], v13
    ds_read_b128 v[92:95], v5 offset:3072
    v_smfmac_f32_16x16x64_bf16 v[68:71], v[28:31], a[200:207], v13
    s_waitcnt lgkmcnt(6)
    v_smfmac_f32_16x16x64_bf16 v[56:59], v[32:35], a[16:23], v13
    ds_read_b128 v[96:99], v5 offset:4096
    v_smfmac_f32_16x16x64_bf16 v[60:63], v[32:35], a[80:87], v13
    ds_read_b128 v[100:103], v5 offset:5120
    v_smfmac_f32_16x16x64_bf16 v[64:67], v[32:35], a[144:151], v13
    ds_read_b128 v[104:107], v5 offset:6144
    v_smfmac_f32_16x16x64_bf16 v[68:71], v[32:35], a[208:215], v13
    ds_read_b128 v[108:111], v5 offset:7168
    v_smfmac_f32_16x16x64_bf16 v[56:59], v[36:39], a[24:31], v13
    v_mov_b32 v22, s26
    v_smfmac_f32_16x16x64_bf16 v[60:63], v[36:39], a[88:95], v13
    buffer_store_dword v22, v15, s[8:11], s64 offen sc1
    v_smfmac_f32_16x16x64_bf16 v[64:67], v[36:39], a[152:159], v13
    v_mov_b32 v0, v1
    v_smfmac_f32_16x16x64_bf16 v[68:71], v[36:39], a[216:223], v13
    v_mov_b32 v0, v1
    v_smfmac_f32_16x16x64_bf16 v[56:59], v[48:51], a[48:55], v13
    v_mov_b32 v0, v1
    v_smfmac_f32_16x16x64_bf16 v[60:63], v[48:51], a[112:119], v13
    v_mov_b32 v0, v1
    v_smfmac_f32_16x16x64_bf16 v[64:67], v[48:51], a[176:183], v13
    v_mov_b32 v0, v1
    v_smfmac_f32_16x16x64_bf16 v[68:71], v[48:51], a[240:247], v13
    v_mov_b32 v0, v1
    v_smfmac_f32_16x16x64_bf16 v[56:59], v[52:55], a[56:63], v13
    v_mov_b32 v0, v1
    v_smfmac_f32_16x16x64_bf16 v[60:63], v[52:55], a[120:127], v13
    v_mov_b32 v0, v1
    v_smfmac_f32_16x16x64_bf16 v[64:67], v[52:55], a[184:191], v13
    v_mov_b32 v0, v1
    v_smfmac_f32_16x16x64_bf16 v[68:71], v[52:55], a[248:255], v13
    s_waitcnt lgkmcnt(8)
    s_branch L_qk_done
L_qk3:
    ds_read_b128 v[24:27], v1 offset:0
    ds_read_b128 v[28:31], v1 offset:1024
    v_smfmac_f32_16x16x64_bf16 v[56:59], v[104:107], a[48:55], v13
    ds_read_b128 v[32:35], v1 offset:2048
    v_smfmac_f32_16x16x64_bf16 v[60:63], v[104:107], a[112:119], v13
    ds_read_b128 v[36:39], v1 offset:3072
    v_smfmac_f32_16x16x64_bf16 v[64:67], v[104:107], a[176:183], v13
    ds_read_b128 v[40:43], v1 offset:4096
    v_smfmac_f32_16x16x64_bf16 v[68:71], v[104:107], a[240:247], v13
    ds_read_b128 v[44:47], v1 offset:5120
    v_smfmac_f32_16x16x64_bf16 v[56:59], v[108:111], a[56:63], v13
    ds_read_b128 v[48:51], v1 offset:6144
    v_smfmac_f32_16x16x64_bf16 v[60:63], v[108:111], a[120:127], v13
    ds_read_b128 v[52:55], v1 offset:7168
    v_smfmac_f32_16x16x64_bf16 v[64:67], v[108:111], a[184:191], v13
    buffer_load_dwordx4 v[112:115], v2, s[8:11], s41 offen offset:0 sc1
    v_smfmac_f32_16x16x64_bf16 v[68:71], v[108:111], a[248:255], v13
    s_waitcnt lgkmcnt(6)
    v_smfmac_f32_16x16x64_bf16 v[56:59], v[24:27], a[0:7], v13
    buffer_load_dwordx4 v[116:119], v2, s[8:11], s41 offen offset:1024 sc1
    v_smfmac_f32_16x16x64_bf16 v[60:63], v[24:27], a[64:71], v13
    s_waitcnt vmcnt(2)
    ds_read_b128 v[80:83], v5 offset:0
    v_smfmac_f32_16x16x64_bf16 v[64:67], v[24:27], a[128:135], v13
    buffer_load_dwordx4 v2, s[8:11], s40 offen offset:0 sc1 lds
    v_smfmac_f32_16x16x64_bf16 v[68:71], v[24:27], a[192:199], v13
    ds_read_b128 v[84:87], v5 offset:1024
    v_smfmac_f32_16x16x64_bf16 v[56:59], v[28:31], a[8:15], v13
    buffer_load_dwordx4 v2, s[8:11], s40 offen offset:1024 sc1 lds
    v_smfmac_f32_16x16x64_bf16 v[60:63], v[28:31], a[72:79], v13
    ds_read_b128 v[88:91], v5 offset:2048
    v_smfmac_f32_16x16x64_bf16 v[64:67], v[28:31], a[136:143], v13
    ds_read_b128 v[92:95], v5 offset:3072
    v_smfmac_f32_16x16x64_bf16 v[68:71], v[28:31], a[200:207], v13
    s_waitcnt lgkmcnt(6)
    v_smfmac_f32_16x16x64_bf16 v[56:59], v[32:35], a[16:23], v13
    ds_read_b128 v[96:99], v5 offset:4096
    v_smfmac_f32_16x16x64_bf16 v[60:63], v[32:35], a[80:87], v13
    ds_read_b128 v[100:103], v5 offset:5120
    v_smfmac_f32_16x16x64_bf16 v[64:67], v[32:35], a[144:151], v13
    ds_read_b128 v[104:107], v5 offset:6144
    v_smfmac_f32_16x16x64_bf16 v[68:71], v[32:35], a[208:215], v13
    ds_read_b128 v[108:111], v5 offset:7168
    v_smfmac_f32_16x16x64_bf16 v[56:59], v[36:39], a[24:31], v13
    v_mov_b32 v22, s26
    v_smfmac_f32_16x16x64_bf16 v[60:63], v[36:39], a[88:95], v13
    v_mov_b32 v0, v1
    v_smfmac_f32_16x16x64_bf16 v[64:67], v[36:39], a[152:159], v13
    v_mov_b32 v0, v1
    v_smfmac_f32_16x16x64_bf16 v[68:71], v[36:39], a[216:223], v13
    v_mov_b32 v0, v1
    v_smfmac_f32_16x16x64_bf16 v[56:59], v[40:43], a[32:39], v13
    v_mov_b32 v0, v1
    v_smfmac_f32_16x16x64_bf16 v[60:63], v[40:43], a[96:103], v13
    v_mov_b32 v0, v1
    v_smfmac_f32_16x16x64_bf16 v[64:67], v[40:43], a[160:167], v13
    v_mov_b32 v0, v1
    v_smfmac_f32_16x16x64_bf16 v[68:71], v[40:43], a[224:231], v13
    v_mov_b32 v0, v1
    v_smfmac_f32_16x16x64_bf16 v[56:59], v[44:47], a[40:47], v13
    v_mov_b32 v0, v1
    v_smfmac_f32_16x16x64_bf16 v[60:63], v[44:47], a[104:111], v13
    v_mov_b32 v0, v1
    v_smfmac_f32_16x16x64_bf16 v[64:67], v[44:47], a[168:175], v13
    v_mov_b32 v0, v1
    v_smfmac_f32_16x16x64_bf16 v[68:71], v[44:47], a[232:239], v13
    v_mov_b32 v0, v1
    s_waitcnt lgkmcnt(8)
L_qk_done:
    v_smfmac_f32_16x16x64_bf16 v[72:75], v[24:27], v[128:135], v13
    v_pk_add_f32 v[20:21], v[56:57], v[58:59]
    v_pk_add_f32 v[22:23], v[60:61], v[62:63]
    v_pk_mul_f32 v[20:21], v[20:21], s[48:49]
    v_pk_mul_f32 v[22:23], v[22:23], s[48:49]
    v_pk_add_f32 v[56:57], v[64:65], v[66:67]
    v_pk_add_f32 v[58:59], v[68:69], v[70:71]
    v_cvt_pk_bf16_f32 v18, v20, v21
    v_cvt_pk_bf16_f32 v16, v56, v57
    v_cvt_pk_bf16_f32 v19, v22, v23
    ds_write2_b32 v3, v16, v18 offset0:0 offset1:1
    v_cvt_pk_bf16_f32 v17, v58, v59
    ds_write2_b32 v3, v17, v19 offset0:128 offset1:129
    v_smfmac_f32_16x16x64_bf16 v[76:79], v[24:27], v[192:199], v13
    v_mov_b32 v0, v1
    v_smfmac_f32_16x16x64_bf16 v[72:75], v[28:31], v[136:143], v13
    v_mov_b32 v0, v1
    v_smfmac_f32_16x16x64_bf16 v[76:79], v[28:31], v[200:207], v13
    v_mov_b32 v0, v1
    v_smfmac_f32_16x16x64_bf16 v[72:75], v[32:35], v[144:151], v13
    v_mov_b32 v0, v1
    v_smfmac_f32_16x16x64_bf16 v[76:79], v[32:35], v[208:215], v13
    v_mov_b32 v0, v1
    s_waitcnt lgkmcnt(0)
    s_barrier
    ds_read_b64_tr_b16 v[24:25], v4 offset:0
    ds_read_b64_tr_b16 v[26:27], v4 offset:512
    ds_read_b64_tr_b16 v[28:29], v4 offset:1024
    ds_read_b64_tr_b16 v[30:31], v4 offset:1536
    ds_read_b64_tr_b16 v[32:33], v4 offset:2048
    ds_read_b64_tr_b16 v[34:35], v4 offset:2560
    ds_read_b64_tr_b16 v[120:121], v4 offset:3072
    ds_read_b64_tr_b16 v[122:123], v4 offset:3584
    v_smfmac_f32_16x16x64_bf16 v[72:75], v[36:39], v[152:159], v13
    buffer_store_dwordx2 v[16:17], v1, s[8:11], s42 offen sc1
    v_smfmac_f32_16x16x64_bf16 v[76:79], v[36:39], v[216:223], v13
    s_waitcnt lgkmcnt(6)
    v_mfma_f32_16x16x32_bf16 v[60:63], v[80:83], v[24:27], 0
    v_mov_b32 v0, v1
    s_waitcnt lgkmcnt(4)
    v_mfma_f32_16x16x32_bf16 v[60:63], v[84:87], v[28:31], v[60:63]
    v_mov_b32 v0, v1
    s_waitcnt lgkmcnt(2)
    v_mfma_f32_16x16x32_bf16 v[60:63], v[88:91], v[32:35], v[60:63]
    v_mov_b32 v0, v1
    s_waitcnt lgkmcnt(0)
    v_mfma_f32_16x16x32_bf16 v[60:63], v[92:95], v[120:123], v[60:63]
    v_mov_b32 v0, v1
    v_mfma_f32_16x16x32_bf16 v[64:67], v[96:99], v[24:27], 0
    ds_read_b128 v[80:83], v7 offset:0
    ds_read_b128 v[84:87], v7 offset:1024
    v_mfma_f32_16x16x32_bf16 v[64:67], v[100:103], v[28:31], v[64:67]
    ds_read_b128 v[88:91], v7 offset:2048
    ds_read_b128 v[92:95], v7 offset:3072
    v_mfma_f32_16x16x32_bf16 v[64:67], v[104:107], v[32:35], v[64:67]
    v_exp_f32 v60, v60
    v_mfma_f32_16x16x32_bf16 v[64:67], v[108:111], v[120:123], v[64:67]
    v_exp_f32 v61, v61
    v_mfma_f32_16x16x32_bf16 v[56:59], v[24:27], v[24:27], 0
    v_exp_f32 v62, v62
    ds_read_b128 v[96:99], v8 offset:0
    v_mfma_f32_16x16x32_bf16 v[56:59], v[28:31], v[28:31], v[56:59]
    v_exp_f32 v63, v63
    ds_read_b128 v[100:103], v8 offset:1024
    v_mfma_f32_16x16x32_bf16 v[56:59], v[32:35], v[32:35], v[56:59]
    v_exp_f32 v64, v64
    ds_read_b128 v[104:107], v8 offset:2048
    v_mfma_f32_16x16x32_bf16 v[56:59], v[120:123], v[120:123], v[56:59]
    v_exp_f32 v65, v65
    ds_read_b128 v[108:111], v8 offset:3072
    v_smfmac_f32_16x16x64_bf16 v[72:75], v[40:43], v[160:167], v13
    v_cvt_pk_bf16_f32 v20, v60, v61
    ds_read_b128 v[24:27], v7 offset:4096
    v_smfmac_f32_16x16x64_bf16 v[76:79], v[40:43], v[224:231], v13
    v_exp_f32 v66, v66
    v_smfmac_f32_16x16x64_bf16 v[72:75], v[44:47], v[168:175], v13
    v_exp_f32 v67, v67
    v_smfmac_f32_16x16x64_bf16 v[76:79], v[44:47], v[232:239], v13
    v_cvt_pk_bf16_f32 v21, v62, v63
    ds_read_b128 v[28:31], v7 offset:5120
    v_smfmac_f32_16x16x64_bf16 v[72:75], v[48:51], v[176:183], v13
    v_exp_f32 v56, v56
    v_smfmac_f32_16x16x64_bf16 v[76:79], v[48:51], v[240:247], v13
    v_exp_f32 v57, v57
    v_smfmac_f32_16x16x64_bf16 v[72:75], v[52:55], v[184:191], v13
    v_cvt_pk_bf16_f32 v22, v64, v65
    ds_read_b128 v[32:35], v7 offset:6144
    v_smfmac_f32_16x16x64_bf16 v[76:79], v[52:55], v[248:255], v13
    v_cvt_pk_bf16_f32 v23, v66, v67
    ds_read_b128 v[36:39], v7 offset:7168
    s_waitcnt vmcnt(3)
    v_cvt_pk_bf16_f32 v124, v56, v57
    v_mfma_f32_16x16x32_bf16 v[40:43], v[112:115], v[20:23], 0
    v_pk_add_f32 v[120:121], v[60:61], v[62:63]
    v_pk_add_f32 v[122:123], v[64:65], v[66:67]
    v_mfma_f32_16x16x32_bf16 v[44:47], v[116:119], v[20:23], 0
    v_pk_add_f32 v[72:73], v[72:73], v[74:75]
    v_pk_add_f32 v[76:77], v[76:77], v[78:79]
    v_cvt_pk_bf16_f32 v126, v72, v73
    v_cvt_pk_bf16_f32 v14, v76, v77
    v_pk_add_f32 v[120:121], v[120:121], v[56:57]
    v_pk_add_f32 v[120:121], v[120:121], v[122:123]
    v_mfma_f32_16x16x16_bf16 v[40:43], v[126:127], v[124:125], v[40:43]
    v_add_f32 v122, v120, v121
    v_add_f32 v123, v120, v121
    v_mfma_f32_16x16x16_bf16 v[44:47], v[14:15], v[124:125], v[44:47]
    ds_read_b128 v[48:51], v8 offset:4096
    v_permlane32_swap_b32 v122, v123
    v_add_f32 v120, v122, v123
    v_add_f32 v121, v122, v123
    ds_read_b128 v[52:55], v8 offset:5120
    v_cvt_pk_bf16_f32 v18, v72, v73
    v_permlane16_swap_b32 v120, v121
    v_add_f32 v122, v120, v121
    v_rcp_f32 v120, v122
    v_lshrrev_b32 v123, 23, v122
    v_subrev_u32 v123, 27, v123
    v_cmp_lt_u32 vcc, 200, v123
L_sm_back:
    v_pk_mul_f32 v[40:41], v[40:41], v[120:121] op_sel_hi:[1,0]
    v_pk_mul_f32 v[42:43], v[42:43], v[120:121] op_sel_hi:[1,0]
    v_pk_mul_f32 v[44:45], v[44:45], v[120:121] op_sel_hi:[1,0]
    v_pk_mul_f32 v[46:47], v[46:47], v[120:121] op_sel_hi:[1,0]
    v_cvt_pk_bf16_f32 v19, v76, v77
    s_and_b64 vcc, vcc, s[52:53]
    v_cvt_pk_bf16_f32 v20, v40, v41
    v_cvt_pk_bf16_f32 v21, v42, v43
    v_cvt_pk_bf16_f32 v22, v44, v45
    v_cvt_pk_bf16_f32 v23, v46, v47
    s_cbranch_scc1 L_sm_slow
    s_mov_b64 exec, s[52:53]
    ds_write_b128 v6, v[20:23]
    s_mov_b64 exec, -1
    buffer_store_dwordx2 v[18:19], v1, s[8:11], s42 offen offset:8 sc1
    s_cmp_eq_u32 s26, 63
    s_cbranch_scc1 L_rec_done
    v_mov_b64 v[56:57], 0
    v_mov_b64 v[58:59], 0
    v_mov_b64 v[60:61], 0
    v_mov_b64 v[62:63], 0
    v_mov_b64 v[64:65], 0
    v_mov_b64 v[66:67], 0
    v_mov_b64 v[68:69], 0
    v_mov_b64 v[70:71], 0
    s_waitcnt lgkmcnt(0)
    s_barrier
    ds_read_b128 v[112:115], v1 offset:12288
    ds_read_b128 v[116:119], v1 offset:13312
    ds_read_b128 v[16:19], v8 offset:6144
    ds_read_b128 v[20:23], v8 offset:7168
    v_mov_b64 v[72:73], 0
    v_mov_b64 v[74:75], 0
    v_mov_b64 v[76:77], 0
    v_mov_b64 v[78:79], 0
    v_mov_b64 v[40:41], 0
    v_mov_b64 v[42:43], 0
    v_mov_b64 v[44:45], 0
    v_mov_b64 v[46:47], 0
    s_waitcnt lgkmcnt(3)
    v_smfmac_f32_16x16x64_bf16 v[56:59], v[112:115], v[80:87], v13
    ds_read_b128 v[80:83], v7 offset:8192
    ds_read_b128 v[84:87], v7 offset:9216
    v_smfmac_f32_16x16x64_bf16 v[60:63], v[112:115], v[88:95], v13
    ds_read_b128 v[88:91], v7 offset:10240
    ds_read_b128 v[92:95], v7 offset:11264
    s_waitcnt lgkmcnt(6)
    v_smfmac_f32_16x16x64_bf16 v[56:59], v[116:119], v[96:103], v13
    ds_read_b128 v[96:99], v8 offset:8192
    ds_read_b128 v[100:103], v8 offset:9216
    v_smfmac_f32_16x16x64_bf16 v[60:63], v[116:119], v[104:111], v13
    ds_read_b128 v[104:107], v8 offset:10240
    ds_read_b128 v[108:111], v8 offset:11264
    v_smfmac_f32_16x16x64_bf16 v[64:67], v[112:115], v[24:31], v13
    ds_read_b128 v[24:27], v7 offset:12288
    v_smfmac_f32_16x16x64_bf16 v[68:71], v[112:115], v[32:39], v13
    ds_read_b128 v[28:31], v7 offset:13312
    s_waitcnt lgkmcnt(10)
    v_smfmac_f32_16x16x64_bf16 v[64:67], v[116:119], v[48:55], v13
    ds_read_b128 v[32:35], v7 offset:14336
    v_smfmac_f32_16x16x64_bf16 v[68:71], v[116:119], v[16:23], v13
    ds_read_b128 v[36:39], v7 offset:15360
    s_waitcnt lgkmcnt(8)
    v_smfmac_f32_16x16x64_bf16 v[72:75], v[112:115], v[80:87], v13
    ds_read_b128 v[48:51], v8 offset:12288
    v_smfmac_f32_16x16x64_bf16 v[76:79], v[112:115], v[88:95], v13
    ds_read_b128 v[52:55], v8 offset:13312
    s_waitcnt lgkmcnt(6)
    v_smfmac_f32_16x16x64_bf16 v[72:75], v[116:119], v[96:103], v13
    ds_read_b128 v[16:19], v8 offset:14336
    v_smfmac_f32_16x16x64_bf16 v[76:79], v[116:119], v[104:111], v13
    ds_read_b128 v[20:23], v8 offset:15360
    s_waitcnt lgkmcnt(4)
    v_smfmac_f32_16x16x64_bf16 v[40:43], v[112:115], v[24:31], v13
    v_pk_add_f32 v[56:57], v[56:57], v[58:59]
    v_cvt_pk_bf16_f32 v56, v56, v57
    v_smfmac_f32_16x16x64_bf16 v[44:47], v[112:115], v[32:39], v13
    v_and_or_b32 v56, v56, -2, s27
    v_pk_add_f32 v[60:61], v[60:61], v[62:63]
    s_waitcnt lgkmcnt(0)
    v_smfmac_f32_16x16x64_bf16 v[40:43], v[116:119], v[48:55], v13
    v_cvt_pk_bf16_f32 v57, v60, v61
    v_pk_add_f32 v[64:65], v[64:65], v[66:67]
    v_smfmac_f32_16x16x64_bf16 v[44:47], v[116:119], v[16:23], v13
    v_cvt_pk_bf16_f32 v58, v64, v65
    v_pk_add_f32 v[68:69], v[68:69], v[70:71]
    v_cvt_pk_bf16_f32 v59, v68, v69
    buffer_store_dwordx4 v[56:59], v9, s[8:11], s32 offen
    v_pk_add_f32 v[72:73], v[72:73], v[74:75]
    v_cvt_pk_bf16_f32 v72, v72, v73
    v_and_or_b32 v72, v72, -2, s27
    v_pk_add_f32 v[76:77], v[76:77], v[78:79]
    v_cvt_pk_bf16_f32 v73, v76, v77
    v_pk_add_f32 v[40:41], v[40:41], v[42:43]
    v_cvt_pk_bf16_f32 v74, v40, v41
    v_pk_add_f32 v[44:45], v[44:45], v[46:47]
    v_cvt_pk_bf16_f32 v75, v44, v45
    buffer_store_dwordx4 v[72:75], v9, s[8:11], s33 offen
    ds_read_b128 v[80:83], v1 offset:15360
    v_xor_b32 v5, 8192, v5
    s_xor_b32 s44, s44, 8192
    s_add_u32 s41, s41, 0x40000
    s_add_u32 s42, s42, 0x20000
    s_add_u32 s26, s26, 1
    s_cmp_lt_u32 s26, 62
    s_cselect_b32 s31, 0x40000, 0
    s_add_u32 s40, s40, s31
    v_mov_b64 v[56:57], 0
    v_mov_b64 v[58:59], 0
    v_mov_b64 v[60:61], 0
    v_mov_b64 v[62:63], 0
    v_mov_b64 v[64:65], 0
    v_mov_b64 v[66:67], 0
    v_mov_b64 v[68:69], 0
    v_mov_b64 v[70:71], 0
    v_mov_b64 v[72:73], 0
    v_mov_b64 v[74:75], 0
    v_mov_b64 v[76:77], 0
    v_mov_b64 v[78:79], 0
    s_mov_b32 m0, s44
    s_cmp_ge_u32 s25, 2
    s_cbranch_scc1 L_side
    v_mov_b32 v21, -1
    s_mov_b64 exec, s[54:55]
    buffer_store_dword v21, v11, s[8:11], s30 offen
    s_mov_b64 exec, -1
    v_mov_b32 v0, v1
    v_mov_b32 v0, v1
    v_mov_b32 v0, v1
    v_mov_b32 v0, v1
    v_mov_b32 v0, v1
    v_mov_b32 v0, v1
    v_mov_b32 v0, v1
    v_mov_b32 v0, v1
    v_mov_b32 v0, v1
    v_mov_b32 v0, v1
    v_mov_b32 v0, v1
    v_mov_b32 v0, v1
    v_mov_b32 v0, v1
    v_mov_b32 v0, v1
    v_mov_b32 v0, v1
    v_mov_b32 v0, v1
    v_mov_b32 v0, v1
    v_mov_b32 v0, v1
    v_mov_b32 v0, v1
    v_mov_b32 v0, v1
    v_mov_b32 v0, v1
    v_mov_b32 v0, v1
    v_mov_b32 v0, v1
    v_mov_b32 v0, v1
    v_mov_b32 v0, v1
    v_mov_b32 v0, v1
    v_mov_b32 v0, v1
    v_mov_b32 v0, v1
    v_mov_b32 v0, v1
    v_mov_b32 v0, v1
    v_mov_b32 v0, v1
    v_mov_b32 v0, v1
    v_mov_b32 v0, v1
    v_mov_b32 v0, v1
    v_mov_b32 v0, v1
    v_mov_b32 v0, v1
    v_mov_b32 v0, v1
    v_mov_b32 v0, v1
    v_mov_b32 v0, v1
    v_mov_b32 v0, v1
    buffer_load_dwordx4 v[24:27], v10, s[8:11], s34 offen offset:0 sc1
    buffer_load_dwordx4 v[28:31], v10, s[8:11], s34 offen offset:2048 sc1
    buffer_load_dwordx4 v[32:35], v10, s[8:11], s35 offen offset:0 sc1
    buffer_load_dwordx4 v[36:39], v10, s[8:11], s35 offen offset:2048 sc1
    v_mov_b32 v0, v1
    v_mov_b32 v0, v1
    v_mov_b32 v0, v1
    v_mov_b32 v0, v1
    v_mov_b32 v0, v1
    v_mov_b32 v0, v1
    v_mov_b32 v0, v1
    v_mov_b32 v0, v1
    v_mov_b32 v0, v1
    v_mov_b32 v0, v1
    v_mov_b32 v0, v1
    v_mov_b32 v0, v1
    v_mov_b32 v0, v1
    v_mov_b32 v0, v1
    v_mov_b32 v0, v1
    v_mov_b32 v0, v1
    v_mov_b32 v0, v1
    v_mov_b32 v0, v1
    v_mov_b32 v0, v1
    v_mov_b32 v0, v1
    v_mov_b32 v0, v1
    v_mov_b32 v0, v1
    v_mov_b32 v0, v1
    v_mov_b32 v0, v1
    v_mov_b32 v0, v1
    v_mov_b32 v0, v1
    v_mov_b32 v0, v1
    v_mov_b32 v0, v1
    v_mov_b32 v0, v1
    v_mov_b32 v0, v1
L_poll1:
    buffer_load_dwordx4 v[40:43], v10, s[8:11], s34 offen offset:0 sc1
    buffer_load_dwordx4 v[44:47], v10, s[8:11], s34 offen offset:2048 sc1
    buffer_load_dwordx4 v[48:51], v10, s[8:11], s35 offen offset:0 sc1
    buffer_load_dwordx4 v[52:55], v10, s[8:11], s35 offen offset:2048 sc1
    v_mov_b32 v0, v1
    v_mov_b32 v0, v1
    v_mov_b32 v0, v1
    v_mov_b32 v0, v1
    v_mov_b32 v0, v1
    v_mov_b32 v0, v1
    v_mov_b32 v0, v1
    v_mov_b32 v0, v1
    s_waitcnt vmcnt(7) lgkmcnt(0)
    v_mfma_f32_16x16x32_bf16 v[88:91], v[80:83], v[24:27], 0
    s_waitcnt vmcnt(6)
    v_mfma_f32_16x16x32_bf16 v[88:91], v[80:83], v[28:31], v[88:91]
    v_bitop3_b32 v16, v24, v28, s27 bitop3:0x7e
    s_waitcnt vmcnt(5)
    v_mfma_f32_16x16x32_bf16 v[88:91], v[80:83], v[32:35], v[88:91]
    s_waitcnt vmcnt(4)
    v_mfma_f32_16x16x32_bf16 v[88:91], v[80:83], v[36:39], v[88:91]
    v_bitop3_b32 v17, v32, v36, s27 bitop3:0x7e
    v_or_b32 v16, v16, v17
    v_and_b32 v16, 1, v16
    v_cmp_ne_u32 vcc, 0, v16
    v_mov_b32 v0, v1
    v_mov_b32 v0, v1
    v_mov_b32 v0, v1
    v_mov_b32 v0, v1
    s_cbranch_vccz L_poll1_ok
    buffer_load_dwordx4 v[24:27], v10, s[8:11], s34 offen offset:0 sc1
    buffer_load_dwordx4 v[28:31], v10, s[8:11], s34 offen offset:2048 sc1
    buffer_load_dwordx4 v[32:35], v10, s[8:11], s35 offen offset:0 sc1
    buffer_load_dwordx4 v[36:39], v10, s[8:11], s35 offen offset:2048 sc1
    v_mov_b32 v0, v1
    v_mov_b32 v0, v1
    v_mov_b32 v0, v1
    v_mov_b32 v0, v1
    v_mov_b32 v0, v1
    v_mov_b32 v0, v1
    v_mov_b32 v0, v1
    v_mov_b32 v0, v1
    s_waitcnt vmcnt(7) lgkmcnt(0)
    v_mfma_f32_16x16x32_bf16 v[88:91], v[80:83], v[40:43], 0
    s_waitcnt vmcnt(6)
    v_mfma_f32_16x16x32_bf16 v[88:91], v[80:83], v[44:47], v[88:91]
    v_bitop3_b32 v16, v40, v44, s27 bitop3:0x7e
    s_waitcnt vmcnt(5)
    v_mfma_f32_16x16x32_bf16 v[88:91], v[80:83], v[48:51], v[88:91]
    s_waitcnt vmcnt(4)
    v_mfma_f32_16x16x32_bf16 v[88:91], v[80:83], v[52:55], v[88:91]
    v_bitop3_b32 v17, v48, v52, s27 bitop3:0x7e
    v_or_b32 v16, v16, v17
    v_and_b32 v16, 1, v16
    v_cmp_ne_u32 vcc, 0, v16
    v_mov_b32 v0, v1
    v_mov_b32 v0, v1
    v_mov_b32 v0, v1
    v_mov_b32 v0, v1
    s_cbranch_vccz L_poll1_ok
    s_sub_u32 s65, s65, 1
    s_cmp_eq_u32 s65, 0
    s_cbranch_scc0 L_poll1
    s_mov_b32 s31, 3
    s_branch L_abort
L_poll1_ok:
    v_add_f32_dpp v92, v88, v88 row_ror:8 row_mask:0xf bank_mask:0xf
    v_add_f32_dpp v93, v89, v89 row_ror:8 row_mask:0xf bank_mask:0xf
    v_add_f32_dpp v94, v90, v90 row_ror:8 row_mask:0xf bank_mask:0xf
    v_add_f32_dpp v95, v91, v91 row_ror:8 row_mask:0xf bank_mask:0xf
    v_cndmask_b32 v88, v92, v93, s[6:7]
    v_cndmask_b32 v90, v94, v95, s[6:7]
    v_cvt_pk_bf16_f32 v92, v88, v90
    s_mov_b64 exec, s[54:55]
    v_min_u32 v92, -2, v92
    buffer_store_dword v92, v11, s[8:11], s29 offen
    s_mov_b64 exec, -1
    v_mov_b32 v0, v1
    v_mov_b32 v0, v1
    v_mov_b32 v0, v1
    v_mov_b32 v0, v1
    v_mov_b32 v0, v1
    v_mov_b32 v0, v1
    v_mov_b32 v0, v1
    v_mov_b32 v0, v1
    v_mov_b32 v0, v1
    v_mov_b32 v0, v1
    v_mov_b32 v0, v1
    v_mov_b32 v0, v1
    v_mov_b32 v0, v1
    v_mov_b32 v0, v1
    v_mov_b32 v0, v1
    v_mov_b32 v0, v1
    v_mov_b32 v0, v1
    v_mov_b32 v0, v1
    v_mov_b32 v0, v1
    v_mov_b32 v0, v1
    s_branch L_join
L_side:
    s_waitcnt vmcnt(0) lgkmcnt(0)
    v_bfe_u32 v23, v1, 4, 4
    v_lshlrev_b32 v23, 2, v23
    s_add_u32 s45, s26, 1
    s_min_u32 s45, s45, 60
L_kvspin:
    s_cmp_le_i32 s45, s67
    s_cbranch_scc1 L_kv_ok
    buffer_load_dword v12, v23, s[8:11], s66 offen sc1
    s_waitcnt vmcnt(0)
    v_bfe_u32 v22, v1, 4, 2
    v_lshl_add_u32 v12, v12, 2, v22
    s_nop 1
    v_min_u32_dpp v12, v12, v12 row_ror:8 row_mask:0xf bank_mask:0xf
    s_nop 1
    v_min_u32_dpp v12, v12, v12 row_ror:4 row_mask:0xf bank_mask:0xf
    s_nop 1
    v_min_u32_dpp v12, v12, v12 row_ror:2 row_mask:0xf bank_mask:0xf
    s_nop 1
    v_min_u32_dpp v12, v12, v12 row_ror:1 row_mask:0xf bank_mask:0xf
    s_nop 0
    v_readfirstlane_b32 s67, v12
    s_nop 3
    s_sub_i32 s67, s67, 4
    s_sub_u32 s65, s65, 1
    s_cmp_eq_u32 s65, 0
    s_cbranch_scc0 L_kvspin
    s_mov_b32 s31, 6
    s_branch L_abort
L_kv_ok:
    s_mov_b32 s31, 10
L_sidefill:
    v_mov_b32 v0, v1
    v_mov_b32 v0, v1
    v_mov_b32 v0, v1
    v_mov_b32 v0, v1
    v_mov_b32 v0, v1
    v_mov_b32 v0, v1
    v_mov_b32 v0, v1
    v_mov_b32 v0, v1
    s_sub_u32 s31, s31, 1
    s_cmp_lg_u32 s31, 0
    s_cbranch_scc1 L_sidefill
L_join:
    v_mov_b32 v0, v1
    s_mov_b32 s31, s28
    s_mov_b32 s28, s29
    v_mov_b32 v0, v1
    s_mov_b32 s29, s30
    s_mov_b32 s30, s31
    v_mov_b32 v0, v1
    s_xor_b32 s27, s27, 1
    s_branch L_step
L_sm_slow:
    s_waitcnt lgkmcnt(0)
    ds_read_b128 v[80:83], v5 offset:0
    ds_read_b128 v[84:87], v5 offset:1024
    ds_read_b128 v[88:91], v5 offset:2048
    ds_read_b128 v[92:95], v5 offset:3072
    ds_read_b128 v[96:99], v5 offset:4096
    ds_read_b128 v[100:103], v5 offset:5120
    ds_read_b128 v[104:107], v5 offset:6144
    ds_read_b128 v[108:111], v5 offset:7168
    s_waitcnt lgkmcnt(0)
    ds_read_b64_tr_b16 v[24:25], v4 offset:0
    ds_read_b64_tr_b16 v[26:27], v4 offset:512
    ds_read_b64_tr_b16 v[28:29], v4 offset:1024
    ds_read_b64_tr_b16 v[30:31], v4 offset:1536
    ds_read_b64_tr_b16 v[32:33], v4 offset:2048
    ds_read_b64_tr_b16 v[34:35], v4 offset:2560
    ds_read_b64_tr_b16 v[36:37], v4 offset:3072
    ds_read_b64_tr_b16 v[38:39], v4 offset:3584
    s_waitcnt lgkmcnt(0)
    v_mfma_f32_16x16x32_bf16 v[60:63], v[80:83], v[24:27], 0
    v_mfma_f32_16x16x32_bf16 v[60:63], v[84:87], v[28:31], v[60:63]
    v_mfma_f32_16x16x32_bf16 v[60:63], v[88:91], v[32:35], v[60:63]
    v_mfma_f32_16x16x32_bf16 v[60:63], v[92:95], v[36:39], v[60:63]
    v_mfma_f32_16x16x32_bf16 v[64:67], v[96:99], v[24:27], 0
    v_mfma_f32_16x16x32_bf16 v[64:67], v[100:103], v[28:31], v[64:67]
    v_mfma_f32_16x16x32_bf16 v[64:67], v[104:107], v[32:35], v[64:67]
    v_mfma_f32_16x16x32_bf16 v[64:67], v[108:111], v[36:39], v[64:67]
    v_mfma_f32_16x16x32_bf16 v[56:59], v[24:27], v[24:27], 0
    v_mfma_f32_16x16x32_bf16 v[56:59], v[28:31], v[28:31], v[56:59]
    v_mfma_f32_16x16x32_bf16 v[56:59], v[32:35], v[32:35], v[56:59]
    v_mfma_f32_16x16x32_bf16 v[56:59], v[36:39], v[36:39], v[56:59]
    v_max_f32 v120, v60, v61
    v_max3_f32 v120, v120, v62, v63
    v_max3_f32 v120, v120, v64, v65
    v_max3_f32 v120, v120, v66, v67
    s_nop 3
    v_max3_f32 v120, v120, v56, v57
    v_mov_b32 v121, v120
    s_nop 1
    v_permlane32_swap_b32 v120, v121
    v_max_f32 v120, v120, v121
    v_mov_b32 v121, v120
    s_nop 1
    v_permlane16_swap_b32 v120, v121
    v_max_f32 v120, v120, v121
    v_sub_f32 v60, v60, v120
    v_sub_f32 v61, v61, v120
    v_sub_f32 v62, v62, v120
    v_sub_f32 v63, v63, v120
    v_sub_f32 v64, v64, v120
    v_sub_f32 v65, v65, v120
    v_sub_f32 v66, v66, v120
    v_sub_f32 v67, v67, v120
    v_sub_f32 v56, v56, v120
    v_sub_f32 v57, v57, v120
    v_exp_f32 v60, v60
    v_exp_f32 v61, v61
    v_exp_f32 v62, v62
    v_exp_f32 v63, v63
    v_exp_f32 v64, v64
    v_exp_f32 v65, v65
    v_exp_f32 v66, v66
    v_exp_f32 v67, v67
    v_exp_f32 v56, v56
    v_exp_f32 v57, v57
    v_cvt_pk_bf16_f32 v20, v60, v61
    v_cvt_pk_bf16_f32 v21, v62, v63
    v_cvt_pk_bf16_f32 v22, v64, v65
    v_cvt_pk_bf16_f32 v23, v66, v67
    v_cvt_pk_bf16_f32 v124, v56, v57
    s_nop 0
    v_mfma_f32_16x16x32_bf16 v[40:43], v[112:115], v[20:23], 0
    v_mfma_f32_16x16x32_bf16 v[44:47], v[116:119], v[20:23], 0
    v_mfma_f32_16x16x16_bf16 v[40:43], v[126:127], v[124:125], v[40:43]
    v_mfma_f32_16x16x16_bf16 v[44:47], v[14:15], v[124:125], v[44:47]
    v_add_f32 v120, v60, v61
    v_add_f32 v120, v120, v62
    v_add_f32 v120, v120, v63
    v_add_f32 v120, v120, v64
    v_add_f32 v120, v120, v65
    v_add_f32 v120, v120, v66
    v_add_f32 v120, v120, v67
    v_add_f32 v120, v120, v56
    v_add_f32 v120, v120, v57
    v_mov_b32 v121, v120
    s_nop 1
    v_permlane32_swap_b32 v120, v121
    v_add_f32 v120, v120, v121
    v_mov_b32 v121, v120
    s_nop 1
    v_permlane16_swap_b32 v120, v121
    v_add_f32 v120, v120, v121
    v_rcp_f32 v120, v120
    ds_read_b128 v[80:83], v7 offset:0
    ds_read_b128 v[84:87], v7 offset:1024
    ds_read_b128 v[88:91], v7 offset:2048
    ds_read_b128 v[92:95], v7 offset:3072
    ds_read_b128 v[96:99], v8 offset:0
    ds_read_b128 v[100:103], v8 offset:1024
    ds_read_b128 v[104:107], v8 offset:2048
    ds_read_b128 v[108:111], v8 offset:3072
    ds_read_b128 v[24:27], v7 offset:4096
    ds_read_b128 v[28:31], v7 offset:5120
    ds_read_b128 v[32:35], v7 offset:6144
    ds_read_b128 v[36:39], v7 offset:7168
    ds_read_b128 v[48:51], v8 offset:4096
    ds_read_b128 v[52:55], v8 offset:5120
    s_mov_b64 vcc, 0
    s_waitcnt lgkmcnt(0)
    s_nop 11
    s_branch L_sm_back
L_rec_done:
    s_waitcnt vmcnt(0) lgkmcnt(0)
    s_barrier
    v_mov_b32 v16, 64
    s_cmp_eq_u32 s25, 0
    s_cselect_b64 exec, 1, 0
    buffer_store_dword v16, v15, s[8:11], s64 offen sc1
    s_mov_b64 exec, -1
    s_waitcnt vmcnt(0)
    s_endpgm
L_abort:
    s_waitcnt vmcnt(0) lgkmcnt(0)
    s_lshl_b32 s45, s26, 8
    s_or_b32 s31, s31, s45
    v_mov_b32 v16, s31
    v_mov_b32 v17, 36
    s_mov_b64 exec, 1
    buffer_store_dword v16, v17, s[12:15], 0 offen sc1
    s_waitcnt vmcnt(0)
    s_endpgm
L_bulk:
    s_mov_b32 s20, s4
    s_and_b32 s21, s5, 0xffff
    s_mov_b32 s22, 0x200000
    s_mov_b32 s23, 0x20000
    v_cmp_eq_u32 vcc, 0, v0
    s_nop 0
    s_and_saveexec_b64 s[46:47], vcc
    s_cbranch_execz L_nt_bulk
    v_mov_b32 v1, 1
    v_mov_b32 v2, 40
    buffer_atomic_add v1, v2, s[12:15], 0 offen sc0
    s_waitcnt vmcnt(0)
    v_mov_b32 v2, 14336
    ds_write_b32 v2, v1
    s_waitcnt lgkmcnt(0)
L_nt_bulk:
    s_mov_b64 exec, -1
    s_barrier
    v_mov_b32 v2, 14336
    ds_read_b32 v1, v2
    s_waitcnt lgkmcnt(0)
    v_readfirstlane_b32 s99, v1
    s_nop 3
    s_barrier
    s_cmp_ge_u32 s99, 224
    s_cbranch_scc1 L_end
    s_mov_b32 s97, 300000
    s_cmp_lg_u32 s99, 0
    s_cbranch_scc1 L_noinit
    v_lshlrev_b32 v1, 4, v0
    v_mov_b32 v4, 0
    v_mov_b32 v5, 0
    v_mov_b32 v6, 0
    v_mov_b32 v7, 0
    s_mov_b32 s31, 0x5200000
    buffer_store_dwordx4 v[4:7], v1, s[8:11], s31 offen sc1
    s_mov_b32 s31, 0x5201000
    buffer_store_dwordx4 v[4:7], v1, s[8:11], s31 offen sc1
    s_mov_b32 s31, 0x5202000
    buffer_store_dwordx4 v[4:7], v1, s[8:11], s31 offen sc1
    s_mov_b32 s31, 0x5203000
    buffer_store_dwordx4 v[4:7], v1, s[8:11], s31 offen sc1
    s_mov_b32 s31, 0x5204000
    buffer_store_dwordx4 v[4:7], v1, s[8:11], s31 offen sc1
    s_mov_b32 s31, 0x5205000
    buffer_store_dwordx4 v[4:7], v1, s[8:11], s31 offen sc1
    s_waitcnt vmcnt(0)
    s_barrier
    s_cmp_lg_u32 s25, 0
    s_cbranch_scc1 L_noinit
    v_mov_b32 v250, 60
    v_mov_b32 v251, 1
    s_mov_b64 exec, 1
    buffer_atomic_add v251, v250, s[12:15], 0 offen
    s_mov_b64 exec, -1
L_noinit:
    s_cmp_ge_u32 s99, 192
    s_cbranch_scc1 L_moe
    s_mov_b32 s77, 0
    s_mov_b32 s76, s99
    s_cmp_ge_u32 s76, 48
    s_cselect_b32 s31, 48, 0
    s_cselect_b32 s45, 1, 0
    s_sub_u32 s76, s76, s31
    s_add_u32 s77, s77, s45
    s_cmp_ge_u32 s76, 48
    s_cselect_b32 s31, 48, 0
    s_cselect_b32 s45, 1, 0
    s_sub_u32 s76, s76, s31
    s_add_u32 s77, s77, s45
    s_cmp_ge_u32 s76, 48
    s_cselect_b32 s31, 48, 0
    s_cselect_b32 s45, 1, 0
    s_sub_u32 s76, s76, s31
    s_add_u32 s77, s77, s45
    v_and_b32 v1, 63, v0
    v_and_b32 v2, 15, v0
    v_bfe_u32 v3, v0, 4, 2
    s_lshr_b32 s78, s76, 4
    s_and_b32 s79, s76, 15
    s_cmp_eq_u32 s78, 0
    s_cselect_b32 s31, s58, s60
    s_cselect_b32 s45, s59, s61
    s_cmp_eq_u32 s78, 2
    s_cselect_b32 s16, s56, s31
    s_cselect_b32 s45, s57, s45
    s_and_b32 s17, s45, 0xffff
    s_mov_b32 s18, 0x400000
    s_mov_b32 s19, 0x20000
    v_lshrrev_b32 v4, 5, v1
    v_and_b32 v5, 31, v1
    v_lshlrev_b32 v5, 4, v5
    v_lshlrev_b32 v8, 5, v4
    v_xor_b32 v5, v5, v8
    v_lshl_add_u32 v8, v4, 13, v5
    v_xor_b32 v9, 64, v8
    v_xor_b32 v10, 128, v8
    v_xor_b32 v11, 192, v8
    v_lshrrev_b32 v4, 2, v2
    v_and_b32 v5, 1, v3
    v_lshl_or_b32 v5, v5, 2, v4
    v_lshl_add_u32 v4, v3, 3, v4
    v_lshlrev_b32 v4, 9, v4
    v_and_b32 v6, 3, v2
    v_lshl_add_u32 v4, v6, 3, v4
    s_lshl_b32 s31, s25, 2
    v_xor_b32 v6, s31, v5
    v_lshl_add_u32 v12, v6, 5, v4
    v_add_u32 v16, 0x10000, v12
    v_xor_b32 v6, s31, v5
    v_xor_b32 v6, 1, v6
    v_lshl_add_u32 v13, v6, 5, v4
    v_add_u32 v17, 0x10000, v13
    v_xor_b32 v6, s31, v5
    v_xor_b32 v6, 2, v6
    v_lshl_add_u32 v14, v6, 5, v4
    v_add_u32 v18, 0x10000, v14
    v_xor_b32 v6, s31, v5
    v_xor_b32 v6, 3, v6
    v_lshl_add_u32 v15, v6, 5, v4
    v_add_u32 v19, 0x10000, v15
    s_barrier
    s_lshl_b32 s31, s25, 18
    s_lshl_b32 s45, s79, 9
    s_add_u32 s31, s31, s45
    s_add_u32 s31, s31, 0x0
    s_lshl_b32 s45, s25, 14
    s_add_u32 s45, s45, 0x0
    s_mov_b32 m0, s45
    s_nop 0
    buffer_load_dwordx4 v8, s[16:19], s31 offen lds
    s_add_u32 s31, s31, 0x4000
    s_add_u32 s45, s45, 0x400
    s_mov_b32 m0, s45
    s_nop 0
    buffer_load_dwordx4 v9, s[16:19], s31 offen lds
    s_add_u32 s31, s31, 0x4000
    s_add_u32 s45, s45, 0x400
    s_mov_b32 m0, s45
    s_nop 0
    buffer_load_dwordx4 v8, s[16:19], s31 offen lds
    s_add_u32 s31, s31, 0x4000
    s_add_u32 s45, s45, 0x400
    s_mov_b32 m0, s45
    s_nop 0
    buffer_load_dwordx4 v9, s[16:19], s31 offen lds
    s_add_u32 s31, s31, 0x4000
    s_add_u32 s45, s45, 0x400
    s_mov_b32 m0, s45
    s_nop 0
    buffer_load_dwordx4 v10, s[16:19], s31 offen lds
    s_add_u32 s31, s31, 0x4000
    s_add_u32 s45, s45, 0x400
    s_mov_b32 m0, s45
    s_nop 0
    buffer_load_dwordx4 v11, s[16:19], s31 offen lds
    s_add_u32 s31, s31, 0x4000
    s_add_u32 s45, s45, 0x400
    s_mov_b32 m0, s45
    s_nop 0
    buffer_load_dwordx4 v10, s[16:19], s31 offen lds
    s_add_u32 s31, s31, 0x4000
    s_add_u32 s45, s45, 0x400
    s_mov_b32 m0, s45
    s_nop 0
    buffer_load_dwordx4 v11, s[16:19], s31 offen lds
    s_add_u32 s31, s31, 0x4000
    s_add_u32 s45, s45, 0x400
    s_mov_b32 m0, s45
    s_nop 0
    buffer_load_dwordx4 v8, s[16:19], s31 offen lds
    s_add_u32 s31, s31, 0x4000
    s_add_u32 s45, s45, 0x400
    s_mov_b32 m0, s45
    s_nop 0
    buffer_load_dwordx4 v9, s[16:19], s31 offen lds
    s_add_u32 s31, s31, 0x4000
    s_add_u32 s45, s45, 0x400
    s_mov_b32 m0, s45
    s_nop 0
    buffer_load_dwordx4 v8, s[16:19], s31 offen lds
    s_add_u32 s31, s31, 0x4000
    s_add_u32 s45, s45, 0x400
    s_mov_b32 m0, s45
    s_nop 0
    buffer_load_dwordx4 v9, s[16:19], s31 offen lds
    s_add_u32 s31, s31, 0x4000
    s_add_u32 s45, s45, 0x400
    s_mov_b32 m0, s45
    s_nop 0
    buffer_load_dwordx4 v10, s[16:19], s31 offen lds
    s_add_u32 s31, s31, 0x4000
    s_add_u32 s45, s45, 0x400
    s_mov_b32 m0, s45
    s_nop 0
    buffer_load_dwordx4 v11, s[16:19], s31 offen lds
    s_add_u32 s31, s31, 0x4000
    s_add_u32 s45, s45, 0x400
    s_mov_b32 m0, s45
    s_nop 0
    buffer_load_dwordx4 v10, s[16:19], s31 offen lds
    s_add_u32 s31, s31, 0x4000
    s_add_u32 s45, s45, 0x400
    s_mov_b32 m0, s45
    s_nop 0
    buffer_load_dwordx4 v11, s[16:19], s31 offen lds
    s_add_u32 s31, s31, 0x4000
    s_add_u32 s45, s45, 0x400
    s_lshl_b32 s31, s25, 18
    s_lshl_b32 s45, s79, 9
    s_add_u32 s31, s31, s45
    s_add_u32 s31, s31, 0x100000
    s_lshl_b32 s45, s25, 14
    s_add_u32 s45, s45, 0x10000
    s_mov_b32 m0, s45
    s_nop 0
    buffer_load_dwordx4 v8, s[16:19], s31 offen lds
    s_add_u32 s31, s31, 0x4000
    s_add_u32 s45, s45, 0x400
    s_mov_b32 m0, s45
    s_nop 0
    buffer_load_dwordx4 v9, s[16:19], s31 offen lds
    s_add_u32 s31, s31, 0x4000
    s_add_u32 s45, s45, 0x400
    s_mov_b32 m0, s45
    s_nop 0
    buffer_load_dwordx4 v8, s[16:19], s31 offen lds
    s_add_u32 s31, s31, 0x4000
    s_add_u32 s45, s45, 0x400
    s_mov_b32 m0, s45
    s_nop 0
    buffer_load_dwordx4 v9, s[16:19], s31 offen lds
    s_add_u32 s31, s31, 0x4000
    s_add_u32 s45, s45, 0x400
    s_mov_b32 m0, s45
    s_nop 0
    buffer_load_dwordx4 v10, s[16:19], s31 offen lds
    s_add_u32 s31, s31, 0x4000
    s_add_u32 s45, s45, 0x400
    s_mov_b32 m0, s45
    s_nop 0
    buffer_load_dwordx4 v11, s[16:19], s31 offen lds
    s_add_u32 s31, s31, 0x4000
    s_add_u32 s45, s45, 0x400
    s_mov_b32 m0, s45
    s_nop 0
    buffer_load_dwordx4 v10, s[16:19], s31 offen lds
    s_add_u32 s31, s31, 0x4000
    s_add_u32 s45, s45, 0x400
    s_mov_b32 m0, s45
    s_nop 0
    buffer_load_dwordx4 v11, s[16:19], s31 offen lds
    s_add_u32 s31, s31, 0x4000
    s_add_u32 s45, s45, 0x400
    s_mov_b32 m0, s45
    s_nop 0
    buffer_load_dwordx4 v8, s[16:19], s31 offen lds
    s_add_u32 s31, s31, 0x4000
    s_add_u32 s45, s45, 0x400
    s_mov_b32 m0, s45
    s_nop 0
    buffer_load_dwordx4 v9, s[16:19], s31 offen lds
    s_add_u32 s31, s31, 0x4000
    s_add_u32 s45, s45, 0x400
    s_mov_b32 m0, s45
    s_nop 0
    buffer_load_dwordx4 v8, s[16:19], s31 offen lds
    s_add_u32 s31, s31, 0x4000
    s_add_u32 s45, s45, 0x400
    s_mov_b32 m0, s45
    s_nop 0
    buffer_load_dwordx4 v9, s[16:19], s31 offen lds
    s_add_u32 s31, s31, 0x4000
    s_add_u32 s45, s45, 0x400
    s_mov_b32 m0, s45
    s_nop 0
    buffer_load_dwordx4 v10, s[16:19], s31 offen lds
    s_add_u32 s31, s31, 0x4000
    s_add_u32 s45, s45, 0x400
    s_mov_b32 m0, s45
    s_nop 0
    buffer_load_dwordx4 v11, s[16:19], s31 offen lds
    s_add_u32 s31, s31, 0x4000
    s_add_u32 s45, s45, 0x400
    s_mov_b32 m0, s45
    s_nop 0
    buffer_load_dwordx4 v10, s[16:19], s31 offen lds
    s_add_u32 s31, s31, 0x4000
    s_add_u32 s45, s45, 0x400
    s_mov_b32 m0, s45
    s_nop 0
    buffer_load_dwordx4 v11, s[16:19], s31 offen lds
    s_add_u32 s31, s31, 0x4000
    s_add_u32 s45, s45, 0x400
    s_waitcnt vmcnt(16)
    s_barrier
    ds_read_b64_tr_b16 a[0:1], v12 offset:0
    ds_read_b64_tr_b16 a[2:3], v12 offset:2048
    ds_read_b64_tr_b16 a[4:5], v12 offset:16384
    ds_read_b64_tr_b16 a[6:7], v12 offset:18432
    ds_read_b64_tr_b16 a[8:9], v12 offset:32768
    ds_read_b64_tr_b16 a[10:11], v12 offset:34816
    ds_read_b64_tr_b16 a[12:13], v12 offset:49152
    ds_read_b64_tr_b16 a[14:15], v12 offset:51200
    ds_read_b64_tr_b16 a[64:65], v13 offset:0
    ds_read_b64_tr_b16 a[66:67], v13 offset:2048
    ds_read_b64_tr_b16 a[68:69], v13 offset:16384
    ds_read_b64_tr_b16 a[70:71], v13 offset:18432
    s_waitcnt lgkmcnt(4)
    ds_read_b64_tr_b16 a[72:73], v13 offset:32768
    ds_read_b64_tr_b16 a[74:75], v13 offset:34816
    ds_read_b64_tr_b16 a[76:77], v13 offset:49152
    ds_read_b64_tr_b16 a[78:79], v13 offset:51200
    ds_read_b64_tr_b16 a[128:129], v14 offset:0
    ds_read_b64_tr_b16 a[130:131], v14 offset:2048
    ds_read_b64_tr_b16 a[132:133], v14 offset:16384
    ds_read_b64_tr_b16 a[134:135], v14 offset:18432
    ds_read_b64_tr_b16 a[136:137], v14 offset:32768
    ds_read_b64_tr_b16 a[138:139], v14 offset:34816
    ds_read_b64_tr_b16 a[140:141], v14 offset:49152
    ds_read_b64_tr_b16 a[142:143], v14 offset:51200
    s_waitcnt lgkmcnt(4)
    ds_read_b64_tr_b16 a[192:193], v15 offset:0
    ds_read_b64_tr_b16 a[194:195], v15 offset:2048
    ds_read_b64_tr_b16 a[196:197], v15 offset:16384
    ds_read_b64_tr_b16 a[198:199], v15 offset:18432
    ds_read_b64_tr_b16 a[200:201], v15 offset:32768
    ds_read_b64_tr_b16 a[202:203], v15 offset:34816
    ds_read_b64_tr_b16 a[204:205], v15 offset:49152
    ds_read_b64_tr_b16 a[206:207], v15 offset:51200
    s_waitcnt lgkmcnt(0)
    s_barrier
    s_lshl_b32 s31, s25, 18
    s_lshl_b32 s45, s79, 9
    s_add_u32 s31, s31, s45
    s_add_u32 s31, s31, 0x200000
    s_lshl_b32 s45, s25, 14
    s_add_u32 s45, s45, 0x0
    s_mov_b32 m0, s45
    s_nop 0
    buffer_load_dwordx4 v8, s[16:19], s31 offen lds
    s_add_u32 s31, s31, 0x4000
    s_add_u32 s45, s45, 0x400
    s_mov_b32 m0, s45
    s_nop 0
    buffer_load_dwordx4 v9, s[16:19], s31 offen lds
    s_add_u32 s31, s31, 0x4000
    s_add_u32 s45, s45, 0x400
    s_mov_b32 m0, s45
    s_nop 0
    buffer_load_dwordx4 v8, s[16:19], s31 offen lds
    s_add_u32 s31, s31, 0x4000
    s_add_u32 s45, s45, 0x400
    s_mov_b32 m0, s45
    s_nop 0
    buffer_load_dwordx4 v9, s[16:19], s31 offen lds
    s_add_u32 s31, s31, 0x4000
    s_add_u32 s45, s45, 0x400
    s_mov_b32 m0, s45
    s_nop 0
    buffer_load_dwordx4 v10, s[16:19], s31 offen lds
    s_add_u32 s31, s31, 0x4000
    s_add_u32 s45, s45, 0x400
    s_mov_b32 m0, s45
    s_nop 0
    buffer_load_dwordx4 v11, s[16:19], s31 offen lds
    s_add_u32 s31, s31, 0x4000
    s_add_u32 s45, s45, 0x400
    s_mov_b32 m0, s45
    s_nop 0
    buffer_load_dwordx4 v10, s[16:19], s31 offen lds
    s_add_u32 s31, s31, 0x4000
    s_add_u32 s45, s45, 0x400
    s_mov_b32 m0, s45
    s_nop 0
    buffer_load_dwordx4 v11, s[16:19], s31 offen lds
    s_add_u32 s31, s31, 0x4000
    s_add_u32 s45, s45, 0x400
    s_mov_b32 m0, s45
    s_nop 0
    buffer_load_dwordx4 v8, s[16:19], s31 offen lds
    s_add_u32 s31, s31, 0x4000
    s_add_u32 s45, s45, 0x400
    s_mov_b32 m0, s45
    s_nop 0
    buffer_load_dwordx4 v9, s[16:19], s31 offen lds
    s_add_u32 s31, s31, 0x4000
    s_add_u32 s45, s45, 0x400
    s_mov_b32 m0, s45
    s_nop 0
    buffer_load_dwordx4 v8, s[16:19], s31 offen lds
    s_add_u32 s31, s31, 0x4000
    s_add_u32 s45, s45, 0x400
    s_mov_b32 m0, s45
    s_nop 0
    buffer_load_dwordx4 v9, s[16:19], s31 offen lds
    s_add_u32 s31, s31, 0x4000
    s_add_u32 s45, s45, 0x400
    s_mov_b32 m0, s45
    s_nop 0
    buffer_load_dwordx4 v10, s[16:19], s31 offen lds
    s_add_u32 s31, s31, 0x4000
    s_add_u32 s45, s45, 0x400
    s_mov_b32 m0, s45
    s_nop 0
    buffer_load_dwordx4 v11, s[16:19], s31 offen lds
    s_add_u32 s31, s31, 0x4000
    s_add_u32 s45, s45, 0x400
    s_mov_b32 m0, s45
    s_nop 0
    buffer_load_dwordx4 v10, s[16:19], s31 offen lds
    s_add_u32 s31, s31, 0x4000
    s_add_u32 s45, s45, 0x400
    s_mov_b32 m0, s45
    s_nop 0
    buffer_load_dwordx4 v11, s[16:19], s31 offen lds
    s_add_u32 s31, s31, 0x4000
    s_add_u32 s45, s45, 0x400
    s_waitcnt vmcnt(16)
    s_barrier
    ds_read_b64_tr_b16 a[16:17], v16 offset:0
    ds_read_b64_tr_b16 a[18:19], v16 offset:2048
    ds_read_b64_tr_b16 a[20:21], v16 offset:16384
    ds_read_b64_tr_b16 a[22:23], v16 offset:18432
    ds_read_b64_tr_b16 a[24:25], v16 offset:32768
    ds_read_b64_tr_b16 a[26:27], v16 offset:34816
    ds_read_b64_tr_b16 a[28:29], v16 offset:49152
    ds_read_b64_tr_b16 a[30:31], v16 offset:51200
    ds_read_b64_tr_b16 a[80:81], v17 offset:0
    ds_read_b64_tr_b16 a[82:83], v17 offset:2048
    ds_read_b64_tr_b16 a[84:85], v17 offset:16384
    ds_read_b64_tr_b16 a[86:87], v17 offset:18432
    s_waitcnt lgkmcnt(4)
    ds_read_b64_tr_b16 a[88:89], v17 offset:32768
    ds_read_b64_tr_b16 a[90:91], v17 offset:34816
    ds_read_b64_tr_b16 a[92:93], v17 offset:49152
    ds_read_b64_tr_b16 a[94:95], v17 offset:51200
    ds_read_b64_tr_b16 a[144:145], v18 offset:0
    ds_read_b64_tr_b16 a[146:147], v18 offset:2048
    ds_read_b64_tr_b16 a[148:149], v18 offset:16384
    ds_read_b64_tr_b16 a[150:151], v18 offset:18432
    ds_read_b64_tr_b16 a[152:153], v18 offset:32768
    ds_read_b64_tr_b16 a[154:155], v18 offset:34816
    ds_read_b64_tr_b16 a[156:157], v18 offset:49152
    ds_read_b64_tr_b16 a[158:159], v18 offset:51200
    s_waitcnt lgkmcnt(4)
    ds_read_b64_tr_b16 a[208:209], v19 offset:0
    ds_read_b64_tr_b16 a[210:211], v19 offset:2048
    ds_read_b64_tr_b16 a[212:213], v19 offset:16384
    ds_read_b64_tr_b16 a[214:215], v19 offset:18432
    ds_read_b64_tr_b16 a[216:217], v19 offset:32768
    ds_read_b64_tr_b16 a[218:219], v19 offset:34816
    ds_read_b64_tr_b16 a[220:221], v19 offset:49152
    ds_read_b64_tr_b16 a[222:223], v19 offset:51200
    s_waitcnt lgkmcnt(0)
    s_barrier
    s_lshl_b32 s31, s25, 18
    s_lshl_b32 s45, s79, 9
    s_add_u32 s31, s31, s45
    s_add_u32 s31, s31, 0x300000
    s_lshl_b32 s45, s25, 14
    s_add_u32 s45, s45, 0x10000
    s_mov_b32 m0, s45
    s_nop 0
    buffer_load_dwordx4 v8, s[16:19], s31 offen lds
    s_add_u32 s31, s31, 0x4000
    s_add_u32 s45, s45, 0x400
    s_mov_b32 m0, s45
    s_nop 0
    buffer_load_dwordx4 v9, s[16:19], s31 offen lds
    s_add_u32 s31, s31, 0x4000
    s_add_u32 s45, s45, 0x400
    s_mov_b32 m0, s45
    s_nop 0
    buffer_load_dwordx4 v8, s[16:19], s31 offen lds
    s_add_u32 s31, s31, 0x4000
    s_add_u32 s45, s45, 0x400
    s_mov_b32 m0, s45
    s_nop 0
    buffer_load_dwordx4 v9, s[16:19], s31 offen lds
    s_add_u32 s31, s31, 0x4000
    s_add_u32 s45, s45, 0x400
    s_mov_b32 m0, s45
    s_nop 0
    buffer_load_dwordx4 v10, s[16:19], s31 offen lds
    s_add_u32 s31, s31, 0x4000
    s_add_u32 s45, s45, 0x400
    s_mov_b32 m0, s45
    s_nop 0
    buffer_load_dwordx4 v11, s[16:19], s31 offen lds
    s_add_u32 s31, s31, 0x4000
    s_add_u32 s45, s45, 0x400
    s_mov_b32 m0, s45
    s_nop 0
    buffer_load_dwordx4 v10, s[16:19], s31 offen lds
    s_add_u32 s31, s31, 0x4000
    s_add_u32 s45, s45, 0x400
    s_mov_b32 m0, s45
    s_nop 0
    buffer_load_dwordx4 v11, s[16:19], s31 offen lds
    s_add_u32 s31, s31, 0x4000
    s_add_u32 s45, s45, 0x400
    s_mov_b32 m0, s45
    s_nop 0
    buffer_load_dwordx4 v8, s[16:19], s31 offen lds
    s_add_u32 s31, s31, 0x4000
    s_add_u32 s45, s45, 0x400
    s_mov_b32 m0, s45
    s_nop 0
    buffer_load_dwordx4 v9, s[16:19], s31 offen lds
    s_add_u32 s31, s31, 0x4000
    s_add_u32 s45, s45, 0x400
    s_mov_b32 m0, s45
    s_nop 0
    buffer_load_dwordx4 v8, s[16:19], s31 offen lds
    s_add_u32 s31, s31, 0x4000
    s_add_u32 s45, s45, 0x400
    s_mov_b32 m0, s45
    s_nop 0
    buffer_load_dwordx4 v9, s[16:19], s31 offen lds
    s_add_u32 s31, s31, 0x4000
    s_add_u32 s45, s45, 0x400
    s_mov_b32 m0, s45
    s_nop 0
    buffer_load_dwordx4 v10, s[16:19], s31 offen lds
    s_add_u32 s31, s31, 0x4000
    s_add_u32 s45, s45, 0x400
    s_mov_b32 m0, s45
    s_nop 0
    buffer_load_dwordx4 v11, s[16:19], s31 offen lds
    s_add_u32 s31, s31, 0x4000
    s_add_u32 s45, s45, 0x400
    s_mov_b32 m0, s45
    s_nop 0
    buffer_load_dwordx4 v10, s[16:19], s31 offen lds
    s_add_u32 s31, s31, 0x4000
    s_add_u32 s45, s45, 0x400
    s_mov_b32 m0, s45
    s_nop 0
    buffer_load_dwordx4 v11, s[16:19], s31 offen lds
    s_add_u32 s31, s31, 0x4000
    s_add_u32 s45, s45, 0x400
    s_waitcnt vmcnt(16)
    s_barrier
    ds_read_b64_tr_b16 a[32:33], v12 offset:0
    ds_read_b64_tr_b16 a[34:35], v12 offset:2048
    ds_read_b64_tr_b16 a[36:37], v12 offset:16384
    ds_read_b64_tr_b16 a[38:39], v12 offset:18432
    ds_read_b64_tr_b16 a[40:41], v12 offset:32768
    ds_read_b64_tr_b16 a[42:43], v12 offset:34816
    ds_read_b64_tr_b16 a[44:45], v12 offset:49152
    ds_read_b64_tr_b16 a[46:47], v12 offset:51200
    ds_read_b64_tr_b16 a[96:97], v13 offset:0
    ds_read_b64_tr_b16 a[98:99], v13 offset:2048
    ds_read_b64_tr_b16 a[100:101], v13 offset:16384
    ds_read_b64_tr_b16 a[102:103], v13 offset:18432
    s_waitcnt lgkmcnt(4)
    ds_read_b64_tr_b16 a[104:105], v13 offset:32768
    ds_read_b64_tr_b16 a[106:107], v13 offset:34816
    ds_read_b64_tr_b16 a[108:109], v13 offset:49152
    ds_read_b64_tr_b16 a[110:111], v13 offset:51200
    ds_read_b64_tr_b16 a[160:161], v14 offset:0
    ds_read_b64_tr_b16 a[162:163], v14 offset:2048
    ds_read_b64_tr_b16 a[164:165], v14 offset:16384
    ds_read_b64_tr_b16 a[166:167], v14 offset:18432
    ds_read_b64_tr_b16 a[168:169], v14 offset:32768
    ds_read_b64_tr_b16 a[170:171], v14 offset:34816
    ds_read_b64_tr_b16 a[172:173], v14 offset:49152
    ds_read_b64_tr_b16 a[174:175], v14 offset:51200
    s_waitcnt lgkmcnt(4)
    ds_read_b64_tr_b16 a[224:225], v15 offset:0
    ds_read_b64_tr_b16 a[226:227], v15 offset:2048
    ds_read_b64_tr_b16 a[228:229], v15 offset:16384
    ds_read_b64_tr_b16 a[230:231], v15 offset:18432
    ds_read_b64_tr_b16 a[232:233], v15 offset:32768
    ds_read_b64_tr_b16 a[234:235], v15 offset:34816
    ds_read_b64_tr_b16 a[236:237], v15 offset:49152
    ds_read_b64_tr_b16 a[238:239], v15 offset:51200
    s_waitcnt lgkmcnt(0)
    s_barrier
    s_waitcnt vmcnt(0)
    s_barrier
    ds_read_b64_tr_b16 a[48:49], v16 offset:0
    ds_read_b64_tr_b16 a[50:51], v16 offset:2048
    ds_read_b64_tr_b16 a[52:53], v16 offset:16384
    ds_read_b64_tr_b16 a[54:55], v16 offset:18432
    ds_read_b64_tr_b16 a[56:57], v16 offset:32768
    ds_read_b64_tr_b16 a[58:59], v16 offset:34816
    ds_read_b64_tr_b16 a[60:61], v16 offset:49152
    ds_read_b64_tr_b16 a[62:63], v16 offset:51200
    ds_read_b64_tr_b16 a[112:113], v17 offset:0
    ds_read_b64_tr_b16 a[114:115], v17 offset:2048
    ds_read_b64_tr_b16 a[116:117], v17 offset:16384
    ds_read_b64_tr_b16 a[118:119], v17 offset:18432
    s_waitcnt lgkmcnt(4)
    ds_read_b64_tr_b16 a[120:121], v17 offset:32768
    ds_read_b64_tr_b16 a[122:123], v17 offset:34816
    ds_read_b64_tr_b16 a[124:125], v17 offset:49152
    ds_read_b64_tr_b16 a[126:127], v17 offset:51200
    ds_read_b64_tr_b16 a[176:177], v18 offset:0
    ds_read_b64_tr_b16 a[178:179], v18 offset:2048
    ds_read_b64_tr_b16 a[180:181], v18 offset:16384
    ds_read_b64_tr_b16 a[182:183], v18 offset:18432
    ds_read_b64_tr_b16 a[184:185], v18 offset:32768
    ds_read_b64_tr_b16 a[186:187], v18 offset:34816
    ds_read_b64_tr_b16 a[188:189], v18 offset:49152
    ds_read_b64_tr_b16 a[190:191], v18 offset:51200
    s_waitcnt lgkmcnt(4)
    ds_read_b64_tr_b16 a[240:241], v19 offset:0
    ds_read_b64_tr_b16 a[242:243], v19 offset:2048
    ds_read_b64_tr_b16 a[244:245], v19 offset:16384
    ds_read_b64_tr_b16 a[246:247], v19 offset:18432
    ds_read_b64_tr_b16 a[248:249], v19 offset:32768
    ds_read_b64_tr_b16 a[250:251], v19 offset:34816
    ds_read_b64_tr_b16 a[252:253], v19 offset:49152
    ds_read_b64_tr_b16 a[254:255], v19 offset:51200
    s_waitcnt lgkmcnt(0)
    s_barrier
    v_lshlrev_b32 v4, 10, v2
    v_lshl_add_u32 v4, v3, 4, v4
    v_lshlrev_b32 v5, 4, v1
    v_mov_b32 v6, v5
    s_lshl_b32 s80, s77, 15
    s_lshr_b32 s31, s25, 1
    s_lshl_b32 s31, s31, 14
    s_add_u32 s80, s80, s31
    s_and_b32 s31, s25, 1
    s_lshl_b32 s31, s31, 9
    s_add_u32 s80, s80, s31
    s_lshl_b32 s81, s25, 13
    s_cmp_eq_u32 s78, 0
    s_cselect_b32 s31, s31, s31
    s_mov_b32 s31, 0x1000000
    s_mov_b32 s45, 0x2000000
    s_cmp_eq_u32 s78, 0
    s_cselect_b32 s83, s31, s45
    s_cmp_eq_u32 s78, 2
    s_cselect_b32 s83, 0, s83
    s_lshl_b32 s31, s77, 18
    s_add_u32 s83, s83, s31
    s_lshl_b32 s31, s79, 14
    s_add_u32 s83, s83, s31
    s_lshr_b32 s31, s25, 1
    s_lshl_b32 s31, s31, 13
    s_add_u32 s83, s83, s31
    s_and_b32 s31, s25, 1
    s_cmp_eq_u32 s78, 1
    s_cselect_b32 s45, 12, 11
    s_lshl_b32 s31, s31, s45
    s_add_u32 s83, s83, s31
    s_mov_b32 s31, s80
    s_mov_b32 s45, s81
    s_mov_b32 m0, s45
    s_nop 0
    buffer_load_dwordx4 v4, s[20:23], s31 offen lds
    s_add_u32 s31, s31, 64
    s_add_u32 s45, s45, 0x400
    s_mov_b32 m0, s45
    s_nop 0
    buffer_load_dwordx4 v4, s[20:23], s31 offen lds
    s_add_u32 s31, s31, 64
    s_add_u32 s45, s45, 0x400
    s_mov_b32 m0, s45
    s_nop 0
    buffer_load_dwordx4 v4, s[20:23], s31 offen lds
    s_add_u32 s31, s31, 64
    s_add_u32 s45, s45, 0x400
    s_mov_b32 m0, s45
    s_nop 0
    buffer_load_dwordx4 v4, s[20:23], s31 offen lds
    s_add_u32 s31, s31, 64
    s_add_u32 s45, s45, 0x400
    s_mov_b32 m0, s45
    s_nop 0
    buffer_load_dwordx4 v4, s[20:23], s31 offen lds
    s_add_u32 s31, s31, 64
    s_add_u32 s45, s45, 0x400
    s_mov_b32 m0, s45
    s_nop 0
    buffer_load_dwordx4 v4, s[20:23], s31 offen lds
    s_add_u32 s31, s31, 64
    s_add_u32 s45, s45, 0x400
    s_mov_b32 m0, s45
    s_nop 0
    buffer_load_dwordx4 v4, s[20:23], s31 offen lds
    s_add_u32 s31, s31, 64
    s_add_u32 s45, s45, 0x400
    s_mov_b32 m0, s45
    s_nop 0
    buffer_load_dwordx4 v4, s[20:23], s31 offen lds
    s_add_u32 s80, s80, 0x20000
    s_xor_b32 s81, s81, 0x8000
    s_mov_b32 s84, 0
    s_lshl_b32 s98, s79, 8
    s_lshr_b32 s31, s25, 1
    s_lshl_b32 s31, s31, 7
    s_add_u32 s98, s98, s31
    s_lshl_b32 s31, s78, 5
    s_add_u32 s98, s98, s31
    s_and_b32 s31, s25, 1
    s_lshl_b32 s31, s31, 4
    s_add_u32 s98, s98, s31
    s_lshl_b32 s31, s77, 2
    s_add_u32 s98, s98, s31
    s_add_u32 s98, s98, 0x5202000
    v_mov_b32 v7, 0
    v_mov_b32 v250, 60
L_g_frdy:
    buffer_load_dword v251, v250, s[12:15], 0 offen sc1
    s_waitcnt vmcnt(0)
    v_cmp_gt_u32 vcc, 1, v251
    s_cbranch_vccz L_g_frdy_ok
    s_sleep 4
    s_sub_u32 s97, s97, 1
    s_cmp_eq_u32 s97, 0
    s_cbranch_scc0 L_g_frdy
    s_mov_b32 s31, 10
    s_branch L_babort
L_g_frdy_ok:
    s_waitcnt vmcnt(0)
    s_cmp_eq_u32 s78, 1
    s_cbranch_scc1 L_g_V
L_g_loopKQ:
    s_barrier
    s_cmp_lt_u32 s84, 15
    s_cbranch_scc0 L_g_nodmaKQ
    s_mov_b32 s31, s80
    s_mov_b32 s45, s81
    s_mov_b32 m0, s45
    s_nop 0
    buffer_load_dwordx4 v4, s[20:23], s31 offen lds
    s_add_u32 s31, s31, 64
    s_add_u32 s45, s45, 0x400
    s_mov_b32 m0, s45
    s_nop 0
    buffer_load_dwordx4 v4, s[20:23], s31 offen lds
    s_add_u32 s31, s31, 64
    s_add_u32 s45, s45, 0x400
    s_mov_b32 m0, s45
    s_nop 0
    buffer_load_dwordx4 v4, s[20:23], s31 offen lds
    s_add_u32 s31, s31, 64
    s_add_u32 s45, s45, 0x400
    s_mov_b32 m0, s45
    s_nop 0
    buffer_load_dwordx4 v4, s[20:23], s31 offen lds
    s_add_u32 s31, s31, 64
    s_add_u32 s45, s45, 0x400
    s_mov_b32 m0, s45
    s_nop 0
    buffer_load_dwordx4 v4, s[20:23], s31 offen lds
    s_add_u32 s31, s31, 64
    s_add_u32 s45, s45, 0x400
    s_mov_b32 m0, s45
    s_nop 0
    buffer_load_dwordx4 v4, s[20:23], s31 offen lds
    s_add_u32 s31, s31, 64
    s_add_u32 s45, s45, 0x400
    s_mov_b32 m0, s45
    s_nop 0
    buffer_load_dwordx4 v4, s[20:23], s31 offen lds
    s_add_u32 s31, s31, 64
    s_add_u32 s45, s45, 0x400
    s_mov_b32 m0, s45
    s_nop 0
    buffer_load_dwordx4 v4, s[20:23], s31 offen lds
    s_add_u32 s80, s80, 0x20000
    s_xor_b32 s81, s81, 0x8000
L_g_nodmaKQ:
    ds_read_b128 v[16:19], v6 offset:0
    ds_read_b128 v[20:23], v6 offset:1024
    ds_read_b128 v[24:27], v6 offset:2048
    ds_read_b128 v[28:31], v6 offset:3072
    s_waitcnt lgkmcnt(3)
    v_mfma_f32_16x16x32_bf16 v[32:35], a[0:3], v[16:19], 0
    v_mfma_f32_16x16x32_bf16 v[36:39], a[64:67], v[16:19], 0
    v_mfma_f32_16x16x32_bf16 v[40:43], a[128:131], v[16:19], 0
    v_mfma_f32_16x16x32_bf16 v[44:47], a[192:195], v[16:19], 0
    ds_read_b128 v[16:19], v6 offset:4096
    s_waitcnt lgkmcnt(3)
    v_mfma_f32_16x16x32_bf16 v[32:35], a[4:7], v[20:23], v[32:35]
    v_mfma_f32_16x16x32_bf16 v[36:39], a[68:71], v[20:23], v[36:39]
    v_mfma_f32_16x16x32_bf16 v[40:43], a[132:135], v[20:23], v[40:43]
    v_mfma_f32_16x16x32_bf16 v[44:47], a[196:199], v[20:23], v[44:47]
    ds_read_b128 v[20:23], v6 offset:5120
    s_waitcnt lgkmcnt(3)
    v_mfma_f32_16x16x32_bf16 v[32:35], a[8:11], v[24:27], v[32:35]
    v_mfma_f32_16x16x32_bf16 v[36:39], a[72:75], v[24:27], v[36:39]
    v_mfma_f32_16x16x32_bf16 v[40:43], a[136:139], v[24:27], v[40:43]
    v_mfma_f32_16x16x32_bf16 v[44:47], a[200:203], v[24:27], v[44:47]
    ds_read_b128 v[24:27], v6 offset:6144
    s_waitcnt lgkmcnt(3)
    v_mfma_f32_16x16x32_bf16 v[32:35], a[12:15], v[28:31], v[32:35]
    v_mfma_f32_16x16x32_bf16 v[36:39], a[76:79], v[28:31], v[36:39]
    v_mfma_f32_16x16x32_bf16 v[40:43], a[140:143], v[28:31], v[40:43]
    v_mfma_f32_16x16x32_bf16 v[44:47], a[204:207], v[28:31], v[44:47]
    ds_read_b128 v[28:31], v6 offset:7168
    s_waitcnt lgkmcnt(3)
    v_mfma_f32_16x16x32_bf16 v[32:35], a[16:19], v[16:19], v[32:35]
    v_mfma_f32_16x16x32_bf16 v[36:39], a[80:83], v[16:19], v[36:39]
    v_mfma_f32_16x16x32_bf16 v[40:43], a[144:147], v[16:19], v[40:43]
    v_mfma_f32_16x16x32_bf16 v[44:47], a[208:211], v[16:19], v[44:47]
    ds_read_b128 v[16:19], v6 offset:8192
    s_waitcnt lgkmcnt(3)
    v_mfma_f32_16x16x32_bf16 v[32:35], a[20:23], v[20:23], v[32:35]
    v_mfma_f32_16x16x32_bf16 v[36:39], a[84:87], v[20:23], v[36:39]
    v_mfma_f32_16x16x32_bf16 v[40:43], a[148:151], v[20:23], v[40:43]
    v_mfma_f32_16x16x32_bf16 v[44:47], a[212:215], v[20:23], v[44:47]
    ds_read_b128 v[20:23], v6 offset:9216
    s_waitcnt lgkmcnt(3)
    v_mfma_f32_16x16x32_bf16 v[32:35], a[24:27], v[24:27], v[32:35]
    v_mfma_f32_16x16x32_bf16 v[36:39], a[88:91], v[24:27], v[36:39]
    v_mfma_f32_16x16x32_bf16 v[40:43], a[152:155], v[24:27], v[40:43]
    v_mfma_f32_16x16x32_bf16 v[44:47], a[216:219], v[24:27], v[44:47]
    ds_read_b128 v[24:27], v6 offset:10240
    s_waitcnt lgkmcnt(3)
    v_mfma_f32_16x16x32_bf16 v[32:35], a[28:31], v[28:31], v[32:35]
    v_mfma_f32_16x16x32_bf16 v[36:39], a[92:95], v[28:31], v[36:39]
    v_mfma_f32_16x16x32_bf16 v[40:43], a[156:159], v[28:31], v[40:43]
    v_mfma_f32_16x16x32_bf16 v[44:47], a[220:223], v[28:31], v[44:47]
    ds_read_b128 v[28:31], v6 offset:11264
    s_waitcnt lgkmcnt(3)
    v_mfma_f32_16x16x32_bf16 v[32:35], a[32:35], v[16:19], v[32:35]
    v_mfma_f32_16x16x32_bf16 v[36:39], a[96:99], v[16:19], v[36:39]
    v_mfma_f32_16x16x32_bf16 v[40:43], a[160:163], v[16:19], v[40:43]
    v_mfma_f32_16x16x32_bf16 v[44:47], a[224:227], v[16:19], v[44:47]
    ds_read_b128 v[16:19], v6 offset:12288
    s_waitcnt lgkmcnt(3)
    v_mfma_f32_16x16x32_bf16 v[32:35], a[36:39], v[20:23], v[32:35]
    v_mfma_f32_16x16x32_bf16 v[36:39], a[100:103], v[20:23], v[36:39]
    v_mfma_f32_16x16x32_bf16 v[40:43], a[164:167], v[20:23], v[40:43]
    v_mfma_f32_16x16x32_bf16 v[44:47], a[228:231], v[20:23], v[44:47]
    ds_read_b128 v[20:23], v6 offset:13312
    s_waitcnt lgkmcnt(3)
    v_mfma_f32_16x16x32_bf16 v[32:35], a[40:43], v[24:27], v[32:35]
    v_mfma_f32_16x16x32_bf16 v[36:39], a[104:107], v[24:27], v[36:39]
    v_mfma_f32_16x16x32_bf16 v[40:43], a[168:171], v[24:27], v[40:43]
    v_mfma_f32_16x16x32_bf16 v[44:47], a[232:235], v[24:27], v[44:47]
    ds_read_b128 v[24:27], v6 offset:14336
    s_waitcnt lgkmcnt(3)
    v_mfma_f32_16x16x32_bf16 v[32:35], a[44:47], v[28:31], v[32:35]
    v_mfma_f32_16x16x32_bf16 v[36:39], a[108:111], v[28:31], v[36:39]
    v_mfma_f32_16x16x32_bf16 v[40:43], a[172:175], v[28:31], v[40:43]
    v_mfma_f32_16x16x32_bf16 v[44:47], a[236:239], v[28:31], v[44:47]
    ds_read_b128 v[28:31], v6 offset:15360
    s_waitcnt lgkmcnt(3)
    v_mfma_f32_16x16x32_bf16 v[32:35], a[48:51], v[16:19], v[32:35]
    v_mfma_f32_16x16x32_bf16 v[36:39], a[112:115], v[16:19], v[36:39]
    v_mfma_f32_16x16x32_bf16 v[40:43], a[176:179], v[16:19], v[40:43]
    v_mfma_f32_16x16x32_bf16 v[44:47], a[240:243], v[16:19], v[44:47]
    ds_read_b128 v[16:19], v6 offset:16384
    s_waitcnt lgkmcnt(3)
    v_mfma_f32_16x16x32_bf16 v[32:35], a[52:55], v[20:23], v[32:35]
    v_mfma_f32_16x16x32_bf16 v[36:39], a[116:119], v[20:23], v[36:39]
    v_mfma_f32_16x16x32_bf16 v[40:43], a[180:183], v[20:23], v[40:43]
    v_mfma_f32_16x16x32_bf16 v[44:47], a[244:247], v[20:23], v[44:47]
    ds_read_b128 v[20:23], v6 offset:17408
    s_waitcnt lgkmcnt(3)
    v_mfma_f32_16x16x32_bf16 v[32:35], a[56:59], v[24:27], v[32:35]
    v_mfma_f32_16x16x32_bf16 v[36:39], a[120:123], v[24:27], v[36:39]
    v_mfma_f32_16x16x32_bf16 v[40:43], a[184:187], v[24:27], v[40:43]
    v_mfma_f32_16x16x32_bf16 v[44:47], a[248:251], v[24:27], v[44:47]
    ds_read_b128 v[24:27], v6 offset:18432
    s_waitcnt lgkmcnt(3)
    v_mfma_f32_16x16x32_bf16 v[32:35], a[60:63], v[28:31], v[32:35]
    v_mfma_f32_16x16x32_bf16 v[36:39], a[124:127], v[28:31], v[36:39]
    v_mfma_f32_16x16x32_bf16 v[40:43], a[188:191], v[28:31], v[40:43]
    v_mfma_f32_16x16x32_bf16 v[44:47], a[252:255], v[28:31], v[44:47]
    ds_read_b128 v[28:31], v6 offset:19456
    s_waitcnt lgkmcnt(3)
    v_mfma_f32_16x16x32_bf16 v[48:51], a[0:3], v[16:19], 0
    v_mfma_f32_16x16x32_bf16 v[52:55], a[64:67], v[16:19], 0
    v_mfma_f32_16x16x32_bf16 v[56:59], a[128:131], v[16:19], 0
    v_mfma_f32_16x16x32_bf16 v[60:63], a[192:195], v[16:19], 0
    ds_read_b128 v[16:19], v6 offset:20480
    s_waitcnt lgkmcnt(3)
    v_mfma_f32_16x16x32_bf16 v[48:51], a[4:7], v[20:23], v[48:51]
    v_mfma_f32_16x16x32_bf16 v[52:55], a[68:71], v[20:23], v[52:55]
    v_mfma_f32_16x16x32_bf16 v[56:59], a[132:135], v[20:23], v[56:59]
    v_mfma_f32_16x16x32_bf16 v[60:63], a[196:199], v[20:23], v[60:63]
    ds_read_b128 v[20:23], v6 offset:21504
    s_waitcnt lgkmcnt(3)
    v_mfma_f32_16x16x32_bf16 v[48:51], a[8:11], v[24:27], v[48:51]
    v_mfma_f32_16x16x32_bf16 v[52:55], a[72:75], v[24:27], v[52:55]
    v_mfma_f32_16x16x32_bf16 v[56:59], a[136:139], v[24:27], v[56:59]
    v_mfma_f32_16x16x32_bf16 v[60:63], a[200:203], v[24:27], v[60:63]
    ds_read_b128 v[24:27], v6 offset:22528
    s_waitcnt lgkmcnt(3)
    v_mfma_f32_16x16x32_bf16 v[48:51], a[12:15], v[28:31], v[48:51]
    v_mfma_f32_16x16x32_bf16 v[52:55], a[76:79], v[28:31], v[52:55]
    v_mfma_f32_16x16x32_bf16 v[56:59], a[140:143], v[28:31], v[56:59]
    v_mfma_f32_16x16x32_bf16 v[60:63], a[204:207], v[28:31], v[60:63]
    ds_read_b128 v[28:31], v6 offset:23552
    s_waitcnt lgkmcnt(3)
    v_mfma_f32_16x16x32_bf16 v[48:51], a[16:19], v[16:19], v[48:51]
    v_mfma_f32_16x16x32_bf16 v[52:55], a[80:83], v[16:19], v[52:55]
    v_mfma_f32_16x16x32_bf16 v[56:59], a[144:147], v[16:19], v[56:59]
    v_mfma_f32_16x16x32_bf16 v[60:63], a[208:211], v[16:19], v[60:63]
    ds_read_b128 v[16:19], v6 offset:24576
    s_waitcnt lgkmcnt(3)
    v_mfma_f32_16x16x32_bf16 v[48:51], a[20:23], v[20:23], v[48:51]
    v_mfma_f32_16x16x32_bf16 v[52:55], a[84:87], v[20:23], v[52:55]
    v_mfma_f32_16x16x32_bf16 v[56:59], a[148:151], v[20:23], v[56:59]
    v_mfma_f32_16x16x32_bf16 v[60:63], a[212:215], v[20:23], v[60:63]
    ds_read_b128 v[20:23], v6 offset:25600
    s_waitcnt lgkmcnt(3)
    v_mfma_f32_16x16x32_bf16 v[48:51], a[24:27], v[24:27], v[48:51]
    v_mfma_f32_16x16x32_bf16 v[52:55], a[88:91], v[24:27], v[52:55]
    v_mfma_f32_16x16x32_bf16 v[56:59], a[152:155], v[24:27], v[56:59]
    v_mfma_f32_16x16x32_bf16 v[60:63], a[216:219], v[24:27], v[60:63]
    ds_read_b128 v[24:27], v6 offset:26624
    s_waitcnt lgkmcnt(3)
    v_mfma_f32_16x16x32_bf16 v[48:51], a[28:31], v[28:31], v[48:51]
    v_mfma_f32_16x16x32_bf16 v[52:55], a[92:95], v[28:31], v[52:55]
    v_mfma_f32_16x16x32_bf16 v[56:59], a[156:159], v[28:31], v[56:59]
    v_mfma_f32_16x16x32_bf16 v[60:63], a[220:223], v[28:31], v[60:63]
    ds_read_b128 v[28:31], v6 offset:27648
    s_waitcnt lgkmcnt(3)
    v_mfma_f32_16x16x32_bf16 v[48:51], a[32:35], v[16:19], v[48:51]
    v_mfma_f32_16x16x32_bf16 v[52:55], a[96:99], v[16:19], v[52:55]
    v_mfma_f32_16x16x32_bf16 v[56:59], a[160:163], v[16:19], v[56:59]
    v_mfma_f32_16x16x32_bf16 v[60:63], a[224:227], v[16:19], v[60:63]
    ds_read_b128 v[16:19], v6 offset:28672
    s_waitcnt lgkmcnt(3)
    v_mfma_f32_16x16x32_bf16 v[48:51], a[36:39], v[20:23], v[48:51]
    v_mfma_f32_16x16x32_bf16 v[52:55], a[100:103], v[20:23], v[52:55]
    v_mfma_f32_16x16x32_bf16 v[56:59], a[164:167], v[20:23], v[56:59]
    v_mfma_f32_16x16x32_bf16 v[60:63], a[228:231], v[20:23], v[60:63]
    ds_read_b128 v[20:23], v6 offset:29696
    s_waitcnt lgkmcnt(3)
    v_mfma_f32_16x16x32_bf16 v[48:51], a[40:43], v[24:27], v[48:51]
    v_mfma_f32_16x16x32_bf16 v[52:55], a[104:107], v[24:27], v[52:55]
    v_mfma_f32_16x16x32_bf16 v[56:59], a[168:171], v[24:27], v[56:59]
    v_mfma_f32_16x16x32_bf16 v[60:63], a[232:235], v[24:27], v[60:63]
    ds_read_b128 v[24:27], v6 offset:30720
    s_waitcnt lgkmcnt(3)
    v_mfma_f32_16x16x32_bf16 v[48:51], a[44:47], v[28:31], v[48:51]
    v_mfma_f32_16x16x32_bf16 v[52:55], a[108:111], v[28:31], v[52:55]
    v_mfma_f32_16x16x32_bf16 v[56:59], a[172:175], v[28:31], v[56:59]
    v_mfma_f32_16x16x32_bf16 v[60:63], a[236:239], v[28:31], v[60:63]
    ds_read_b128 v[28:31], v6 offset:31744
    s_waitcnt lgkmcnt(3)
    v_mfma_f32_16x16x32_bf16 v[48:51], a[48:51], v[16:19], v[48:51]
    v_mfma_f32_16x16x32_bf16 v[52:55], a[112:115], v[16:19], v[52:55]
    v_mfma_f32_16x16x32_bf16 v[56:59], a[176:179], v[16:19], v[56:59]
    v_mfma_f32_16x16x32_bf16 v[60:63], a[240:243], v[16:19], v[60:63]
    s_waitcnt lgkmcnt(2)
    v_mfma_f32_16x16x32_bf16 v[48:51], a[52:55], v[20:23], v[48:51]
    v_mfma_f32_16x16x32_bf16 v[52:55], a[116:119], v[20:23], v[52:55]
    v_mfma_f32_16x16x32_bf16 v[56:59], a[180:183], v[20:23], v[56:59]
    v_mfma_f32_16x16x32_bf16 v[60:63], a[244:247], v[20:23], v[60:63]
    s_waitcnt lgkmcnt(1)
    v_mfma_f32_16x16x32_bf16 v[48:51], a[56:59], v[24:27], v[48:51]
    v_mfma_f32_16x16x32_bf16 v[52:55], a[120:123], v[24:27], v[52:55]
    v_mfma_f32_16x16x32_bf16 v[56:59], a[184:187], v[24:27], v[56:59]
    v_mfma_f32_16x16x32_bf16 v[60:63], a[248:251], v[24:27], v[60:63]
    s_waitcnt lgkmcnt(0)
    v_mfma_f32_16x16x32_bf16 v[48:51], a[60:63], v[28:31], v[48:51]
    v_mfma_f32_16x16x32_bf16 v[52:55], a[124:127], v[28:31], v[52:55]
    v_mfma_f32_16x16x32_bf16 v[56:59], a[188:191], v[28:31], v[56:59]
    v_mfma_f32_16x16x32_bf16 v[60:63], a[252:255], v[28:31], v[60:63]
    v_cvt_pk_bf16_f32 v64, v32, v33
    v_cvt_pk_bf16_f32 v65, v34, v35
    v_cvt_pk_bf16_f32 v66, v36, v37
    v_cvt_pk_bf16_f32 v67, v38, v39
    buffer_store_dwordx4 v[64:67], v5, s[8:11], s83 offen offset:0 sc1
    v_cvt_pk_bf16_f32 v68, v40, v41
    v_cvt_pk_bf16_f32 v69, v42, v43
    v_cvt_pk_bf16_f32 v70, v44, v45
    v_cvt_pk_bf16_f32 v71, v46, v47
    buffer_store_dwordx4 v[68:71], v5, s[8:11], s83 offen offset:1024 sc1
    v_cvt_pk_bf16_f32 v72, v48, v49
    v_cvt_pk_bf16_f32 v73, v50, v51
    v_cvt_pk_bf16_f32 v74, v52, v53
    v_cvt_pk_bf16_f32 v75, v54, v55
    s_add_u32 s31, s83, 4096
    buffer_store_dwordx4 v[72:75], v5, s[8:11], s31 offen offset:0 sc1
    v_cvt_pk_bf16_f32 v76, v56, v57
    v_cvt_pk_bf16_f32 v77, v58, v59
    v_cvt_pk_bf16_f32 v78, v60, v61
    v_cvt_pk_bf16_f32 v79, v62, v63
    buffer_store_dwordx4 v[76:79], v5, s[8:11], s31 offen offset:1024 sc1
    s_add_u32 s83, s83, 0x100000
    v_xor_b32 v6, 0x8000, v6
    s_add_u32 s84, s84, 1
    s_waitcnt vmcnt(4)
    s_sub_u32 s31, s84, 1
    s_cmp_gt_u32 s84, 2
    s_cbranch_scc1 L_g_lagKQ
    s_waitcnt vmcnt(0)
    s_mov_b32 s31, s84
L_g_lagKQ:
    v_mov_b32 v8, s31
    s_mov_b64 exec, 1
    buffer_store_dword v8, v7, s[8:11], s98 offen sc1
    s_mov_b64 exec, -1
    s_cmp_lt_u32 s84, 16
    s_cbranch_scc1 L_g_loopKQ
    s_branch L_g_done
L_g_V:
L_g_loopV:
    s_barrier
    s_cmp_lt_u32 s84, 15
    s_cbranch_scc0 L_g_nodmaV
    s_mov_b32 s31, s80
    s_mov_b32 s45, s81
    s_mov_b32 m0, s45
    s_nop 0
    buffer_load_dwordx4 v4, s[20:23], s31 offen lds
    s_add_u32 s31, s31, 64
    s_add_u32 s45, s45, 0x400
    s_mov_b32 m0, s45
    s_nop 0
    buffer_load_dwordx4 v4, s[20:23], s31 offen lds
    s_add_u32 s31, s31, 64
    s_add_u32 s45, s45, 0x400
    s_mov_b32 m0, s45
    s_nop 0
    buffer_load_dwordx4 v4, s[20:23], s31 offen lds
    s_add_u32 s31, s31, 64
    s_add_u32 s45, s45, 0x400
    s_mov_b32 m0, s45
    s_nop 0
    buffer_load_dwordx4 v4, s[20:23], s31 offen lds
    s_add_u32 s31, s31, 64
    s_add_u32 s45, s45, 0x400
    s_mov_b32 m0, s45
    s_nop 0
    buffer_load_dwordx4 v4, s[20:23], s31 offen lds
    s_add_u32 s31, s31, 64
    s_add_u32 s45, s45, 0x400
    s_mov_b32 m0, s45
    s_nop 0
    buffer_load_dwordx4 v4, s[20:23], s31 offen lds
    s_add_u32 s31, s31, 64
    s_add_u32 s45, s45, 0x400
    s_mov_b32 m0, s45
    s_nop 0
    buffer_load_dwordx4 v4, s[20:23], s31 offen lds
    s_add_u32 s31, s31, 64
    s_add_u32 s45, s45, 0x400
    s_mov_b32 m0, s45
    s_nop 0
    buffer_load_dwordx4 v4, s[20:23], s31 offen lds
    s_add_u32 s80, s80, 0x20000
    s_xor_b32 s81, s81, 0x8000
L_g_nodmaV:
    ds_read_b128 v[16:19], v6 offset:0
    ds_read_b128 v[20:23], v6 offset:1024
    ds_read_b128 v[24:27], v6 offset:2048
    ds_read_b128 v[28:31], v6 offset:3072
    s_waitcnt lgkmcnt(3)
    v_mfma_f32_16x16x32_bf16 v[32:35], v[16:19], a[0:3], 0
    v_mfma_f32_16x16x32_bf16 v[36:39], v[16:19], a[64:67], 0
    v_mfma_f32_16x16x32_bf16 v[40:43], v[16:19], a[128:131], 0
    v_mfma_f32_16x16x32_bf16 v[44:47], v[16:19], a[192:195], 0
    ds_read_b128 v[16:19], v6 offset:4096
    s_waitcnt lgkmcnt(3)
    v_mfma_f32_16x16x32_bf16 v[32:35], v[20:23], a[4:7], v[32:35]
    v_mfma_f32_16x16x32_bf16 v[36:39], v[20:23], a[68:71], v[36:39]
    v_mfma_f32_16x16x32_bf16 v[40:43], v[20:23], a[132:135], v[40:43]
    v_mfma_f32_16x16x32_bf16 v[44:47], v[20:23], a[196:199], v[44:47]
    ds_read_b128 v[20:23], v6 offset:5120
    s_waitcnt lgkmcnt(3)
    v_mfma_f32_16x16x32_bf16 v[32:35], v[24:27], a[8:11], v[32:35]
    v_mfma_f32_16x16x32_bf16 v[36:39], v[24:27], a[72:75], v[36:39]
    v_mfma_f32_16x16x32_bf16 v[40:43], v[24:27], a[136:139], v[40:43]
    v_mfma_f32_16x16x32_bf16 v[44:47], v[24:27], a[200:203], v[44:47]
    ds_read_b128 v[24:27], v6 offset:6144
    s_waitcnt lgkmcnt(3)
    v_mfma_f32_16x16x32_bf16 v[32:35], v[28:31], a[12:15], v[32:35]
    v_mfma_f32_16x16x32_bf16 v[36:39], v[28:31], a[76:79], v[36:39]
    v_mfma_f32_16x16x32_bf16 v[40:43], v[28:31], a[140:143], v[40:43]
    v_mfma_f32_16x16x32_bf16 v[44:47], v[28:31], a[204:207], v[44:47]
    ds_read_b128 v[28:31], v6 offset:7168
    s_waitcnt lgkmcnt(3)
    v_mfma_f32_16x16x32_bf16 v[32:35], v[16:19], a[16:19], v[32:35]
    v_mfma_f32_16x16x32_bf16 v[36:39], v[16:19], a[80:83], v[36:39]
    v_mfma_f32_16x16x32_bf16 v[40:43], v[16:19], a[144:147], v[40:43]
    v_mfma_f32_16x16x32_bf16 v[44:47], v[16:19], a[208:211], v[44:47]
    ds_read_b128 v[16:19], v6 offset:8192
    s_waitcnt lgkmcnt(3)
    v_mfma_f32_16x16x32_bf16 v[32:35], v[20:23], a[20:23], v[32:35]
    v_mfma_f32_16x16x32_bf16 v[36:39], v[20:23], a[84:87], v[36:39]
    v_mfma_f32_16x16x32_bf16 v[40:43], v[20:23], a[148:151], v[40:43]
    v_mfma_f32_16x16x32_bf16 v[44:47], v[20:23], a[212:215], v[44:47]
    ds_read_b128 v[20:23], v6 offset:9216
    s_waitcnt lgkmcnt(3)
    v_mfma_f32_16x16x32_bf16 v[32:35], v[24:27], a[24:27], v[32:35]
    v_mfma_f32_16x16x32_bf16 v[36:39], v[24:27], a[88:91], v[36:39]
    v_mfma_f32_16x16x32_bf16 v[40:43], v[24:27], a[152:155], v[40:43]
    v_mfma_f32_16x16x32_bf16 v[44:47], v[24:27], a[216:219], v[44:47]
    ds_read_b128 v[24:27], v6 offset:10240
    s_waitcnt lgkmcnt(3)
    v_mfma_f32_16x16x32_bf16 v[32:35], v[28:31], a[28:31], v[32:35]
    v_mfma_f32_16x16x32_bf16 v[36:39], v[28:31], a[92:95], v[36:39]
    v_mfma_f32_16x16x32_bf16 v[40:43], v[28:31], a[156:159], v[40:43]
    v_mfma_f32_16x16x32_bf16 v[44:47], v[28:31], a[220:223], v[44:47]
    ds_read_b128 v[28:31], v6 offset:11264
    s_waitcnt lgkmcnt(3)
    v_mfma_f32_16x16x32_bf16 v[32:35], v[16:19], a[32:35], v[32:35]
    v_mfma_f32_16x16x32_bf16 v[36:39], v[16:19], a[96:99], v[36:39]
    v_mfma_f32_16x16x32_bf16 v[40:43], v[16:19], a[160:163], v[40:43]
    v_mfma_f32_16x16x32_bf16 v[44:47], v[16:19], a[224:227], v[44:47]
    ds_read_b128 v[16:19], v6 offset:12288
    s_waitcnt lgkmcnt(3)
    v_mfma_f32_16x16x32_bf16 v[32:35], v[20:23], a[36:39], v[32:35]
    v_mfma_f32_16x16x32_bf16 v[36:39], v[20:23], a[100:103], v[36:39]
    v_mfma_f32_16x16x32_bf16 v[40:43], v[20:23], a[164:167], v[40:43]
    v_mfma_f32_16x16x32_bf16 v[44:47], v[20:23], a[228:231], v[44:47]
    ds_read_b128 v[20:23], v6 offset:13312
    s_waitcnt lgkmcnt(3)
    v_mfma_f32_16x16x32_bf16 v[32:35], v[24:27], a[40:43], v[32:35]
    v_mfma_f32_16x16x32_bf16 v[36:39], v[24:27], a[104:107], v[36:39]
    v_mfma_f32_16x16x32_bf16 v[40:43], v[24:27], a[168:171], v[40:43]
    v_mfma_f32_16x16x32_bf16 v[44:47], v[24:27], a[232:235], v[44:47]
    ds_read_b128 v[24:27], v6 offset:14336
    s_waitcnt lgkmcnt(3)
    v_mfma_f32_16x16x32_bf16 v[32:35], v[28:31], a[44:47], v[32:35]
    v_mfma_f32_16x16x32_bf16 v[36:39], v[28:31], a[108:111], v[36:39]
    v_mfma_f32_16x16x32_bf16 v[40:43], v[28:31], a[172:175], v[40:43]
    v_mfma_f32_16x16x32_bf16 v[44:47], v[28:31], a[236:239], v[44:47]
    ds_read_b128 v[28:31], v6 offset:15360
    s_waitcnt lgkmcnt(3)
    v_mfma_f32_16x16x32_bf16 v[32:35], v[16:19], a[48:51], v[32:35]
    v_mfma_f32_16x16x32_bf16 v[36:39], v[16:19], a[112:115], v[36:39]
    v_mfma_f32_16x16x32_bf16 v[40:43], v[16:19], a[176:179], v[40:43]
    v_mfma_f32_16x16x32_bf16 v[44:47], v[16:19], a[240:243], v[44:47]
    ds_read_b128 v[16:19], v6 offset:16384
    s_waitcnt lgkmcnt(3)
    v_mfma_f32_16x16x32_bf16 v[32:35], v[20:23], a[52:55], v[32:35]
    v_mfma_f32_16x16x32_bf16 v[36:39], v[20:23], a[116:119], v[36:39]
    v_mfma_f32_16x16x32_bf16 v[40:43], v[20:23], a[180:183], v[40:43]
    v_mfma_f32_16x16x32_bf16 v[44:47], v[20:23], a[244:247], v[44:47]
    ds_read_b128 v[20:23], v6 offset:17408
    s_waitcnt lgkmcnt(3)
    v_mfma_f32_16x16x32_bf16 v[32:35], v[24:27], a[56:59], v[32:35]
    v_mfma_f32_16x16x32_bf16 v[36:39], v[24:27], a[120:123], v[36:39]
    v_mfma_f32_16x16x32_bf16 v[40:43], v[24:27], a[184:187], v[40:43]
    v_mfma_f32_16x16x32_bf16 v[44:47], v[24:27], a[248:251], v[44:47]
    ds_read_b128 v[24:27], v6 offset:18432
    s_waitcnt lgkmcnt(3)
    v_mfma_f32_16x16x32_bf16 v[32:35], v[28:31], a[60:63], v[32:35]
    v_mfma_f32_16x16x32_bf16 v[36:39], v[28:31], a[124:127], v[36:39]
    v_mfma_f32_16x16x32_bf16 v[40:43], v[28:31], a[188:191], v[40:43]
    v_mfma_f32_16x16x32_bf16 v[44:47], v[28:31], a[252:255], v[44:47]
    ds_read_b128 v[28:31], v6 offset:19456
    s_waitcnt lgkmcnt(3)
    v_mfma_f32_16x16x32_bf16 v[48:51], v[16:19], a[0:3], 0
    v_mfma_f32_16x16x32_bf16 v[52:55], v[16:19], a[64:67], 0
    v_mfma_f32_16x16x32_bf16 v[56:59], v[16:19], a[128:131], 0
    v_mfma_f32_16x16x32_bf16 v[60:63], v[16:19], a[192:195], 0
    ds_read_b128 v[16:19], v6 offset:20480
    s_waitcnt lgkmcnt(3)
    v_mfma_f32_16x16x32_bf16 v[48:51], v[20:23], a[4:7], v[48:51]
    v_mfma_f32_16x16x32_bf16 v[52:55], v[20:23], a[68:71], v[52:55]
    v_mfma_f32_16x16x32_bf16 v[56:59], v[20:23], a[132:135], v[56:59]
    v_mfma_f32_16x16x32_bf16 v[60:63], v[20:23], a[196:199], v[60:63]
    ds_read_b128 v[20:23], v6 offset:21504
    s_waitcnt lgkmcnt(3)
    v_mfma_f32_16x16x32_bf16 v[48:51], v[24:27], a[8:11], v[48:51]
    v_mfma_f32_16x16x32_bf16 v[52:55], v[24:27], a[72:75], v[52:55]
    v_mfma_f32_16x16x32_bf16 v[56:59], v[24:27], a[136:139], v[56:59]
    v_mfma_f32_16x16x32_bf16 v[60:63], v[24:27], a[200:203], v[60:63]
    ds_read_b128 v[24:27], v6 offset:22528
    s_waitcnt lgkmcnt(3)
    v_mfma_f32_16x16x32_bf16 v[48:51], v[28:31], a[12:15], v[48:51]
    v_mfma_f32_16x16x32_bf16 v[52:55], v[28:31], a[76:79], v[52:55]
    v_mfma_f32_16x16x32_bf16 v[56:59], v[28:31], a[140:143], v[56:59]
    v_mfma_f32_16x16x32_bf16 v[60:63], v[28:31], a[204:207], v[60:63]
    ds_read_b128 v[28:31], v6 offset:23552
    s_waitcnt lgkmcnt(3)
    v_mfma_f32_16x16x32_bf16 v[48:51], v[16:19], a[16:19], v[48:51]
    v_mfma_f32_16x16x32_bf16 v[52:55], v[16:19], a[80:83], v[52:55]
    v_mfma_f32_16x16x32_bf16 v[56:59], v[16:19], a[144:147], v[56:59]
    v_mfma_f32_16x16x32_bf16 v[60:63], v[16:19], a[208:211], v[60:63]
    ds_read_b128 v[16:19], v6 offset:24576
    s_waitcnt lgkmcnt(3)
    v_mfma_f32_16x16x32_bf16 v[48:51], v[20:23], a[20:23], v[48:51]
    v_mfma_f32_16x16x32_bf16 v[52:55], v[20:23], a[84:87], v[52:55]
    v_mfma_f32_16x16x32_bf16 v[56:59], v[20:23], a[148:151], v[56:59]
    v_mfma_f32_16x16x32_bf16 v[60:63], v[20:23], a[212:215], v[60:63]
    ds_read_b128 v[20:23], v6 offset:25600
    s_waitcnt lgkmcnt(3)
    v_mfma_f32_16x16x32_bf16 v[48:51], v[24:27], a[24:27], v[48:51]
    v_mfma_f32_16x16x32_bf16 v[52:55], v[24:27], a[88:91], v[52:55]
    v_mfma_f32_16x16x32_bf16 v[56:59], v[24:27], a[152:155], v[56:59]
    v_mfma_f32_16x16x32_bf16 v[60:63], v[24:27], a[216:219], v[60:63]
    ds_read_b128 v[24:27], v6 offset:26624
    s_waitcnt lgkmcnt(3)
    v_mfma_f32_16x16x32_bf16 v[48:51], v[28:31], a[28:31], v[48:51]
    v_mfma_f32_16x16x32_bf16 v[52:55], v[28:31], a[92:95], v[52:55]
    v_mfma_f32_16x16x32_bf16 v[56:59], v[28:31], a[156:159], v[56:59]
    v_mfma_f32_16x16x32_bf16 v[60:63], v[28:31], a[220:223], v[60:63]
    ds_read_b128 v[28:31], v6 offset:27648
    s_waitcnt lgkmcnt(3)
    v_mfma_f32_16x16x32_bf16 v[48:51], v[16:19], a[32:35], v[48:51]
    v_mfma_f32_16x16x32_bf16 v[52:55], v[16:19], a[96:99], v[52:55]
    v_mfma_f32_16x16x32_bf16 v[56:59], v[16:19], a[160:163], v[56:59]
    v_mfma_f32_16x16x32_bf16 v[60:63], v[16:19], a[224:227], v[60:63]
    ds_read_b128 v[16:19], v6 offset:28672
    s_waitcnt lgkmcnt(3)
    v_mfma_f32_16x16x32_bf16 v[48:51], v[20:23], a[36:39], v[48:51]
    v_mfma_f32_16x16x32_bf16 v[52:55], v[20:23], a[100:103], v[52:55]
    v_mfma_f32_16x16x32_bf16 v[56:59], v[20:23], a[164:167], v[56:59]
    v_mfma_f32_16x16x32_bf16 v[60:63], v[20:23], a[228:231], v[60:63]
    ds_read_b128 v[20:23], v6 offset:29696
    s_waitcnt lgkmcnt(3)
    v_mfma_f32_16x16x32_bf16 v[48:51], v[24:27], a[40:43], v[48:51]
    v_mfma_f32_16x16x32_bf16 v[52:55], v[24:27], a[104:107], v[52:55]
    v_mfma_f32_16x16x32_bf16 v[56:59], v[24:27], a[168:171], v[56:59]
    v_mfma_f32_16x16x32_bf16 v[60:63], v[24:27], a[232:235], v[60:63]
    ds_read_b128 v[24:27], v6 offset:30720
    s_waitcnt lgkmcnt(3)
    v_mfma_f32_16x16x32_bf16 v[48:51], v[28:31], a[44:47], v[48:51]
    v_mfma_f32_16x16x32_bf16 v[52:55], v[28:31], a[108:111], v[52:55]
    v_mfma_f32_16x16x32_bf16 v[56:59], v[28:31], a[172:175], v[56:59]
    v_mfma_f32_16x16x32_bf16 v[60:63], v[28:31], a[236:239], v[60:63]
    ds_read_b128 v[28:31], v6 offset:31744
    s_waitcnt lgkmcnt(3)
    v_mfma_f32_16x16x32_bf16 v[48:51], v[16:19], a[48:51], v[48:51]
    v_mfma_f32_16x16x32_bf16 v[52:55], v[16:19], a[112:115], v[52:55]
    v_mfma_f32_16x16x32_bf16 v[56:59], v[16:19], a[176:179], v[56:59]
    v_mfma_f32_16x16x32_bf16 v[60:63], v[16:19], a[240:243], v[60:63]
    s_waitcnt lgkmcnt(2)
    v_mfma_f32_16x16x32_bf16 v[48:51], v[20:23], a[52:55], v[48:51]
    v_mfma_f32_16x16x32_bf16 v[52:55], v[20:23], a[116:119], v[52:55]
    v_mfma_f32_16x16x32_bf16 v[56:59], v[20:23], a[180:183], v[56:59]
    v_mfma_f32_16x16x32_bf16 v[60:63], v[20:23], a[244:247], v[60:63]
    s_waitcnt lgkmcnt(1)
    v_mfma_f32_16x16x32_bf16 v[48:51], v[24:27], a[56:59], v[48:51]
    v_mfma_f32_16x16x32_bf16 v[52:55], v[24:27], a[120:123], v[52:55]
    v_mfma_f32_16x16x32_bf16 v[56:59], v[24:27], a[184:187], v[56:59]
    v_mfma_f32_16x16x32_bf16 v[60:63], v[24:27], a[248:251], v[60:63]
    s_waitcnt lgkmcnt(0)
    v_mfma_f32_16x16x32_bf16 v[48:51], v[28:31], a[60:63], v[48:51]
    v_mfma_f32_16x16x32_bf16 v[52:55], v[28:31], a[124:127], v[52:55]
    v_mfma_f32_16x16x32_bf16 v[56:59], v[28:31], a[188:191], v[56:59]
    v_mfma_f32_16x16x32_bf16 v[60:63], v[28:31], a[252:255], v[60:63]
    v_cvt_pk_bf16_f32 v64, v32, v33
    v_cvt_pk_bf16_f32 v65, v34, v35
    v_cvt_pk_bf16_f32 v66, v48, v49
    v_cvt_pk_bf16_f32 v67, v50, v51
    buffer_store_dwordx4 v[64:67], v5, s[8:11], s83 offen offset:0 sc1
    v_cvt_pk_bf16_f32 v68, v36, v37
    v_cvt_pk_bf16_f32 v69, v38, v39
    v_cvt_pk_bf16_f32 v70, v52, v53
    v_cvt_pk_bf16_f32 v71, v54, v55
    buffer_store_dwordx4 v[68:71], v5, s[8:11], s83 offen offset:1024 sc1
    v_cvt_pk_bf16_f32 v72, v40, v41
    v_cvt_pk_bf16_f32 v73, v42, v43
    v_cvt_pk_bf16_f32 v74, v56, v57
    v_cvt_pk_bf16_f32 v75, v58, v59
    buffer_store_dwordx4 v[72:75], v5, s[8:11], s83 offen offset:2048 sc1
    v_cvt_pk_bf16_f32 v76, v44, v45
    v_cvt_pk_bf16_f32 v77, v46, v47
    v_cvt_pk_bf16_f32 v78, v60, v61
    v_cvt_pk_bf16_f32 v79, v62, v63
    buffer_store_dwordx4 v[76:79], v5, s[8:11], s83 offen offset:3072 sc1
    s_add_u32 s83, s83, 0x100000
    v_xor_b32 v6, 0x8000, v6
    s_add_u32 s84, s84, 1
    s_waitcnt vmcnt(4)
    s_sub_u32 s31, s84, 1
    s_cmp_gt_u32 s84, 2
    s_cbranch_scc1 L_g_lagV
    s_waitcnt vmcnt(0)
    s_mov_b32 s31, s84
L_g_lagV:
    v_mov_b32 v8, s31
    s_mov_b64 exec, 1
    buffer_store_dword v8, v7, s[8:11], s98 offen sc1
    s_mov_b64 exec, -1
    s_cmp_lt_u32 s84, 16
    s_cbranch_scc1 L_g_loopV
L_g_done:
    s_waitcnt vmcnt(0)
    v_mov_b32 v8, 16
    s_mov_b64 exec, 1
    buffer_store_dword v8, v7, s[8:11], s98 offen sc1
    s_mov_b64 exec, -1
    s_cmp_lt_u32 s99, 160
    s_cbranch_scc1 L_oproj
    s_sub_u32 s99, s99, 128
    s_branch L_attn
L_moe:
    s_sub_u32 s99, s99, 192
    s_load_dwordx2 s[82:83], s[0:1], 64
    s_load_dwordx2 s[84:85], s[0:1], 96
    s_waitcnt lgkmcnt(0)
    s_lshl_b32 s76, s99, 2
    s_add_u32 s76, s76, s25
    v_and_b32 v1, 63, v0
    v_and_b32 v2, 15, v0
    v_bfe_u32 v3, v0, 4, 2
    v_lshlrev_b32 v4, 4, v1
    s_mov_b32 s16, s82
    s_and_b32 s17, s83, 0xffff
    s_mov_b32 s18, 0x400
    s_mov_b32 s19, 0x20000
    buffer_load_dwordx4 v[8:11], v4, s[16:19], 0 offen
    s_waitcnt vmcnt(0)
    s_mov_b32 s16, s84
    s_and_b32 s17, s85, 0xffff
    s_mov_b32 s18, 0x400
    s_mov_b32 s19, 0x20000
    buffer_load_dwordx4 v[12:15], v4, s[16:19], 0 offen
    s_lshl_b32 s78, s76, 14
    s_add_u32 s31, s78, 0
    buffer_load_dwordx4 v[32:35], v4, s[20:23], s31 offen offset:0
    buffer_load_dwordx4 v[36:39], v4, s[20:23], s31 offen offset:1024
    buffer_load_dwordx4 v[40:43], v4, s[20:23], s31 offen offset:2048
    buffer_load_dwordx4 v[44:47], v4, s[20:23], s31 offen offset:3072
    s_add_u32 s31, s78, 4096
    buffer_load_dwordx4 v[48:51], v4, s[20:23], s31 offen offset:0
    buffer_load_dwordx4 v[52:55], v4, s[20:23], s31 offen offset:1024
    buffer_load_dwordx4 v[56:59], v4, s[20:23], s31 offen offset:2048
    buffer_load_dwordx4 v[60:63], v4, s[20:23], s31 offen offset:3072
    s_add_u32 s31, s78, 8192
    buffer_load_dwordx4 v[64:67], v4, s[20:23], s31 offen offset:0
    buffer_load_dwordx4 v[68:71], v4, s[20:23], s31 offen offset:1024
    buffer_load_dwordx4 v[72:75], v4, s[20:23], s31 offen offset:2048
    buffer_load_dwordx4 v[76:79], v4, s[20:23], s31 offen offset:3072
    s_add_u32 s31, s78, 12288
    buffer_load_dwordx4 v[80:83], v4, s[20:23], s31 offen offset:0
    buffer_load_dwordx4 v[84:87], v4, s[20:23], s31 offen offset:1024
    buffer_load_dwordx4 v[88:91], v4, s[20:23], s31 offen offset:2048
    buffer_load_dwordx4 v[92:95], v4, s[20:23], s31 offen offset:3072
    s_mov_b32 s79, 0xbfb8aa3b
    v_lshlrev_b32 v16, 16, v8
    v_and_b32 v17, 0xffff0000, v8
    v_lshlrev_b32 v18, 16, v9
    v_and_b32 v19, 0xffff0000, v9
    v_lshlrev_b32 v20, 16, v10
    v_and_b32 v21, 0xffff0000, v10
    v_lshlrev_b32 v22, 16, v11
    v_and_b32 v23, 0xffff0000, v11
    s_waitcnt vmcnt(16)
    v_lshlrev_b32 v24, 16, v12
    v_and_b32 v25, 0xffff0000, v12
    v_lshlrev_b32 v26, 16, v13
    v_and_b32 v27, 0xffff0000, v13
    v_lshlrev_b32 v28, 16, v14
    v_and_b32 v29, 0xffff0000, v14
    v_lshlrev_b32 v30, 16, v15
    v_and_b32 v31, 0xffff0000, v15
    v_mov_b32 v112, 0
    v_mov_b32 v113, 0
    s_waitcnt vmcnt(15)
    v_lshlrev_b32 v96, 16, v32
    v_and_b32 v97, 0xffff0000, v32
    v_lshlrev_b32 v98, 16, v33
    v_and_b32 v99, 0xffff0000, v33
    v_lshlrev_b32 v100, 16, v34
    v_and_b32 v101, 0xffff0000, v34
    v_lshlrev_b32 v102, 16, v35
    v_and_b32 v103, 0xffff0000, v35
    v_pk_mul_f32 v[104:105], v[96:97], v[16:17]
    v_pk_fma_f32 v[104:105], v[98:99], v[18:19], v[104:105]
    v_pk_fma_f32 v[104:105], v[100:101], v[20:21], v[104:105]
    v_pk_fma_f32 v[104:105], v[102:103], v[22:23], v[104:105]
    v_add_f32 v104, v104, v105
    v_pk_mul_f32 v[96:97], v[96:97], v[24:25]
    v_cvt_pk_bf16_f32 v107, v96, v97
    v_lshlrev_b32 v96, 16, v107
    v_and_b32 v97, 0xffff0000, v107
    v_pk_mul_f32 v[98:99], v[98:99], v[26:27]
    v_cvt_pk_bf16_f32 v107, v98, v99
    v_lshlrev_b32 v98, 16, v107
    v_and_b32 v99, 0xffff0000, v107
    v_pk_mul_f32 v[100:101], v[100:101], v[28:29]
    v_cvt_pk_bf16_f32 v107, v100, v101
    v_lshlrev_b32 v100, 16, v107
    v_and_b32 v101, 0xffff0000, v107
    v_pk_mul_f32 v[102:103], v[102:103], v[30:31]
    v_cvt_pk_bf16_f32 v107, v102, v103
    v_lshlrev_b32 v102, 16, v107
    v_and_b32 v103, 0xffff0000, v107
    v_pk_add_f32 v[96:97], v[96:97], v[98:99]
    v_pk_add_f32 v[100:101], v[100:101], v[102:103]
    v_pk_add_f32 v[96:97], v[96:97], v[100:101]
    v_add_f32 v105, v96, v97
    v_add_f32_dpp v104, v104, v104 row_ror:8 row_mask:0xf bank_mask:0xf
    s_nop 1
    v_add_f32_dpp v104, v104, v104 row_ror:4 row_mask:0xf bank_mask:0xf
    s_nop 1
    v_add_f32_dpp v104, v104, v104 row_ror:2 row_mask:0xf bank_mask:0xf
    s_nop 1
    v_add_f32_dpp v104, v104, v104 row_ror:1 row_mask:0xf bank_mask:0xf
    v_mov_b32 v107, v104
    s_nop 1
    v_permlane16_swap_b32 v104, v107
    v_add_f32 v104, v104, v107
    v_mov_b32 v107, v104
    s_nop 1
    v_permlane32_swap_b32 v104, v107
    v_add_f32 v104, v104, v107
    v_add_f32_dpp v105, v105, v105 row_ror:8 row_mask:0xf bank_mask:0xf
    s_nop 1
    v_add_f32_dpp v105, v105, v105 row_ror:4 row_mask:0xf bank_mask:0xf
    s_nop 1
    v_add_f32_dpp v105, v105, v105 row_ror:2 row_mask:0xf bank_mask:0xf
    s_nop 1
    v_add_f32_dpp v105, v105, v105 row_ror:1 row_mask:0xf bank_mask:0xf
    v_mov_b32 v107, v105
    s_nop 1
    v_permlane16_swap_b32 v105, v107
    v_add_f32 v105, v105, v107
    v_mov_b32 v107, v105
    s_nop 1
    v_permlane32_swap_b32 v105, v107
    v_add_f32 v105, v105, v107
    v_cmp_eq_u32 vcc, 0, v1
    s_nop 1
    v_cndmask_b32 v112, v112, v104, vcc
    v_cndmask_b32 v113, v113, v105, vcc
    s_waitcnt vmcnt(14)
    v_lshlrev_b32 v96, 16, v36
    v_and_b32 v97, 0xffff0000, v36
    v_lshlrev_b32 v98, 16, v37
    v_and_b32 v99, 0xffff0000, v37
    v_lshlrev_b32 v100, 16, v38
    v_and_b32 v101, 0xffff0000, v38
    v_lshlrev_b32 v102, 16, v39
    v_and_b32 v103, 0xffff0000, v39
    v_pk_mul_f32 v[104:105], v[96:97], v[16:17]
    v_pk_fma_f32 v[104:105], v[98:99], v[18:19], v[104:105]
    v_pk_fma_f32 v[104:105], v[100:101], v[20:21], v[104:105]
    v_pk_fma_f32 v[104:105], v[102:103], v[22:23], v[104:105]
    v_add_f32 v104, v104, v105
    v_pk_mul_f32 v[96:97], v[96:97], v[24:25]
    v_cvt_pk_bf16_f32 v107, v96, v97
    v_lshlrev_b32 v96, 16, v107
    v_and_b32 v97, 0xffff0000, v107
    v_pk_mul_f32 v[98:99], v[98:99], v[26:27]
    v_cvt_pk_bf16_f32 v107, v98, v99
    v_lshlrev_b32 v98, 16, v107
    v_and_b32 v99, 0xffff0000, v107
    v_pk_mul_f32 v[100:101], v[100:101], v[28:29]
    v_cvt_pk_bf16_f32 v107, v100, v101
    v_lshlrev_b32 v100, 16, v107
    v_and_b32 v101, 0xffff0000, v107
    v_pk_mul_f32 v[102:103], v[102:103], v[30:31]
    v_cvt_pk_bf16_f32 v107, v102, v103
    v_lshlrev_b32 v102, 16, v107
    v_and_b32 v103, 0xffff0000, v107
    v_pk_add_f32 v[96:97], v[96:97], v[98:99]
    v_pk_add_f32 v[100:101], v[100:101], v[102:103]
    v_pk_add_f32 v[96:97], v[96:97], v[100:101]
    v_add_f32 v105, v96, v97
    v_add_f32_dpp v104, v104, v104 row_ror:8 row_mask:0xf bank_mask:0xf
    s_nop 1
    v_add_f32_dpp v104, v104, v104 row_ror:4 row_mask:0xf bank_mask:0xf
    s_nop 1
    v_add_f32_dpp v104, v104, v104 row_ror:2 row_mask:0xf bank_mask:0xf
    s_nop 1
    v_add_f32_dpp v104, v104, v104 row_ror:1 row_mask:0xf bank_mask:0xf
    v_mov_b32 v107, v104
    s_nop 1
    v_permlane16_swap_b32 v104, v107
    v_add_f32 v104, v104, v107
    v_mov_b32 v107, v104
    s_nop 1
    v_permlane32_swap_b32 v104, v107
    v_add_f32 v104, v104, v107
    v_add_f32_dpp v105, v105, v105 row_ror:8 row_mask:0xf bank_mask:0xf
    s_nop 1
    v_add_f32_dpp v105, v105, v105 row_ror:4 row_mask:0xf bank_mask:0xf
    s_nop 1
    v_add_f32_dpp v105, v105, v105 row_ror:2 row_mask:0xf bank_mask:0xf
    s_nop 1
    v_add_f32_dpp v105, v105, v105 row_ror:1 row_mask:0xf bank_mask:0xf
    v_mov_b32 v107, v105
    s_nop 1
    v_permlane16_swap_b32 v105, v107
    v_add_f32 v105, v105, v107
    v_mov_b32 v107, v105
    s_nop 1
    v_permlane32_swap_b32 v105, v107
    v_add_f32 v105, v105, v107
    v_cmp_eq_u32 vcc, 1, v1
    s_nop 1
    v_cndmask_b32 v112, v112, v104, vcc
    v_cndmask_b32 v113, v113, v105, vcc
    s_waitcnt vmcnt(13)
    v_lshlrev_b32 v96, 16, v40
    v_and_b32 v97, 0xffff0000, v40
    v_lshlrev_b32 v98, 16, v41
    v_and_b32 v99, 0xffff0000, v41
    v_lshlrev_b32 v100, 16, v42
    v_and_b32 v101, 0xffff0000, v42
    v_lshlrev_b32 v102, 16, v43
    v_and_b32 v103, 0xffff0000, v43
    v_pk_mul_f32 v[104:105], v[96:97], v[16:17]
    v_pk_fma_f32 v[104:105], v[98:99], v[18:19], v[104:105]
    v_pk_fma_f32 v[104:105], v[100:101], v[20:21], v[104:105]
    v_pk_fma_f32 v[104:105], v[102:103], v[22:23], v[104:105]
    v_add_f32 v104, v104, v105
    v_pk_mul_f32 v[96:97], v[96:97], v[24:25]
    v_cvt_pk_bf16_f32 v107, v96, v97
    v_lshlrev_b32 v96, 16, v107
    v_and_b32 v97, 0xffff0000, v107
    v_pk_mul_f32 v[98:99], v[98:99], v[26:27]
    v_cvt_pk_bf16_f32 v107, v98, v99
    v_lshlrev_b32 v98, 16, v107
    v_and_b32 v99, 0xffff0000, v107
    v_pk_mul_f32 v[100:101], v[100:101], v[28:29]
    v_cvt_pk_bf16_f32 v107, v100, v101
    v_lshlrev_b32 v100, 16, v107
    v_and_b32 v101, 0xffff0000, v107
    v_pk_mul_f32 v[102:103], v[102:103], v[30:31]
    v_cvt_pk_bf16_f32 v107, v102, v103
    v_lshlrev_b32 v102, 16, v107
    v_and_b32 v103, 0xffff0000, v107
    v_pk_add_f32 v[96:97], v[96:97], v[98:99]
    v_pk_add_f32 v[100:101], v[100:101], v[102:103]
    v_pk_add_f32 v[96:97], v[96:97], v[100:101]
    v_add_f32 v105, v96, v97
    v_add_f32_dpp v104, v104, v104 row_ror:8 row_mask:0xf bank_mask:0xf
    s_nop 1
    v_add_f32_dpp v104, v104, v104 row_ror:4 row_mask:0xf bank_mask:0xf
    s_nop 1
    v_add_f32_dpp v104, v104, v104 row_ror:2 row_mask:0xf bank_mask:0xf
    s_nop 1
    v_add_f32_dpp v104, v104, v104 row_ror:1 row_mask:0xf bank_mask:0xf
    v_mov_b32 v107, v104
    s_nop 1
    v_permlane16_swap_b32 v104, v107
    v_add_f32 v104, v104, v107
    v_mov_b32 v107, v104
    s_nop 1
    v_permlane32_swap_b32 v104, v107
    v_add_f32 v104, v104, v107
    v_add_f32_dpp v105, v105, v105 row_ror:8 row_mask:0xf bank_mask:0xf
    s_nop 1
    v_add_f32_dpp v105, v105, v105 row_ror:4 row_mask:0xf bank_mask:0xf
    s_nop 1
    v_add_f32_dpp v105, v105, v105 row_ror:2 row_mask:0xf bank_mask:0xf
    s_nop 1
    v_add_f32_dpp v105, v105, v105 row_ror:1 row_mask:0xf bank_mask:0xf
    v_mov_b32 v107, v105
    s_nop 1
    v_permlane16_swap_b32 v105, v107
    v_add_f32 v105, v105, v107
    v_mov_b32 v107, v105
    s_nop 1
    v_permlane32_swap_b32 v105, v107
    v_add_f32 v105, v105, v107
    v_cmp_eq_u32 vcc, 2, v1
    s_nop 1
    v_cndmask_b32 v112, v112, v104, vcc
    v_cndmask_b32 v113, v113, v105, vcc
    s_waitcnt vmcnt(12)
    v_lshlrev_b32 v96, 16, v44
    v_and_b32 v97, 0xffff0000, v44
    v_lshlrev_b32 v98, 16, v45
    v_and_b32 v99, 0xffff0000, v45
    v_lshlrev_b32 v100, 16, v46
    v_and_b32 v101, 0xffff0000, v46
    v_lshlrev_b32 v102, 16, v47
    v_and_b32 v103, 0xffff0000, v47
    v_pk_mul_f32 v[104:105], v[96:97], v[16:17]
    v_pk_fma_f32 v[104:105], v[98:99], v[18:19], v[104:105]
    v_pk_fma_f32 v[104:105], v[100:101], v[20:21], v[104:105]
    v_pk_fma_f32 v[104:105], v[102:103], v[22:23], v[104:105]
    v_add_f32 v104, v104, v105
    v_pk_mul_f32 v[96:97], v[96:97], v[24:25]
    v_cvt_pk_bf16_f32 v107, v96, v97
    v_lshlrev_b32 v96, 16, v107
    v_and_b32 v97, 0xffff0000, v107
    v_pk_mul_f32 v[98:99], v[98:99], v[26:27]
    v_cvt_pk_bf16_f32 v107, v98, v99
    v_lshlrev_b32 v98, 16, v107
    v_and_b32 v99, 0xffff0000, v107
    v_pk_mul_f32 v[100:101], v[100:101], v[28:29]
    v_cvt_pk_bf16_f32 v107, v100, v101
    v_lshlrev_b32 v100, 16, v107
    v_and_b32 v101, 0xffff0000, v107
    v_pk_mul_f32 v[102:103], v[102:103], v[30:31]
    v_cvt_pk_bf16_f32 v107, v102, v103
    v_lshlrev_b32 v102, 16, v107
    v_and_b32 v103, 0xffff0000, v107
    v_pk_add_f32 v[96:97], v[96:97], v[98:99]
    v_pk_add_f32 v[100:101], v[100:101], v[102:103]
    v_pk_add_f32 v[96:97], v[96:97], v[100:101]
    v_add_f32 v105, v96, v97
    v_add_f32_dpp v104, v104, v104 row_ror:8 row_mask:0xf bank_mask:0xf
    s_nop 1
    v_add_f32_dpp v104, v104, v104 row_ror:4 row_mask:0xf bank_mask:0xf
    s_nop 1
    v_add_f32_dpp v104, v104, v104 row_ror:2 row_mask:0xf bank_mask:0xf
    s_nop 1
    v_add_f32_dpp v104, v104, v104 row_ror:1 row_mask:0xf bank_mask:0xf
    v_mov_b32 v107, v104
    s_nop 1
    v_permlane16_swap_b32 v104, v107
    v_add_f32 v104, v104, v107
    v_mov_b32 v107, v104
    s_nop 1
    v_permlane32_swap_b32 v104, v107
    v_add_f32 v104, v104, v107
    v_add_f32_dpp v105, v105, v105 row_ror:8 row_mask:0xf bank_mask:0xf
    s_nop 1
    v_add_f32_dpp v105, v105, v105 row_ror:4 row_mask:0xf bank_mask:0xf
    s_nop 1
    v_add_f32_dpp v105, v105, v105 row_ror:2 row_mask:0xf bank_mask:0xf
    s_nop 1
    v_add_f32_dpp v105, v105, v105 row_ror:1 row_mask:0xf bank_mask:0xf
    v_mov_b32 v107, v105
    s_nop 1
    v_permlane16_swap_b32 v105, v107
    v_add_f32 v105, v105, v107
    v_mov_b32 v107, v105
    s_nop 1
    v_permlane32_swap_b32 v105, v107
    v_add_f32 v105, v105, v107
    v_cmp_eq_u32 vcc, 3, v1
    s_nop 1
    v_cndmask_b32 v112, v112, v104, vcc
    v_cndmask_b32 v113, v113, v105, vcc
    s_waitcnt vmcnt(11)
    v_lshlrev_b32 v96, 16, v48
    v_and_b32 v97, 0xffff0000, v48
    v_lshlrev_b32 v98, 16, v49
    v_and_b32 v99, 0xffff0000, v49
    v_lshlrev_b32 v100, 16, v50
    v_and_b32 v101, 0xffff0000, v50
    v_lshlrev_b32 v102, 16, v51
    v_and_b32 v103, 0xffff0000, v51
    v_pk_mul_f32 v[104:105], v[96:97], v[16:17]
    v_pk_fma_f32 v[104:105], v[98:99], v[18:19], v[104:105]
    v_pk_fma_f32 v[104:105], v[100:101], v[20:21], v[104:105]
    v_pk_fma_f32 v[104:105], v[102:103], v[22:23], v[104:105]
    v_add_f32 v104, v104, v105
    v_pk_mul_f32 v[96:97], v[96:97], v[24:25]
    v_cvt_pk_bf16_f32 v107, v96, v97
    v_lshlrev_b32 v96, 16, v107
    v_and_b32 v97, 0xffff0000, v107
    v_pk_mul_f32 v[98:99], v[98:99], v[26:27]
    v_cvt_pk_bf16_f32 v107, v98, v99
    v_lshlrev_b32 v98, 16, v107
    v_and_b32 v99, 0xffff0000, v107
    v_pk_mul_f32 v[100:101], v[100:101], v[28:29]
    v_cvt_pk_bf16_f32 v107, v100, v101
    v_lshlrev_b32 v100, 16, v107
    v_and_b32 v101, 0xffff0000, v107
    v_pk_mul_f32 v[102:103], v[102:103], v[30:31]
    v_cvt_pk_bf16_f32 v107, v102, v103
    v_lshlrev_b32 v102, 16, v107
    v_and_b32 v103, 0xffff0000, v107
    v_pk_add_f32 v[96:97], v[96:97], v[98:99]
    v_pk_add_f32 v[100:101], v[100:101], v[102:103]
    v_pk_add_f32 v[96:97], v[96:97], v[100:101]
    v_add_f32 v105, v96, v97
    v_add_f32_dpp v104, v104, v104 row_ror:8 row_mask:0xf bank_mask:0xf
    s_nop 1
    v_add_f32_dpp v104, v104, v104 row_ror:4 row_mask:0xf bank_mask:0xf
    s_nop 1
    v_add_f32_dpp v104, v104, v104 row_ror:2 row_mask:0xf bank_mask:0xf
    s_nop 1
    v_add_f32_dpp v104, v104, v104 row_ror:1 row_mask:0xf bank_mask:0xf
    v_mov_b32 v107, v104
    s_nop 1
    v_permlane16_swap_b32 v104, v107
    v_add_f32 v104, v104, v107
    v_mov_b32 v107, v104
    s_nop 1
    v_permlane32_swap_b32 v104, v107
    v_add_f32 v104, v104, v107
    v_add_f32_dpp v105, v105, v105 row_ror:8 row_mask:0xf bank_mask:0xf
    s_nop 1
    v_add_f32_dpp v105, v105, v105 row_ror:4 row_mask:0xf bank_mask:0xf
    s_nop 1
    v_add_f32_dpp v105, v105, v105 row_ror:2 row_mask:0xf bank_mask:0xf
    s_nop 1
    v_add_f32_dpp v105, v105, v105 row_ror:1 row_mask:0xf bank_mask:0xf
    v_mov_b32 v107, v105
    s_nop 1
    v_permlane16_swap_b32 v105, v107
    v_add_f32 v105, v105, v107
    v_mov_b32 v107, v105
    s_nop 1
    v_permlane32_swap_b32 v105, v107
    v_add_f32 v105, v105, v107
    v_cmp_eq_u32 vcc, 4, v1
    s_nop 1
    v_cndmask_b32 v112, v112, v104, vcc
    v_cndmask_b32 v113, v113, v105, vcc
    s_waitcnt vmcnt(10)
    v_lshlrev_b32 v96, 16, v52
    v_and_b32 v97, 0xffff0000, v52
    v_lshlrev_b32 v98, 16, v53
    v_and_b32 v99, 0xffff0000, v53
    v_lshlrev_b32 v100, 16, v54
    v_and_b32 v101, 0xffff0000, v54
    v_lshlrev_b32 v102, 16, v55
    v_and_b32 v103, 0xffff0000, v55
    v_pk_mul_f32 v[104:105], v[96:97], v[16:17]
    v_pk_fma_f32 v[104:105], v[98:99], v[18:19], v[104:105]
    v_pk_fma_f32 v[104:105], v[100:101], v[20:21], v[104:105]
    v_pk_fma_f32 v[104:105], v[102:103], v[22:23], v[104:105]
    v_add_f32 v104, v104, v105
    v_pk_mul_f32 v[96:97], v[96:97], v[24:25]
    v_cvt_pk_bf16_f32 v107, v96, v97
    v_lshlrev_b32 v96, 16, v107
    v_and_b32 v97, 0xffff0000, v107
    v_pk_mul_f32 v[98:99], v[98:99], v[26:27]
    v_cvt_pk_bf16_f32 v107, v98, v99
    v_lshlrev_b32 v98, 16, v107
    v_and_b32 v99, 0xffff0000, v107
    v_pk_mul_f32 v[100:101], v[100:101], v[28:29]
    v_cvt_pk_bf16_f32 v107, v100, v101
    v_lshlrev_b32 v100, 16, v107
    v_and_b32 v101, 0xffff0000, v107
    v_pk_mul_f32 v[102:103], v[102:103], v[30:31]
    v_cvt_pk_bf16_f32 v107, v102, v103
    v_lshlrev_b32 v102, 16, v107
    v_and_b32 v103, 0xffff0000, v107
    v_pk_add_f32 v[96:97], v[96:97], v[98:99]
    v_pk_add_f32 v[100:101], v[100:101], v[102:103]
    v_pk_add_f32 v[96:97], v[96:97], v[100:101]
    v_add_f32 v105, v96, v97
    v_add_f32_dpp v104, v104, v104 row_ror:8 row_mask:0xf bank_mask:0xf
    s_nop 1
    v_add_f32_dpp v104, v104, v104 row_ror:4 row_mask:0xf bank_mask:0xf
    s_nop 1
    v_add_f32_dpp v104, v104, v104 row_ror:2 row_mask:0xf bank_mask:0xf
    s_nop 1
    v_add_f32_dpp v104, v104, v104 row_ror:1 row_mask:0xf bank_mask:0xf
    v_mov_b32 v107, v104
    s_nop 1
    v_permlane16_swap_b32 v104, v107
    v_add_f32 v104, v104, v107
    v_mov_b32 v107, v104
    s_nop 1
    v_permlane32_swap_b32 v104, v107
    v_add_f32 v104, v104, v107
    v_add_f32_dpp v105, v105, v105 row_ror:8 row_mask:0xf bank_mask:0xf
    s_nop 1
    v_add_f32_dpp v105, v105, v105 row_ror:4 row_mask:0xf bank_mask:0xf
    s_nop 1
    v_add_f32_dpp v105, v105, v105 row_ror:2 row_mask:0xf bank_mask:0xf
    s_nop 1
    v_add_f32_dpp v105, v105, v105 row_ror:1 row_mask:0xf bank_mask:0xf
    v_mov_b32 v107, v105
    s_nop 1
    v_permlane16_swap_b32 v105, v107
    v_add_f32 v105, v105, v107
    v_mov_b32 v107, v105
    s_nop 1
    v_permlane32_swap_b32 v105, v107
    v_add_f32 v105, v105, v107
    v_cmp_eq_u32 vcc, 5, v1
    s_nop 1
    v_cndmask_b32 v112, v112, v104, vcc
    v_cndmask_b32 v113, v113, v105, vcc
    s_waitcnt vmcnt(9)
    v_lshlrev_b32 v96, 16, v56
    v_and_b32 v97, 0xffff0000, v56
    v_lshlrev_b32 v98, 16, v57
    v_and_b32 v99, 0xffff0000, v57
    v_lshlrev_b32 v100, 16, v58
    v_and_b32 v101, 0xffff0000, v58
    v_lshlrev_b32 v102, 16, v59
    v_and_b32 v103, 0xffff0000, v59
    v_pk_mul_f32 v[104:105], v[96:97], v[16:17]
    v_pk_fma_f32 v[104:105], v[98:99], v[18:19], v[104:105]
    v_pk_fma_f32 v[104:105], v[100:101], v[20:21], v[104:105]
    v_pk_fma_f32 v[104:105], v[102:103], v[22:23], v[104:105]
    v_add_f32 v104, v104, v105
    v_pk_mul_f32 v[96:97], v[96:97], v[24:25]
    v_cvt_pk_bf16_f32 v107, v96, v97
    v_lshlrev_b32 v96, 16, v107
    v_and_b32 v97, 0xffff0000, v107
    v_pk_mul_f32 v[98:99], v[98:99], v[26:27]
    v_cvt_pk_bf16_f32 v107, v98, v99
    v_lshlrev_b32 v98, 16, v107
    v_and_b32 v99, 0xffff0000, v107
    v_pk_mul_f32 v[100:101], v[100:101], v[28:29]
    v_cvt_pk_bf16_f32 v107, v100, v101
    v_lshlrev_b32 v100, 16, v107
    v_and_b32 v101, 0xffff0000, v107
    v_pk_mul_f32 v[102:103], v[102:103], v[30:31]
    v_cvt_pk_bf16_f32 v107, v102, v103
    v_lshlrev_b32 v102, 16, v107
    v_and_b32 v103, 0xffff0000, v107
    v_pk_add_f32 v[96:97], v[96:97], v[98:99]
    v_pk_add_f32 v[100:101], v[100:101], v[102:103]
    v_pk_add_f32 v[96:97], v[96:97], v[100:101]
    v_add_f32 v105, v96, v97
    v_add_f32_dpp v104, v104, v104 row_ror:8 row_mask:0xf bank_mask:0xf
    s_nop 1
    v_add_f32_dpp v104, v104, v104 row_ror:4 row_mask:0xf bank_mask:0xf
    s_nop 1
    v_add_f32_dpp v104, v104, v104 row_ror:2 row_mask:0xf bank_mask:0xf
    s_nop 1
    v_add_f32_dpp v104, v104, v104 row_ror:1 row_mask:0xf bank_mask:0xf
    v_mov_b32 v107, v104
    s_nop 1
    v_permlane16_swap_b32 v104, v107
    v_add_f32 v104, v104, v107
    v_mov_b32 v107, v104
    s_nop 1
    v_permlane32_swap_b32 v104, v107
    v_add_f32 v104, v104, v107
    v_add_f32_dpp v105, v105, v105 row_ror:8 row_mask:0xf bank_mask:0xf
    s_nop 1
    v_add_f32_dpp v105, v105, v105 row_ror:4 row_mask:0xf bank_mask:0xf
    s_nop 1
    v_add_f32_dpp v105, v105, v105 row_ror:2 row_mask:0xf bank_mask:0xf
    s_nop 1
    v_add_f32_dpp v105, v105, v105 row_ror:1 row_mask:0xf bank_mask:0xf
    v_mov_b32 v107, v105
    s_nop 1
    v_permlane16_swap_b32 v105, v107
    v_add_f32 v105, v105, v107
    v_mov_b32 v107, v105
    s_nop 1
    v_permlane32_swap_b32 v105, v107
    v_add_f32 v105, v105, v107
    v_cmp_eq_u32 vcc, 6, v1
    s_nop 1
    v_cndmask_b32 v112, v112, v104, vcc
    v_cndmask_b32 v113, v113, v105, vcc
    s_waitcnt vmcnt(8)
    v_lshlrev_b32 v96, 16, v60
    v_and_b32 v97, 0xffff0000, v60
    v_lshlrev_b32 v98, 16, v61
    v_and_b32 v99, 0xffff0000, v61
    v_lshlrev_b32 v100, 16, v62
    v_and_b32 v101, 0xffff0000, v62
    v_lshlrev_b32 v102, 16, v63
    v_and_b32 v103, 0xffff0000, v63
    v_pk_mul_f32 v[104:105], v[96:97], v[16:17]
    v_pk_fma_f32 v[104:105], v[98:99], v[18:19], v[104:105]
    v_pk_fma_f32 v[104:105], v[100:101], v[20:21], v[104:105]
    v_pk_fma_f32 v[104:105], v[102:103], v[22:23], v[104:105]
    v_add_f32 v104, v104, v105
    v_pk_mul_f32 v[96:97], v[96:97], v[24:25]
    v_cvt_pk_bf16_f32 v107, v96, v97
    v_lshlrev_b32 v96, 16, v107
    v_and_b32 v97, 0xffff0000, v107
    v_pk_mul_f32 v[98:99], v[98:99], v[26:27]
    v_cvt_pk_bf16_f32 v107, v98, v99
    v_lshlrev_b32 v98, 16, v107
    v_and_b32 v99, 0xffff0000, v107
    v_pk_mul_f32 v[100:101], v[100:101], v[28:29]
    v_cvt_pk_bf16_f32 v107, v100, v101
    v_lshlrev_b32 v100, 16, v107
    v_and_b32 v101, 0xffff0000, v107
    v_pk_mul_f32 v[102:103], v[102:103], v[30:31]
    v_cvt_pk_bf16_f32 v107, v102, v103
    v_lshlrev_b32 v102, 16, v107
    v_and_b32 v103, 0xffff0000, v107
    v_pk_add_f32 v[96:97], v[96:97], v[98:99]
    v_pk_add_f32 v[100:101], v[100:101], v[102:103]
    v_pk_add_f32 v[96:97], v[96:97], v[100:101]
    v_add_f32 v105, v96, v97
    v_add_f32_dpp v104, v104, v104 row_ror:8 row_mask:0xf bank_mask:0xf
    s_nop 1
    v_add_f32_dpp v104, v104, v104 row_ror:4 row_mask:0xf bank_mask:0xf
    s_nop 1
    v_add_f32_dpp v104, v104, v104 row_ror:2 row_mask:0xf bank_mask:0xf
    s_nop 1
    v_add_f32_dpp v104, v104, v104 row_ror:1 row_mask:0xf bank_mask:0xf
    v_mov_b32 v107, v104
    s_nop 1
    v_permlane16_swap_b32 v104, v107
    v_add_f32 v104, v104, v107
    v_mov_b32 v107, v104
    s_nop 1
    v_permlane32_swap_b32 v104, v107
    v_add_f32 v104, v104, v107
    v_add_f32_dpp v105, v105, v105 row_ror:8 row_mask:0xf bank_mask:0xf
    s_nop 1
    v_add_f32_dpp v105, v105, v105 row_ror:4 row_mask:0xf bank_mask:0xf
    s_nop 1
    v_add_f32_dpp v105, v105, v105 row_ror:2 row_mask:0xf bank_mask:0xf
    s_nop 1
    v_add_f32_dpp v105, v105, v105 row_ror:1 row_mask:0xf bank_mask:0xf
    v_mov_b32 v107, v105
    s_nop 1
    v_permlane16_swap_b32 v105, v107
    v_add_f32 v105, v105, v107
    v_mov_b32 v107, v105
    s_nop 1
    v_permlane32_swap_b32 v105, v107
    v_add_f32 v105, v105, v107
    v_cmp_eq_u32 vcc, 7, v1
    s_nop 1
    v_cndmask_b32 v112, v112, v104, vcc
    v_cndmask_b32 v113, v113, v105, vcc
    s_waitcnt vmcnt(7)
    v_lshlrev_b32 v96, 16, v64
    v_and_b32 v97, 0xffff0000, v64
    v_lshlrev_b32 v98, 16, v65
    v_and_b32 v99, 0xffff0000, v65
    v_lshlrev_b32 v100, 16, v66
    v_and_b32 v101, 0xffff0000, v66
    v_lshlrev_b32 v102, 16, v67
    v_and_b32 v103, 0xffff0000, v67
    v_pk_mul_f32 v[104:105], v[96:97], v[16:17]
    v_pk_fma_f32 v[104:105], v[98:99], v[18:19], v[104:105]
    v_pk_fma_f32 v[104:105], v[100:101], v[20:21], v[104:105]
    v_pk_fma_f32 v[104:105], v[102:103], v[22:23], v[104:105]
    v_add_f32 v104, v104, v105
    v_pk_mul_f32 v[96:97], v[96:97], v[24:25]
    v_cvt_pk_bf16_f32 v107, v96, v97
    v_lshlrev_b32 v96, 16, v107
    v_and_b32 v97, 0xffff0000, v107
    v_pk_mul_f32 v[98:99], v[98:99], v[26:27]
    v_cvt_pk_bf16_f32 v107, v98, v99
    v_lshlrev_b32 v98, 16, v107
    v_and_b32 v99, 0xffff0000, v107
    v_pk_mul_f32 v[100:101], v[100:101], v[28:29]
    v_cvt_pk_bf16_f32 v107, v100, v101
    v_lshlrev_b32 v100, 16, v107
    v_and_b32 v101, 0xffff0000, v107
    v_pk_mul_f32 v[102:103], v[102:103], v[30:31]
    v_cvt_pk_bf16_f32 v107, v102, v103
    v_lshlrev_b32 v102, 16, v107
    v_and_b32 v103, 0xffff0000, v107
    v_pk_add_f32 v[96:97], v[96:97], v[98:99]
    v_pk_add_f32 v[100:101], v[100:101], v[102:103]
    v_pk_add_f32 v[96:97], v[96:97], v[100:101]
    v_add_f32 v105, v96, v97
    v_add_f32_dpp v104, v104, v104 row_ror:8 row_mask:0xf bank_mask:0xf
    s_nop 1
    v_add_f32_dpp v104, v104, v104 row_ror:4 row_mask:0xf bank_mask:0xf
    s_nop 1
    v_add_f32_dpp v104, v104, v104 row_ror:2 row_mask:0xf bank_mask:0xf
    s_nop 1
    v_add_f32_dpp v104, v104, v104 row_ror:1 row_mask:0xf bank_mask:0xf
    v_mov_b32 v107, v104
    s_nop 1
    v_permlane16_swap_b32 v104, v107
    v_add_f32 v104, v104, v107
    v_mov_b32 v107, v104
    s_nop 1
    v_permlane32_swap_b32 v104, v107
    v_add_f32 v104, v104, v107
    v_add_f32_dpp v105, v105, v105 row_ror:8 row_mask:0xf bank_mask:0xf
    s_nop 1
    v_add_f32_dpp v105, v105, v105 row_ror:4 row_mask:0xf bank_mask:0xf
    s_nop 1
    v_add_f32_dpp v105, v105, v105 row_ror:2 row_mask:0xf bank_mask:0xf
    s_nop 1
    v_add_f32_dpp v105, v105, v105 row_ror:1 row_mask:0xf bank_mask:0xf
    v_mov_b32 v107, v105
    s_nop 1
    v_permlane16_swap_b32 v105, v107
    v_add_f32 v105, v105, v107
    v_mov_b32 v107, v105
    s_nop 1
    v_permlane32_swap_b32 v105, v107
    v_add_f32 v105, v105, v107
    v_cmp_eq_u32 vcc, 8, v1
    s_nop 1
    v_cndmask_b32 v112, v112, v104, vcc
    v_cndmask_b32 v113, v113, v105, vcc
    s_waitcnt vmcnt(6)
    v_lshlrev_b32 v96, 16, v68
    v_and_b32 v97, 0xffff0000, v68
    v_lshlrev_b32 v98, 16, v69
    v_and_b32 v99, 0xffff0000, v69
    v_lshlrev_b32 v100, 16, v70
    v_and_b32 v101, 0xffff0000, v70
    v_lshlrev_b32 v102, 16, v71
    v_and_b32 v103, 0xffff0000, v71
    v_pk_mul_f32 v[104:105], v[96:97], v[16:17]
    v_pk_fma_f32 v[104:105], v[98:99], v[18:19], v[104:105]
    v_pk_fma_f32 v[104:105], v[100:101], v[20:21], v[104:105]
    v_pk_fma_f32 v[104:105], v[102:103], v[22:23], v[104:105]
    v_add_f32 v104, v104, v105
    v_pk_mul_f32 v[96:97], v[96:97], v[24:25]
    v_cvt_pk_bf16_f32 v107, v96, v97
    v_lshlrev_b32 v96, 16, v107
    v_and_b32 v97, 0xffff0000, v107
    v_pk_mul_f32 v[98:99], v[98:99], v[26:27]
    v_cvt_pk_bf16_f32 v107, v98, v99
    v_lshlrev_b32 v98, 16, v107
    v_and_b32 v99, 0xffff0000, v107
    v_pk_mul_f32 v[100:101], v[100:101], v[28:29]
    v_cvt_pk_bf16_f32 v107, v100, v101
    v_lshlrev_b32 v100, 16, v107
    v_and_b32 v101, 0xffff0000, v107
    v_pk_mul_f32 v[102:103], v[102:103], v[30:31]
    v_cvt_pk_bf16_f32 v107, v102, v103
    v_lshlrev_b32 v102, 16, v107
    v_and_b32 v103, 0xffff0000, v107
    v_pk_add_f32 v[96:97], v[96:97], v[98:99]
    v_pk_add_f32 v[100:101], v[100:101], v[102:103]
    v_pk_add_f32 v[96:97], v[96:97], v[100:101]
    v_add_f32 v105, v96, v97
    v_add_f32_dpp v104, v104, v104 row_ror:8 row_mask:0xf bank_mask:0xf
    s_nop 1
    v_add_f32_dpp v104, v104, v104 row_ror:4 row_mask:0xf bank_mask:0xf
    s_nop 1
    v_add_f32_dpp v104, v104, v104 row_ror:2 row_mask:0xf bank_mask:0xf
    s_nop 1
    v_add_f32_dpp v104, v104, v104 row_ror:1 row_mask:0xf bank_mask:0xf
    v_mov_b32 v107, v104
    s_nop 1
    v_permlane16_swap_b32 v104, v107
    v_add_f32 v104, v104, v107
    v_mov_b32 v107, v104
    s_nop 1
    v_permlane32_swap_b32 v104, v107
    v_add_f32 v104, v104, v107
    v_add_f32_dpp v105, v105, v105 row_ror:8 row_mask:0xf bank_mask:0xf
    s_nop 1
    v_add_f32_dpp v105, v105, v105 row_ror:4 row_mask:0xf bank_mask:0xf
    s_nop 1
    v_add_f32_dpp v105, v105, v105 row_ror:2 row_mask:0xf bank_mask:0xf
    s_nop 1
    v_add_f32_dpp v105, v105, v105 row_ror:1 row_mask:0xf bank_mask:0xf
    v_mov_b32 v107, v105
    s_nop 1
    v_permlane16_swap_b32 v105, v107
    v_add_f32 v105, v105, v107
    v_mov_b32 v107, v105
    s_nop 1
    v_permlane32_swap_b32 v105, v107
    v_add_f32 v105, v105, v107
    v_cmp_eq_u32 vcc, 9, v1
    s_nop 1
    v_cndmask_b32 v112, v112, v104, vcc
    v_cndmask_b32 v113, v113, v105, vcc
    s_waitcnt vmcnt(5)
    v_lshlrev_b32 v96, 16, v72
    v_and_b32 v97, 0xffff0000, v72
    v_lshlrev_b32 v98, 16, v73
    v_and_b32 v99, 0xffff0000, v73
    v_lshlrev_b32 v100, 16, v74
    v_and_b32 v101, 0xffff0000, v74
    v_lshlrev_b32 v102, 16, v75
    v_and_b32 v103, 0xffff0000, v75
    v_pk_mul_f32 v[104:105], v[96:97], v[16:17]
    v_pk_fma_f32 v[104:105], v[98:99], v[18:19], v[104:105]
    v_pk_fma_f32 v[104:105], v[100:101], v[20:21], v[104:105]
    v_pk_fma_f32 v[104:105], v[102:103], v[22:23], v[104:105]
    v_add_f32 v104, v104, v105
    v_pk_mul_f32 v[96:97], v[96:97], v[24:25]
    v_cvt_pk_bf16_f32 v107, v96, v97
    v_lshlrev_b32 v96, 16, v107
    v_and_b32 v97, 0xffff0000, v107
    v_pk_mul_f32 v[98:99], v[98:99], v[26:27]
    v_cvt_pk_bf16_f32 v107, v98, v99
    v_lshlrev_b32 v98, 16, v107
    v_and_b32 v99, 0xffff0000, v107
    v_pk_mul_f32 v[100:101], v[100:101], v[28:29]
    v_cvt_pk_bf16_f32 v107, v100, v101
    v_lshlrev_b32 v100, 16, v107
    v_and_b32 v101, 0xffff0000, v107
    v_pk_mul_f32 v[102:103], v[102:103], v[30:31]
    v_cvt_pk_bf16_f32 v107, v102, v103
    v_lshlrev_b32 v102, 16, v107
    v_and_b32 v103, 0xffff0000, v107
    v_pk_add_f32 v[96:97], v[96:97], v[98:99]
    v_pk_add_f32 v[100:101], v[100:101], v[102:103]
    v_pk_add_f32 v[96:97], v[96:97], v[100:101]
    v_add_f32 v105, v96, v97
    v_add_f32_dpp v104, v104, v104 row_ror:8 row_mask:0xf bank_mask:0xf
    s_nop 1
    v_add_f32_dpp v104, v104, v104 row_ror:4 row_mask:0xf bank_mask:0xf
    s_nop 1
    v_add_f32_dpp v104, v104, v104 row_ror:2 row_mask:0xf bank_mask:0xf
    s_nop 1
    v_add_f32_dpp v104, v104, v104 row_ror:1 row_mask:0xf bank_mask:0xf
    v_mov_b32 v107, v104
    s_nop 1
    v_permlane16_swap_b32 v104, v107
    v_add_f32 v104, v104, v107
    v_mov_b32 v107, v104
    s_nop 1
    v_permlane32_swap_b32 v104, v107
    v_add_f32 v104, v104, v107
    v_add_f32_dpp v105, v105, v105 row_ror:8 row_mask:0xf bank_mask:0xf
    s_nop 1
    v_add_f32_dpp v105, v105, v105 row_ror:4 row_mask:0xf bank_mask:0xf
    s_nop 1
    v_add_f32_dpp v105, v105, v105 row_ror:2 row_mask:0xf bank_mask:0xf
    s_nop 1
    v_add_f32_dpp v105, v105, v105 row_ror:1 row_mask:0xf bank_mask:0xf
    v_mov_b32 v107, v105
    s_nop 1
    v_permlane16_swap_b32 v105, v107
    v_add_f32 v105, v105, v107
    v_mov_b32 v107, v105
    s_nop 1
    v_permlane32_swap_b32 v105, v107
    v_add_f32 v105, v105, v107
    v_cmp_eq_u32 vcc, 10, v1
    s_nop 1
    v_cndmask_b32 v112, v112, v104, vcc
    v_cndmask_b32 v113, v113, v105, vcc
    s_waitcnt vmcnt(4)
    v_lshlrev_b32 v96, 16, v76
    v_and_b32 v97, 0xffff0000, v76
    v_lshlrev_b32 v98, 16, v77
    v_and_b32 v99, 0xffff0000, v77
    v_lshlrev_b32 v100, 16, v78
    v_and_b32 v101, 0xffff0000, v78
    v_lshlrev_b32 v102, 16, v79
    v_and_b32 v103, 0xffff0000, v79
    v_pk_mul_f32 v[104:105], v[96:97], v[16:17]
    v_pk_fma_f32 v[104:105], v[98:99], v[18:19], v[104:105]
    v_pk_fma_f32 v[104:105], v[100:101], v[20:21], v[104:105]
    v_pk_fma_f32 v[104:105], v[102:103], v[22:23], v[104:105]
    v_add_f32 v104, v104, v105
    v_pk_mul_f32 v[96:97], v[96:97], v[24:25]
    v_cvt_pk_bf16_f32 v107, v96, v97
    v_lshlrev_b32 v96, 16, v107
    v_and_b32 v97, 0xffff0000, v107
    v_pk_mul_f32 v[98:99], v[98:99], v[26:27]
    v_cvt_pk_bf16_f32 v107, v98, v99
    v_lshlrev_b32 v98, 16, v107
    v_and_b32 v99, 0xffff0000, v107
    v_pk_mul_f32 v[100:101], v[100:101], v[28:29]
    v_cvt_pk_bf16_f32 v107, v100, v101
    v_lshlrev_b32 v100, 16, v107
    v_and_b32 v101, 0xffff0000, v107
    v_pk_mul_f32 v[102:103], v[102:103], v[30:31]
    v_cvt_pk_bf16_f32 v107, v102, v103
    v_lshlrev_b32 v102, 16, v107
    v_and_b32 v103, 0xffff0000, v107
    v_pk_add_f32 v[96:97], v[96:97], v[98:99]
    v_pk_add_f32 v[100:101], v[100:101], v[102:103]
    v_pk_add_f32 v[96:97], v[96:97], v[100:101]
    v_add_f32 v105, v96, v97
    v_add_f32_dpp v104, v104, v104 row_ror:8 row_mask:0xf bank_mask:0xf
    s_nop 1
    v_add_f32_dpp v104, v104, v104 row_ror:4 row_mask:0xf bank_mask:0xf
    s_nop 1
    v_add_f32_dpp v104, v104, v104 row_ror:2 row_mask:0xf bank_mask:0xf
    s_nop 1
    v_add_f32_dpp v104, v104, v104 row_ror:1 row_mask:0xf bank_mask:0xf
    v_mov_b32 v107, v104
    s_nop 1
    v_permlane16_swap_b32 v104, v107
    v_add_f32 v104, v104, v107
    v_mov_b32 v107, v104
    s_nop 1
    v_permlane32_swap_b32 v104, v107
    v_add_f32 v104, v104, v107
    v_add_f32_dpp v105, v105, v105 row_ror:8 row_mask:0xf bank_mask:0xf
    s_nop 1
    v_add_f32_dpp v105, v105, v105 row_ror:4 row_mask:0xf bank_mask:0xf
    s_nop 1
    v_add_f32_dpp v105, v105, v105 row_ror:2 row_mask:0xf bank_mask:0xf
    s_nop 1
    v_add_f32_dpp v105, v105, v105 row_ror:1 row_mask:0xf bank_mask:0xf
    v_mov_b32 v107, v105
    s_nop 1
    v_permlane16_swap_b32 v105, v107
    v_add_f32 v105, v105, v107
    v_mov_b32 v107, v105
    s_nop 1
    v_permlane32_swap_b32 v105, v107
    v_add_f32 v105, v105, v107
    v_cmp_eq_u32 vcc, 11, v1
    s_nop 1
    v_cndmask_b32 v112, v112, v104, vcc
    v_cndmask_b32 v113, v113, v105, vcc
    s_waitcnt vmcnt(3)
    v_lshlrev_b32 v96, 16, v80
    v_and_b32 v97, 0xffff0000, v80
    v_lshlrev_b32 v98, 16, v81
    v_and_b32 v99, 0xffff0000, v81
    v_lshlrev_b32 v100, 16, v82
    v_and_b32 v101, 0xffff0000, v82
    v_lshlrev_b32 v102, 16, v83
    v_and_b32 v103, 0xffff0000, v83
    v_pk_mul_f32 v[104:105], v[96:97], v[16:17]
    v_pk_fma_f32 v[104:105], v[98:99], v[18:19], v[104:105]
    v_pk_fma_f32 v[104:105], v[100:101], v[20:21], v[104:105]
    v_pk_fma_f32 v[104:105], v[102:103], v[22:23], v[104:105]
    v_add_f32 v104, v104, v105
    v_pk_mul_f32 v[96:97], v[96:97], v[24:25]
    v_cvt_pk_bf16_f32 v107, v96, v97
    v_lshlrev_b32 v96, 16, v107
    v_and_b32 v97, 0xffff0000, v107
    v_pk_mul_f32 v[98:99], v[98:99], v[26:27]
    v_cvt_pk_bf16_f32 v107, v98, v99
    v_lshlrev_b32 v98, 16, v107
    v_and_b32 v99, 0xffff0000, v107
    v_pk_mul_f32 v[100:101], v[100:101], v[28:29]
    v_cvt_pk_bf16_f32 v107, v100, v101
    v_lshlrev_b32 v100, 16, v107
    v_and_b32 v101, 0xffff0000, v107
    v_pk_mul_f32 v[102:103], v[102:103], v[30:31]
    v_cvt_pk_bf16_f32 v107, v102, v103
    v_lshlrev_b32 v102, 16, v107
    v_and_b32 v103, 0xffff0000, v107
    v_pk_add_f32 v[96:97], v[96:97], v[98:99]
    v_pk_add_f32 v[100:101], v[100:101], v[102:103]
    v_pk_add_f32 v[96:97], v[96:97], v[100:101]
    v_add_f32 v105, v96, v97
    v_add_f32_dpp v104, v104, v104 row_ror:8 row_mask:0xf bank_mask:0xf
    s_nop 1
    v_add_f32_dpp v104, v104, v104 row_ror:4 row_mask:0xf bank_mask:0xf
    s_nop 1
    v_add_f32_dpp v104, v104, v104 row_ror:2 row_mask:0xf bank_mask:0xf
    s_nop 1
    v_add_f32_dpp v104, v104, v104 row_ror:1 row_mask:0xf bank_mask:0xf
    v_mov_b32 v107, v104
    s_nop 1
    v_permlane16_swap_b32 v104, v107
    v_add_f32 v104, v104, v107
    v_mov_b32 v107, v104
    s_nop 1
    v_permlane32_swap_b32 v104, v107
    v_add_f32 v104, v104, v107
    v_add_f32_dpp v105, v105, v105 row_ror:8 row_mask:0xf bank_mask:0xf
    s_nop 1
    v_add_f32_dpp v105, v105, v105 row_ror:4 row_mask:0xf bank_mask:0xf
    s_nop 1
    v_add_f32_dpp v105, v105, v105 row_ror:2 row_mask:0xf bank_mask:0xf
    s_nop 1
    v_add_f32_dpp v105, v105, v105 row_ror:1 row_mask:0xf bank_mask:0xf
    v_mov_b32 v107, v105
    s_nop 1
    v_permlane16_swap_b32 v105, v107
    v_add_f32 v105, v105, v107
    v_mov_b32 v107, v105
    s_nop 1
    v_permlane32_swap_b32 v105, v107
    v_add_f32 v105, v105, v107
    v_cmp_eq_u32 vcc, 12, v1
    s_nop 1
    v_cndmask_b32 v112, v112, v104, vcc
    v_cndmask_b32 v113, v113, v105, vcc
    s_waitcnt vmcnt(2)
    v_lshlrev_b32 v96, 16, v84
    v_and_b32 v97, 0xffff0000, v84
    v_lshlrev_b32 v98, 16, v85
    v_and_b32 v99, 0xffff0000, v85
    v_lshlrev_b32 v100, 16, v86
    v_and_b32 v101, 0xffff0000, v86
    v_lshlrev_b32 v102, 16, v87
    v_and_b32 v103, 0xffff0000, v87
    v_pk_mul_f32 v[104:105], v[96:97], v[16:17]
    v_pk_fma_f32 v[104:105], v[98:99], v[18:19], v[104:105]
    v_pk_fma_f32 v[104:105], v[100:101], v[20:21], v[104:105]
    v_pk_fma_f32 v[104:105], v[102:103], v[22:23], v[104:105]
    v_add_f32 v104, v104, v105
    v_pk_mul_f32 v[96:97], v[96:97], v[24:25]
    v_cvt_pk_bf16_f32 v107, v96, v97
    v_lshlrev_b32 v96, 16, v107
    v_and_b32 v97, 0xffff0000, v107
    v_pk_mul_f32 v[98:99], v[98:99], v[26:27]
    v_cvt_pk_bf16_f32 v107, v98, v99
    v_lshlrev_b32 v98, 16, v107
    v_and_b32 v99, 0xffff0000, v107
    v_pk_mul_f32 v[100:101], v[100:101], v[28:29]
    v_cvt_pk_bf16_f32 v107, v100, v101
    v_lshlrev_b32 v100, 16, v107
    v_and_b32 v101, 0xffff0000, v107
    v_pk_mul_f32 v[102:103], v[102:103], v[30:31]
    v_cvt_pk_bf16_f32 v107, v102, v103
    v_lshlrev_b32 v102, 16, v107
    v_and_b32 v103, 0xffff0000, v107
    v_pk_add_f32 v[96:97], v[96:97], v[98:99]
    v_pk_add_f32 v[100:101], v[100:101], v[102:103]
    v_pk_add_f32 v[96:97], v[96:97], v[100:101]
    v_add_f32 v105, v96, v97
    v_add_f32_dpp v104, v104, v104 row_ror:8 row_mask:0xf bank_mask:0xf
    s_nop 1
    v_add_f32_dpp v104, v104, v104 row_ror:4 row_mask:0xf bank_mask:0xf
    s_nop 1
    v_add_f32_dpp v104, v104, v104 row_ror:2 row_mask:0xf bank_mask:0xf
    s_nop 1
    v_add_f32_dpp v104, v104, v104 row_ror:1 row_mask:0xf bank_mask:0xf
    v_mov_b32 v107, v104
    s_nop 1
    v_permlane16_swap_b32 v104, v107
    v_add_f32 v104, v104, v107
    v_mov_b32 v107, v104
    s_nop 1
    v_permlane32_swap_b32 v104, v107
    v_add_f32 v104, v104, v107
    v_add_f32_dpp v105, v105, v105 row_ror:8 row_mask:0xf bank_mask:0xf
    s_nop 1
    v_add_f32_dpp v105, v105, v105 row_ror:4 row_mask:0xf bank_mask:0xf
    s_nop 1
    v_add_f32_dpp v105, v105, v105 row_ror:2 row_mask:0xf bank_mask:0xf
    s_nop 1
    v_add_f32_dpp v105, v105, v105 row_ror:1 row_mask:0xf bank_mask:0xf
    v_mov_b32 v107, v105
    s_nop 1
    v_permlane16_swap_b32 v105, v107
    v_add_f32 v105, v105, v107
    v_mov_b32 v107, v105
    s_nop 1
    v_permlane32_swap_b32 v105, v107
    v_add_f32 v105, v105, v107
    v_cmp_eq_u32 vcc, 13, v1
    s_nop 1
    v_cndmask_b32 v112, v112, v104, vcc
    v_cndmask_b32 v113, v113, v105, vcc
    s_waitcnt vmcnt(1)
    v_lshlrev_b32 v96, 16, v88
    v_and_b32 v97, 0xffff0000, v88
    v_lshlrev_b32 v98, 16, v89
    v_and_b32 v99, 0xffff0000, v89
    v_lshlrev_b32 v100, 16, v90
    v_and_b32 v101, 0xffff0000, v90
    v_lshlrev_b32 v102, 16, v91
    v_and_b32 v103, 0xffff0000, v91
    v_pk_mul_f32 v[104:105], v[96:97], v[16:17]
    v_pk_fma_f32 v[104:105], v[98:99], v[18:19], v[104:105]
    v_pk_fma_f32 v[104:105], v[100:101], v[20:21], v[104:105]
    v_pk_fma_f32 v[104:105], v[102:103], v[22:23], v[104:105]
    v_add_f32 v104, v104, v105
    v_pk_mul_f32 v[96:97], v[96:97], v[24:25]
    v_cvt_pk_bf16_f32 v107, v96, v97
    v_lshlrev_b32 v96, 16, v107
    v_and_b32 v97, 0xffff0000, v107
    v_pk_mul_f32 v[98:99], v[98:99], v[26:27]
    v_cvt_pk_bf16_f32 v107, v98, v99
    v_lshlrev_b32 v98, 16, v107
    v_and_b32 v99, 0xffff0000, v107
    v_pk_mul_f32 v[100:101], v[100:101], v[28:29]
    v_cvt_pk_bf16_f32 v107, v100, v101
    v_lshlrev_b32 v100, 16, v107
    v_and_b32 v101, 0xffff0000, v107
    v_pk_mul_f32 v[102:103], v[102:103], v[30:31]
    v_cvt_pk_bf16_f32 v107, v102, v103
    v_lshlrev_b32 v102, 16, v107
    v_and_b32 v103, 0xffff0000, v107
    v_pk_add_f32 v[96:97], v[96:97], v[98:99]
    v_pk_add_f32 v[100:101], v[100:101], v[102:103]
    v_pk_add_f32 v[96:97], v[96:97], v[100:101]
    v_add_f32 v105, v96, v97
    v_add_f32_dpp v104, v104, v104 row_ror:8 row_mask:0xf bank_mask:0xf
    s_nop 1
    v_add_f32_dpp v104, v104, v104 row_ror:4 row_mask:0xf bank_mask:0xf
    s_nop 1
    v_add_f32_dpp v104, v104, v104 row_ror:2 row_mask:0xf bank_mask:0xf
    s_nop 1
    v_add_f32_dpp v104, v104, v104 row_ror:1 row_mask:0xf bank_mask:0xf
    v_mov_b32 v107, v104
    s_nop 1
    v_permlane16_swap_b32 v104, v107
    v_add_f32 v104, v104, v107
    v_mov_b32 v107, v104
    s_nop 1
    v_permlane32_swap_b32 v104, v107
    v_add_f32 v104, v104, v107
    v_add_f32_dpp v105, v105, v105 row_ror:8 row_mask:0xf bank_mask:0xf
    s_nop 1
    v_add_f32_dpp v105, v105, v105 row_ror:4 row_mask:0xf bank_mask:0xf
    s_nop 1
    v_add_f32_dpp v105, v105, v105 row_ror:2 row_mask:0xf bank_mask:0xf
    s_nop 1
    v_add_f32_dpp v105, v105, v105 row_ror:1 row_mask:0xf bank_mask:0xf
    v_mov_b32 v107, v105
    s_nop 1
    v_permlane16_swap_b32 v105, v107
    v_add_f32 v105, v105, v107
    v_mov_b32 v107, v105
    s_nop 1
    v_permlane32_swap_b32 v105, v107
    v_add_f32 v105, v105, v107
    v_cmp_eq_u32 vcc, 14, v1
    s_nop 1
    v_cndmask_b32 v112, v112, v104, vcc
    v_cndmask_b32 v113, v113, v105, vcc
    s_waitcnt vmcnt(0)
    v_lshlrev_b32 v96, 16, v92
    v_and_b32 v97, 0xffff0000, v92
    v_lshlrev_b32 v98, 16, v93
    v_and_b32 v99, 0xffff0000, v93
    v_lshlrev_b32 v100, 16, v94
    v_and_b32 v101, 0xffff0000, v94
    v_lshlrev_b32 v102, 16, v95
    v_and_b32 v103, 0xffff0000, v95
    v_pk_mul_f32 v[104:105], v[96:97], v[16:17]
    v_pk_fma_f32 v[104:105], v[98:99], v[18:19], v[104:105]
    v_pk_fma_f32 v[104:105], v[100:101], v[20:21], v[104:105]
    v_pk_fma_f32 v[104:105], v[102:103], v[22:23], v[104:105]
    v_add_f32 v104, v104, v105
    v_pk_mul_f32 v[96:97], v[96:97], v[24:25]
    v_cvt_pk_bf16_f32 v107, v96, v97
    v_lshlrev_b32 v96, 16, v107
    v_and_b32 v97, 0xffff0000, v107
    v_pk_mul_f32 v[98:99], v[98:99], v[26:27]
    v_cvt_pk_bf16_f32 v107, v98, v99
    v_lshlrev_b32 v98, 16, v107
    v_and_b32 v99, 0xffff0000, v107
    v_pk_mul_f32 v[100:101], v[100:101], v[28:29]
    v_cvt_pk_bf16_f32 v107, v100, v101
    v_lshlrev_b32 v100, 16, v107
    v_and_b32 v101, 0xffff0000, v107
    v_pk_mul_f32 v[102:103], v[102:103], v[30:31]
    v_cvt_pk_bf16_f32 v107, v102, v103
    v_lshlrev_b32 v102, 16, v107
    v_and_b32 v103, 0xffff0000, v107
    v_pk_add_f32 v[96:97], v[96:97], v[98:99]
    v_pk_add_f32 v[100:101], v[100:101], v[102:103]
    v_pk_add_f32 v[96:97], v[96:97], v[100:101]
    v_add_f32 v105, v96, v97
    v_add_f32_dpp v104, v104, v104 row_ror:8 row_mask:0xf bank_mask:0xf
    s_nop 1
    v_add_f32_dpp v104, v104, v104 row_ror:4 row_mask:0xf bank_mask:0xf
    s_nop 1
    v_add_f32_dpp v104, v104, v104 row_ror:2 row_mask:0xf bank_mask:0xf
    s_nop 1
    v_add_f32_dpp v104, v104, v104 row_ror:1 row_mask:0xf bank_mask:0xf
    v_mov_b32 v107, v104
    s_nop 1
    v_permlane16_swap_b32 v104, v107
    v_add_f32 v104, v104, v107
    v_mov_b32 v107, v104
    s_nop 1
    v_permlane32_swap_b32 v104, v107
    v_add_f32 v104, v104, v107
    v_add_f32_dpp v105, v105, v105 row_ror:8 row_mask:0xf bank_mask:0xf
    s_nop 1
    v_add_f32_dpp v105, v105, v105 row_ror:4 row_mask:0xf bank_mask:0xf
    s_nop 1
    v_add_f32_dpp v105, v105, v105 row_ror:2 row_mask:0xf bank_mask:0xf
    s_nop 1
    v_add_f32_dpp v105, v105, v105 row_ror:1 row_mask:0xf bank_mask:0xf
    v_mov_b32 v107, v105
    s_nop 1
    v_permlane16_swap_b32 v105, v107
    v_add_f32 v105, v105, v107
    v_mov_b32 v107, v105
    s_nop 1
    v_permlane32_swap_b32 v105, v107
    v_add_f32 v105, v105, v107
    v_cmp_eq_u32 vcc, 15, v1
    s_nop 1
    v_cndmask_b32 v112, v112, v104, vcc
    v_cndmask_b32 v113, v113, v105, vcc
    v_cvt_pk_bf16_f32 v113, v113, v113
    v_lshlrev_b32 v113, 16, v113
    v_mul_f32 v113, s79, v113
    v_exp_f32 v113, v113
    s_nop 0
    v_add_f32 v113, 1.0, v113
    v_rcp_f32 v113, v113
    s_nop 0
    v_cvt_pk_bf16_f32 v113, v113, v113
    v_lshlrev_b32 v113, 16, v113
    v_cvt_pk_bf16_f32 v112, v112, v112
    v_and_b32 v112, 0xffff0000, v112
    v_ashrrev_i32 v104, 31, v112
    v_or_b32 v104, 0x80000000, v104
    v_xor_b32 v112, v112, v104
    v_and_b32 v112, 0xffff0000, v112
    s_lshl_b32 s31, s76, 4
    s_sub_u32 s31, 2047, s31
    v_sub_u32 v104, s31, v1
    v_or_b32 v112, v112, v104
    v_lshlrev_b32 v5, 2, v1
    v_mov_b32 v104, 0
    s_lshl_b32 s78, s76, 6
    s_mov_b64 exec, 0xffff
    s_add_u32 s31, s78, 0x5100000
    buffer_store_dword v113, v5, s[8:11], s31 offen sc1
    s_add_u32 s31, s78, 0x5110000
    buffer_store_dword v112, v5, s[8:11], s31 offen sc1
    s_add_u32 s31, s78, 0x5120000
    buffer_store_dword v104, v5, s[8:11], s31 offen sc1
    s_mov_b64 exec, -1
    s_waitcnt vmcnt(0)
    v_mov_b32 v250, 44
    v_mov_b32 v251, 1
    s_mov_b64 exec, 1
    buffer_atomic_add v251, v250, s[12:15], 0 offen
    s_mov_b64 exec, -1
    s_cmp_ge_u32 s99, 28
    s_cbranch_scc1 L_down
    s_load_dwordx2 s[82:83], s[0:1], 72
    s_load_dwordx2 s[84:85], s[0:1], 80
    s_waitcnt lgkmcnt(0)
    s_mov_b32 s76, s99
    v_and_b32 v1, 63, v0
    v_and_b32 v2, 15, v0
    v_bfe_u32 v3, v0, 4, 2
    v_lshrrev_b32 v8, 2, v2
    v_lshl_add_u32 v8, v3, 3, v8
    v_lshlrev_b32 v8, 5, v8
    v_and_b32 v9, 3, v2
    v_lshl_add_u32 v8, v9, 3, v8
    s_mul_i32 s78, s25, 32768
    v_add_u32 v6, s78, v8
    v_lshrrev_b32 v8, 1, v1
    s_mov_b32 s31, 3584
    v_mul_lo_u32 v8, v8, s31
    v_and_b32 v9, 1, v1
    v_lshl_add_u32 v5, v9, 4, v8
    s_lshl_b32 s79, s76, 7
    s_lshl_b32 s31, s25, 5
    s_add_u32 s79, s79, s31
    s_barrier
    s_mov_b32 s16, s82
    s_and_b32 s17, s83, 0xffff
    s_mov_b32 s18, 0x1c0000
    s_mov_b32 s19, 0x20000
    s_mov_b32 s31, s79
    s_add_u32 s45, s78, 0
    s_mov_b32 m0, s45
    s_nop 0
    buffer_load_dwordx4 v5, s[16:19], s31 offen lds
    s_add_u32 s31, s31, 114688
    s_add_u32 s45, s45, 0x400
    s_mov_b32 m0, s45
    s_nop 0
    buffer_load_dwordx4 v5, s[16:19], s31 offen lds
    s_add_u32 s31, s31, 114688
    s_add_u32 s45, s45, 0x400
    s_mov_b32 m0, s45
    s_nop 0
    buffer_load_dwordx4 v5, s[16:19], s31 offen lds
    s_add_u32 s31, s31, 114688
    s_add_u32 s45, s45, 0x400
    s_mov_b32 m0, s45
    s_nop 0
    buffer_load_dwordx4 v5, s[16:19], s31 offen lds
    s_add_u32 s31, s31, 114688
    s_add_u32 s45, s45, 0x400
    s_mov_b32 m0, s45
    s_nop 0
    buffer_load_dwordx4 v5, s[16:19], s31 offen lds
    s_add_u32 s31, s31, 114688
    s_add_u32 s45, s45, 0x400
    s_mov_b32 m0, s45
    s_nop 0
    buffer_load_dwordx4 v5, s[16:19], s31 offen lds
    s_add_u32 s31, s31, 114688
    s_add_u32 s45, s45, 0x400
    s_mov_b32 m0, s45
    s_nop 0
    buffer_load_dwordx4 v5, s[16:19], s31 offen lds
    s_add_u32 s31, s31, 114688
    s_add_u32 s45, s45, 0x400
    s_mov_b32 m0, s45
    s_nop 0
    buffer_load_dwordx4 v5, s[16:19], s31 offen lds
    s_add_u32 s31, s31, 114688
    s_add_u32 s45, s45, 0x400
    s_mov_b32 m0, s45
    s_nop 0
    buffer_load_dwordx4 v5, s[16:19], s31 offen lds
    s_add_u32 s31, s31, 114688
    s_add_u32 s45, s45, 0x400
    s_mov_b32 m0, s45
    s_nop 0
    buffer_load_dwordx4 v5, s[16:19], s31 offen lds
    s_add_u32 s31, s31, 114688
    s_add_u32 s45, s45, 0x400
    s_mov_b32 m0, s45
    s_nop 0
    buffer_load_dwordx4 v5, s[16:19], s31 offen lds
    s_add_u32 s31, s31, 114688
    s_add_u32 s45, s45, 0x400
    s_mov_b32 m0, s45
    s_nop 0
    buffer_load_dwordx4 v5, s[16:19], s31 offen lds
    s_add_u32 s31, s31, 114688
    s_add_u32 s45, s45, 0x400
    s_mov_b32 m0, s45
    s_nop 0
    buffer_load_dwordx4 v5, s[16:19], s31 offen lds
    s_add_u32 s31, s31, 114688
    s_add_u32 s45, s45, 0x400
    s_mov_b32 m0, s45
    s_nop 0
    buffer_load_dwordx4 v5, s[16:19], s31 offen lds
    s_add_u32 s31, s31, 114688
    s_add_u32 s45, s45, 0x400
    s_mov_b32 m0, s45
    s_nop 0
    buffer_load_dwordx4 v5, s[16:19], s31 offen lds
    s_add_u32 s31, s31, 114688
    s_add_u32 s45, s45, 0x400
    s_mov_b32 m0, s45
    s_nop 0
    buffer_load_dwordx4 v5, s[16:19], s31 offen lds
    s_add_u32 s31, s31, 114688
    s_add_u32 s45, s45, 0x400
    s_mov_b32 s16, s84
    s_and_b32 s17, s85, 0xffff
    s_mov_b32 s18, 0x1c0000
    s_mov_b32 s19, 0x20000
    s_mov_b32 s31, s79
    s_add_u32 s45, s78, 16384
    s_mov_b32 m0, s45
    s_nop 0
    buffer_load_dwordx4 v5, s[16:19], s31 offen lds
    s_add_u32 s31, s31, 114688
    s_add_u32 s45, s45, 0x400
    s_mov_b32 m0, s45
    s_nop 0
    buffer_load_dwordx4 v5, s[16:19], s31 offen lds
    s_add_u32 s31, s31, 114688
    s_add_u32 s45, s45, 0x400
    s_mov_b32 m0, s45
    s_nop 0
    buffer_load_dwordx4 v5, s[16:19], s31 offen lds
    s_add_u32 s31, s31, 114688
    s_add_u32 s45, s45, 0x400
    s_mov_b32 m0, s45
    s_nop 0
    buffer_load_dwordx4 v5, s[16:19], s31 offen lds
    s_add_u32 s31, s31, 114688
    s_add_u32 s45, s45, 0x400
    s_mov_b32 m0, s45
    s_nop 0
    buffer_load_dwordx4 v5, s[16:19], s31 offen lds
    s_add_u32 s31, s31, 114688
    s_add_u32 s45, s45, 0x400
    s_mov_b32 m0, s45
    s_nop 0
    buffer_load_dwordx4 v5, s[16:19], s31 offen lds
    s_add_u32 s31, s31, 114688
    s_add_u32 s45, s45, 0x400
    s_mov_b32 m0, s45
    s_nop 0
    buffer_load_dwordx4 v5, s[16:19], s31 offen lds
    s_add_u32 s31, s31, 114688
    s_add_u32 s45, s45, 0x400
    s_mov_b32 m0, s45
    s_nop 0
    buffer_load_dwordx4 v5, s[16:19], s31 offen lds
    s_add_u32 s31, s31, 114688
    s_add_u32 s45, s45, 0x400
    s_mov_b32 m0, s45
    s_nop 0
    buffer_load_dwordx4 v5, s[16:19], s31 offen lds
    s_add_u32 s31, s31, 114688
    s_add_u32 s45, s45, 0x400
    s_mov_b32 m0, s45
    s_nop 0
    buffer_load_dwordx4 v5, s[16:19], s31 offen lds
    s_add_u32 s31, s31, 114688
    s_add_u32 s45, s45, 0x400
    s_mov_b32 m0, s45
    s_nop 0
    buffer_load_dwordx4 v5, s[16:19], s31 offen lds
    s_add_u32 s31, s31, 114688
    s_add_u32 s45, s45, 0x400
    s_mov_b32 m0, s45
    s_nop 0
    buffer_load_dwordx4 v5, s[16:19], s31 offen lds
    s_add_u32 s31, s31, 114688
    s_add_u32 s45, s45, 0x400
    s_mov_b32 m0, s45
    s_nop 0
    buffer_load_dwordx4 v5, s[16:19], s31 offen lds
    s_add_u32 s31, s31, 114688
    s_add_u32 s45, s45, 0x400
    s_mov_b32 m0, s45
    s_nop 0
    buffer_load_dwordx4 v5, s[16:19], s31 offen lds
    s_add_u32 s31, s31, 114688
    s_add_u32 s45, s45, 0x400
    s_mov_b32 m0, s45
    s_nop 0
    buffer_load_dwordx4 v5, s[16:19], s31 offen lds
    s_add_u32 s31, s31, 114688
    s_add_u32 s45, s45, 0x400
    s_mov_b32 m0, s45
    s_nop 0
    buffer_load_dwordx4 v5, s[16:19], s31 offen lds
    s_add_u32 s31, s31, 114688
    s_add_u32 s45, s45, 0x400
    v_mov_b32 v250, 48
L_w_t8:
    buffer_load_dword v251, v250, s[12:15], 0 offen sc1
    s_waitcnt vmcnt(0)
    v_cmp_gt_u32 vcc, 1, v251
    s_cbranch_vccz L_w_t8_ok
    s_sleep 4
    s_sub_u32 s97, s97, 1
    s_cmp_eq_u32 s97, 0
    s_cbranch_scc0 L_w_t8
    s_mov_b32 s31, 11
    s_branch L_babort
L_w_t8_ok:
    v_and_b32 v8, 7, v2
    v_lshlrev_b32 v8, 2, v8
    s_mov_b32 s31, 0x5130000
    buffer_load_dword v9, v8, s[8:11], s31 offen sc1
    s_waitcnt vmcnt(0)
    v_lshlrev_b32 v9, 10, v9
    v_lshl_add_u32 v9, v3, 4, v9
    buffer_load_dwordx4 v[16:19], v9, s[20:23], 0 offen offset:0
    buffer_load_dwordx4 v[20:23], v9, s[20:23], 0 offen offset:64
    buffer_load_dwordx4 v[24:27], v9, s[20:23], 0 offen offset:128
    buffer_load_dwordx4 v[28:31], v9, s[20:23], 0 offen offset:192
    buffer_load_dwordx4 v[32:35], v9, s[20:23], 0 offen offset:256
    buffer_load_dwordx4 v[36:39], v9, s[20:23], 0 offen offset:320
    buffer_load_dwordx4 v[40:43], v9, s[20:23], 0 offen offset:384
    buffer_load_dwordx4 v[44:47], v9, s[20:23], 0 offen offset:448
    buffer_load_dwordx4 v[48:51], v9, s[20:23], 0 offen offset:512
    buffer_load_dwordx4 v[52:55], v9, s[20:23], 0 offen offset:576
    buffer_load_dwordx4 v[56:59], v9, s[20:23], 0 offen offset:640
    buffer_load_dwordx4 v[60:63], v9, s[20:23], 0 offen offset:704
    buffer_load_dwordx4 v[64:67], v9, s[20:23], 0 offen offset:768
    buffer_load_dwordx4 v[68:71], v9, s[20:23], 0 offen offset:832
    buffer_load_dwordx4 v[72:75], v9, s[20:23], 0 offen offset:896
    buffer_load_dwordx4 v[76:79], v9, s[20:23], 0 offen offset:960
    s_waitcnt vmcnt(0)
    ds_read_b64_tr_b16 v[80:81], v6 offset:0
    ds_read_b64_tr_b16 v[82:83], v6 offset:128
    ds_read_b64_tr_b16 v[84:85], v6 offset:16384
    ds_read_b64_tr_b16 v[86:87], v6 offset:16512
    s_waitcnt lgkmcnt(0)
    v_mfma_f32_16x16x32_bf16 v[96:99], v[16:19], v[80:83], 0
    v_mfma_f32_16x16x32_bf16 v[100:103], v[16:19], v[84:87], 0
    ds_read_b64_tr_b16 v[88:89], v6 offset:1024
    ds_read_b64_tr_b16 v[90:91], v6 offset:1152
    ds_read_b64_tr_b16 v[92:93], v6 offset:17408
    ds_read_b64_tr_b16 v[94:95], v6 offset:17536
    s_waitcnt lgkmcnt(0)
    v_mfma_f32_16x16x32_bf16 v[96:99], v[20:23], v[88:91], v[96:99]
    v_mfma_f32_16x16x32_bf16 v[100:103], v[20:23], v[92:95], v[100:103]
    ds_read_b64_tr_b16 v[80:81], v6 offset:2048
    ds_read_b64_tr_b16 v[82:83], v6 offset:2176
    ds_read_b64_tr_b16 v[84:85], v6 offset:18432
    ds_read_b64_tr_b16 v[86:87], v6 offset:18560
    s_waitcnt lgkmcnt(0)
    v_mfma_f32_16x16x32_bf16 v[96:99], v[24:27], v[80:83], v[96:99]
    v_mfma_f32_16x16x32_bf16 v[100:103], v[24:27], v[84:87], v[100:103]
    ds_read_b64_tr_b16 v[88:89], v6 offset:3072
    ds_read_b64_tr_b16 v[90:91], v6 offset:3200
    ds_read_b64_tr_b16 v[92:93], v6 offset:19456
    ds_read_b64_tr_b16 v[94:95], v6 offset:19584
    s_waitcnt lgkmcnt(0)
    v_mfma_f32_16x16x32_bf16 v[96:99], v[28:31], v[88:91], v[96:99]
    v_mfma_f32_16x16x32_bf16 v[100:103], v[28:31], v[92:95], v[100:103]
    ds_read_b64_tr_b16 v[80:81], v6 offset:4096
    ds_read_b64_tr_b16 v[82:83], v6 offset:4224
    ds_read_b64_tr_b16 v[84:85], v6 offset:20480
    ds_read_b64_tr_b16 v[86:87], v6 offset:20608
    s_waitcnt lgkmcnt(0)
    v_mfma_f32_16x16x32_bf16 v[96:99], v[32:35], v[80:83], v[96:99]
    v_mfma_f32_16x16x32_bf16 v[100:103], v[32:35], v[84:87], v[100:103]
    ds_read_b64_tr_b16 v[88:89], v6 offset:5120
    ds_read_b64_tr_b16 v[90:91], v6 offset:5248
    ds_read_b64_tr_b16 v[92:93], v6 offset:21504
    ds_read_b64_tr_b16 v[94:95], v6 offset:21632
    s_waitcnt lgkmcnt(0)
    v_mfma_f32_16x16x32_bf16 v[96:99], v[36:39], v[88:91], v[96:99]
    v_mfma_f32_16x16x32_bf16 v[100:103], v[36:39], v[92:95], v[100:103]
    ds_read_b64_tr_b16 v[80:81], v6 offset:6144
    ds_read_b64_tr_b16 v[82:83], v6 offset:6272
    ds_read_b64_tr_b16 v[84:85], v6 offset:22528
    ds_read_b64_tr_b16 v[86:87], v6 offset:22656
    s_waitcnt lgkmcnt(0)
    v_mfma_f32_16x16x32_bf16 v[96:99], v[40:43], v[80:83], v[96:99]
    v_mfma_f32_16x16x32_bf16 v[100:103], v[40:43], v[84:87], v[100:103]
    ds_read_b64_tr_b16 v[88:89], v6 offset:7168
    ds_read_b64_tr_b16 v[90:91], v6 offset:7296
    ds_read_b64_tr_b16 v[92:93], v6 offset:23552
    ds_read_b64_tr_b16 v[94:95], v6 offset:23680
    s_waitcnt lgkmcnt(0)
    v_mfma_f32_16x16x32_bf16 v[96:99], v[44:47], v[88:91], v[96:99]
    v_mfma_f32_16x16x32_bf16 v[100:103], v[44:47], v[92:95], v[100:103]
    ds_read_b64_tr_b16 v[80:81], v6 offset:8192
    ds_read_b64_tr_b16 v[82:83], v6 offset:8320
    ds_read_b64_tr_b16 v[84:85], v6 offset:24576
    ds_read_b64_tr_b16 v[86:87], v6 offset:24704
    s_waitcnt lgkmcnt(0)
    v_mfma_f32_16x16x32_bf16 v[96:99], v[48:51], v[80:83], v[96:99]
    v_mfma_f32_16x16x32_bf16 v[100:103], v[48:51], v[84:87], v[100:103]
    ds_read_b64_tr_b16 v[88:89], v6 offset:9216
    ds_read_b64_tr_b16 v[90:91], v6 offset:9344
    ds_read_b64_tr_b16 v[92:93], v6 offset:25600
    ds_read_b64_tr_b16 v[94:95], v6 offset:25728
    s_waitcnt lgkmcnt(0)
    v_mfma_f32_16x16x32_bf16 v[96:99], v[52:55], v[88:91], v[96:99]
    v_mfma_f32_16x16x32_bf16 v[100:103], v[52:55], v[92:95], v[100:103]
    ds_read_b64_tr_b16 v[80:81], v6 offset:10240
    ds_read_b64_tr_b16 v[82:83], v6 offset:10368
    ds_read_b64_tr_b16 v[84:85], v6 offset:26624
    ds_read_b64_tr_b16 v[86:87], v6 offset:26752
    s_waitcnt lgkmcnt(0)
    v_mfma_f32_16x16x32_bf16 v[96:99], v[56:59], v[80:83], v[96:99]
    v_mfma_f32_16x16x32_bf16 v[100:103], v[56:59], v[84:87], v[100:103]
    ds_read_b64_tr_b16 v[88:89], v6 offset:11264
    ds_read_b64_tr_b16 v[90:91], v6 offset:11392
    ds_read_b64_tr_b16 v[92:93], v6 offset:27648
    ds_read_b64_tr_b16 v[94:95], v6 offset:27776
    s_waitcnt lgkmcnt(0)
    v_mfma_f32_16x16x32_bf16 v[96:99], v[60:63], v[88:91], v[96:99]
    v_mfma_f32_16x16x32_bf16 v[100:103], v[60:63], v[92:95], v[100:103]
    ds_read_b64_tr_b16 v[80:81], v6 offset:12288
    ds_read_b64_tr_b16 v[82:83], v6 offset:12416
    ds_read_b64_tr_b16 v[84:85], v6 offset:28672
    ds_read_b64_tr_b16 v[86:87], v6 offset:28800
    s_waitcnt lgkmcnt(0)
    v_mfma_f32_16x16x32_bf16 v[96:99], v[64:67], v[80:83], v[96:99]
    v_mfma_f32_16x16x32_bf16 v[100:103], v[64:67], v[84:87], v[100:103]
    ds_read_b64_tr_b16 v[88:89], v6 offset:13312
    ds_read_b64_tr_b16 v[90:91], v6 offset:13440
    ds_read_b64_tr_b16 v[92:93], v6 offset:29696
    ds_read_b64_tr_b16 v[94:95], v6 offset:29824
    s_waitcnt lgkmcnt(0)
    v_mfma_f32_16x16x32_bf16 v[96:99], v[68:71], v[88:91], v[96:99]
    v_mfma_f32_16x16x32_bf16 v[100:103], v[68:71], v[92:95], v[100:103]
    ds_read_b64_tr_b16 v[80:81], v6 offset:14336
    ds_read_b64_tr_b16 v[82:83], v6 offset:14464
    ds_read_b64_tr_b16 v[84:85], v6 offset:30720
    ds_read_b64_tr_b16 v[86:87], v6 offset:30848
    s_waitcnt lgkmcnt(0)
    v_mfma_f32_16x16x32_bf16 v[96:99], v[72:75], v[80:83], v[96:99]
    v_mfma_f32_16x16x32_bf16 v[100:103], v[72:75], v[84:87], v[100:103]
    ds_read_b64_tr_b16 v[88:89], v6 offset:15360
    ds_read_b64_tr_b16 v[90:91], v6 offset:15488
    ds_read_b64_tr_b16 v[92:93], v6 offset:31744
    ds_read_b64_tr_b16 v[94:95], v6 offset:31872
    s_waitcnt lgkmcnt(0)
    v_mfma_f32_16x16x32_bf16 v[96:99], v[76:79], v[88:91], v[96:99]
    v_mfma_f32_16x16x32_bf16 v[100:103], v[76:79], v[92:95], v[100:103]
    s_mov_b32 s80, 0xbfb8aa3b
    s_nop 2
    v_cvt_pk_bf16_f32 v8, v96, v97
    v_lshlrev_b32 v96, 16, v8
    v_and_b32 v97, 0xffff0000, v8
    v_cvt_pk_bf16_f32 v8, v98, v99
    v_lshlrev_b32 v98, 16, v8
    v_and_b32 v99, 0xffff0000, v8
    v_cvt_pk_bf16_f32 v8, v100, v101
    v_lshlrev_b32 v100, 16, v8
    v_and_b32 v101, 0xffff0000, v8
    v_cvt_pk_bf16_f32 v8, v102, v103
    v_lshlrev_b32 v102, 16, v8
    v_and_b32 v103, 0xffff0000, v8
    v_mov_b32 v104, v96
    v_mul_f32 v104, s80, v104
    v_exp_f32 v104, v104
    s_nop 0
    v_add_f32 v104, 1.0, v104
    v_rcp_f32 v104, v104
    s_nop 0
    v_mul_f32 v96, v96, v104
    v_mov_b32 v105, v97
    v_mul_f32 v105, s80, v105
    v_exp_f32 v105, v105
    s_nop 0
    v_add_f32 v105, 1.0, v105
    v_rcp_f32 v105, v105
    s_nop 0
    v_mul_f32 v97, v97, v105
    v_mov_b32 v106, v98
    v_mul_f32 v106, s80, v106
    v_exp_f32 v106, v106
    s_nop 0
    v_add_f32 v106, 1.0, v106
    v_rcp_f32 v106, v106
    s_nop 0
    v_mul_f32 v98, v98, v106
    v_mov_b32 v107, v99
    v_mul_f32 v107, s80, v107
    v_exp_f32 v107, v107
    s_nop 0
    v_add_f32 v107, 1.0, v107
    v_rcp_f32 v107, v107
    s_nop 0
    v_mul_f32 v99, v99, v107
    v_cvt_pk_bf16_f32 v8, v96, v97
    v_lshlrev_b32 v96, 16, v8
    v_and_b32 v97, 0xffff0000, v8
    v_cvt_pk_bf16_f32 v8, v98, v99
    v_lshlrev_b32 v98, 16, v8
    v_and_b32 v99, 0xffff0000, v8
    v_pk_mul_f32 v[96:97], v[96:97], v[100:101]
    v_pk_mul_f32 v[98:99], v[98:99], v[102:103]
    v_cvt_pk_bf16_f32 v104, v96, v96
    v_cvt_pk_bf16_f32 v105, v97, v97
    v_cvt_pk_bf16_f32 v106, v98, v98
    v_cvt_pk_bf16_f32 v107, v99, v99
    s_mov_b32 s31, 14336
    v_mul_lo_u32 v8, v3, s31
    v_lshl_add_u32 v8, v2, 1, v8
    s_add_u32 s31, s79, 0x5140000
    s_mov_b64 exec, 0xffffffff
    buffer_store_short v104, v8, s[8:11], s31 offen sc1
    s_add_u32 s31, s31, 3584
    buffer_store_short v105, v8, s[8:11], s31 offen sc1
    s_add_u32 s31, s31, 3584
    buffer_store_short v106, v8, s[8:11], s31 offen sc1
    s_add_u32 s31, s31, 3584
    buffer_store_short v107, v8, s[8:11], s31 offen sc1
    s_add_u32 s31, s31, 3584
    s_mov_b64 exec, -1
    s_waitcnt vmcnt(0)
    v_mov_b32 v250, 52
    v_mov_b32 v251, 1
    s_mov_b64 exec, 1
    buffer_atomic_add v251, v250, s[12:15], 0 offen
    s_mov_b64 exec, -1
    s_branch L_attn
L_down:
    s_cmp_lg_u32 s99, 28
    s_cbranch_scc1 L_not8
    s_cmp_lg_u32 s25, 0
    s_cbranch_scc1 L_not8
    v_mov_b32 v250, 44
L_w_rt:
    buffer_load_dword v251, v250, s[12:15], 0 offen sc1
    s_waitcnt vmcnt(0)
    v_cmp_gt_u32 vcc, 128, v251
    s_cbranch_vccz L_w_rt_ok
    s_sleep 4
    s_sub_u32 s97, s97, 1
    s_cmp_eq_u32 s97, 0
    s_cbranch_scc0 L_w_rt
    s_mov_b32 s31, 12
    s_branch L_babort
L_w_rt_ok:
    v_mov_b32 v11, 0
    v_and_b32 v1, 63, v0
    v_and_b32 v2, 15, v0
    v_bfe_u32 v3, v0, 4, 2
    v_lshlrev_b32 v4, 4, v1
    s_mov_b32 s31, 0x5110000
    buffer_load_dwordx4 v[16:19], v4, s[8:11], s31 offen offset:0 sc1
    buffer_load_dwordx4 v[20:23], v4, s[8:11], s31 offen offset:1024 sc1
    buffer_load_dwordx4 v[24:27], v4, s[8:11], s31 offen offset:2048 sc1
    buffer_load_dwordx4 v[28:31], v4, s[8:11], s31 offen offset:3072 sc1
    s_mov_b32 s31, 0x5111000
    buffer_load_dwordx4 v[32:35], v4, s[8:11], s31 offen offset:0 sc1
    buffer_load_dwordx4 v[36:39], v4, s[8:11], s31 offen offset:1024 sc1
    buffer_load_dwordx4 v[40:43], v4, s[8:11], s31 offen offset:2048 sc1
    buffer_load_dwordx4 v[44:47], v4, s[8:11], s31 offen offset:3072 sc1
    v_mov_b32 v10, 0
    s_mov_b32 s78, 0
    s_waitcnt vmcnt(0)
L_t_loop:
    v_max_u32 v8, v16, v17
    v_max3_u32 v8, v8, v18, v19
    v_max3_u32 v8, v8, v20, v21
    v_max3_u32 v8, v8, v22, v23
    v_max3_u32 v8, v8, v24, v25
    v_max3_u32 v8, v8, v26, v27
    v_max3_u32 v8, v8, v28, v29
    v_max3_u32 v8, v8, v30, v31
    v_max3_u32 v8, v8, v32, v33
    v_max3_u32 v8, v8, v34, v35
    v_max3_u32 v8, v8, v36, v37
    v_max3_u32 v8, v8, v38, v39
    v_max3_u32 v8, v8, v40, v41
    v_max3_u32 v8, v8, v42, v43
    v_max3_u32 v8, v8, v44, v45
    v_max3_u32 v8, v8, v46, v47
    s_nop 1
    v_max_u32_dpp v8, v8, v8 row_ror:8 row_mask:0xf bank_mask:0xf
    s_nop 1
    v_max_u32_dpp v8, v8, v8 row_ror:4 row_mask:0xf bank_mask:0xf
    s_nop 1
    v_max_u32_dpp v8, v8, v8 row_ror:2 row_mask:0xf bank_mask:0xf
    s_nop 1
    v_max_u32_dpp v8, v8, v8 row_ror:1 row_mask:0xf bank_mask:0xf
    v_mov_b32 v9, v8
    s_nop 1
    v_permlane16_swap_b32 v8, v9
    v_max_u32 v8, v8, v9
    v_mov_b32 v9, v8
    s_nop 1
    v_permlane32_swap_b32 v8, v9
    v_max_u32 v8, v8, v9
    v_cmp_eq_u32 vcc, v8, v16
    s_nop 1
    v_cndmask_b32 v16, v16, v11, vcc
    v_cmp_eq_u32 vcc, v8, v17
    s_nop 1
    v_cndmask_b32 v17, v17, v11, vcc
    v_cmp_eq_u32 vcc, v8, v18
    s_nop 1
    v_cndmask_b32 v18, v18, v11, vcc
    v_cmp_eq_u32 vcc, v8, v19
    s_nop 1
    v_cndmask_b32 v19, v19, v11, vcc
    v_cmp_eq_u32 vcc, v8, v20
    s_nop 1
    v_cndmask_b32 v20, v20, v11, vcc
    v_cmp_eq_u32 vcc, v8, v21
    s_nop 1
    v_cndmask_b32 v21, v21, v11, vcc
    v_cmp_eq_u32 vcc, v8, v22
    s_nop 1
    v_cndmask_b32 v22, v22, v11, vcc
    v_cmp_eq_u32 vcc, v8, v23
    s_nop 1
    v_cndmask_b32 v23, v23, v11, vcc
    v_cmp_eq_u32 vcc, v8, v24
    s_nop 1
    v_cndmask_b32 v24, v24, v11, vcc
    v_cmp_eq_u32 vcc, v8, v25
    s_nop 1
    v_cndmask_b32 v25, v25, v11, vcc
    v_cmp_eq_u32 vcc, v8, v26
    s_nop 1
    v_cndmask_b32 v26, v26, v11, vcc
    v_cmp_eq_u32 vcc, v8, v27
    s_nop 1
    v_cndmask_b32 v27, v27, v11, vcc
    v_cmp_eq_u32 vcc, v8, v28
    s_nop 1
    v_cndmask_b32 v28, v28, v11, vcc
    v_cmp_eq_u32 vcc, v8, v29
    s_nop 1
    v_cndmask_b32 v29, v29, v11, vcc
    v_cmp_eq_u32 vcc, v8, v30
    s_nop 1
    v_cndmask_b32 v30, v30, v11, vcc
    v_cmp_eq_u32 vcc, v8, v31
    s_nop 1
    v_cndmask_b32 v31, v31, v11, vcc
    v_cmp_eq_u32 vcc, v8, v32
    s_nop 1
    v_cndmask_b32 v32, v32, v11, vcc
    v_cmp_eq_u32 vcc, v8, v33
    s_nop 1
    v_cndmask_b32 v33, v33, v11, vcc
    v_cmp_eq_u32 vcc, v8, v34
    s_nop 1
    v_cndmask_b32 v34, v34, v11, vcc
    v_cmp_eq_u32 vcc, v8, v35
    s_nop 1
    v_cndmask_b32 v35, v35, v11, vcc
    v_cmp_eq_u32 vcc, v8, v36
    s_nop 1
    v_cndmask_b32 v36, v36, v11, vcc
    v_cmp_eq_u32 vcc, v8, v37
    s_nop 1
    v_cndmask_b32 v37, v37, v11, vcc
    v_cmp_eq_u32 vcc, v8, v38
    s_nop 1
    v_cndmask_b32 v38, v38, v11, vcc
    v_cmp_eq_u32 vcc, v8, v39
    s_nop 1
    v_cndmask_b32 v39, v39, v11, vcc
    v_cmp_eq_u32 vcc, v8, v40
    s_nop 1
    v_cndmask_b32 v40, v40, v11, vcc
    v_cmp_eq_u32 vcc, v8, v41
    s_nop 1
    v_cndmask_b32 v41, v41, v11, vcc
    v_cmp_eq_u32 vcc, v8, v42
    s_nop 1
    v_cndmask_b32 v42, v42, v11, vcc
    v_cmp_eq_u32 vcc, v8, v43
    s_nop 1
    v_cndmask_b32 v43, v43, v11, vcc
    v_cmp_eq_u32 vcc, v8, v44
    s_nop 1
    v_cndmask_b32 v44, v44, v11, vcc
    v_cmp_eq_u32 vcc, v8, v45
    s_nop 1
    v_cndmask_b32 v45, v45, v11, vcc
    v_cmp_eq_u32 vcc, v8, v46
    s_nop 1
    v_cndmask_b32 v46, v46, v11, vcc
    v_cmp_eq_u32 vcc, v8, v47
    s_nop 1
    v_cndmask_b32 v47, v47, v11, vcc
    v_cmp_eq_u32 vcc, s78, v1
    s_nop 1
    v_cndmask_b32 v10, v10, v8, vcc
    s_add_u32 s78, s78, 1
    s_cmp_lt_u32 s78, 8
    s_nop 3
    s_cbranch_scc1 L_t_loop
    v_and_b32 v12, 0x7ff, v10
    v_sub_u32 v12, 2047, v12
    v_and_b32 v13, 0xffff0000, v10
    v_ashrrev_i32 v14, 31, v13
    v_not_b32 v14, v14
    v_or_b32 v14, 0x80000000, v14
    v_xor_b32 v13, v13, v14
    v_and_b32 v13, 0xffff0000, v13
    s_mov_b32 s79, 0xbfb8aa3b
    v_mul_f32 v13, s79, v13
    v_exp_f32 v13, v13
    s_nop 0
    v_add_f32 v13, 1.0, v13
    v_rcp_f32 v13, v13
    s_nop 0
    v_cvt_pk_bf16_f32 v13, v13, v13
    v_lshlrev_b32 v13, 16, v13
    v_lshlrev_b32 v5, 2, v1
    v_lshlrev_b32 v6, 2, v12
    v_add_u32 v7, 1, v1
    s_mov_b64 exec, 0xff
    s_mov_b32 s31, 0x5130000
    buffer_store_dword v12, v5, s[8:11], s31 offen sc1
    buffer_store_dword v13, v5, s[8:11], s31 offen offset:64 sc1
    s_mov_b32 s31, 0x5120000
    buffer_store_dword v7, v6, s[8:11], s31 offen sc1
    s_mov_b64 exec, -1
    s_waitcnt vmcnt(0)
    v_mov_b32 v250, 48
    v_mov_b32 v251, 1
    s_mov_b64 exec, 1
    buffer_atomic_add v251, v250, s[12:15], 0 offen
    s_mov_b64 exec, -1
L_not8:
    s_load_dwordx2 s[82:83], s[0:1], 88
    s_waitcnt lgkmcnt(0)
    s_sub_u32 s76, s99, 28
    s_lshl_b32 s76, s76, 1
    s_mov_b32 s77, 0
L_down_loop:
    v_and_b32 v1, 63, v0
    v_and_b32 v2, 15, v0
    v_bfe_u32 v3, v0, 4, 2
    v_lshrrev_b32 v8, 2, v2
    v_lshl_add_u32 v8, v3, 3, v8
    v_lshlrev_b32 v8, 5, v8
    v_and_b32 v9, 3, v2
    v_lshl_add_u32 v8, v9, 3, v8
    s_mul_i32 s78, s25, 32768
    v_add_u32 v6, s78, v8
    v_lshrrev_b32 v8, 1, v1
    v_lshlrev_b32 v8, 10, v8
    v_and_b32 v9, 1, v1
    v_lshl_add_u32 v5, v9, 4, v8
    s_lshl_b32 s79, s76, 7
    s_lshl_b32 s31, s25, 5
    s_add_u32 s79, s79, s31
    s_mov_b32 s16, s82
    s_and_b32 s17, s83, 0xffff
    s_mov_b32 s18, 0x1c0000
    s_mov_b32 s19, 0x20000
    s_barrier
    s_add_u32 s31, s79, 0
    s_mov_b32 s45, s78
    s_mov_b32 m0, s45
    s_nop 0
    buffer_load_dwordx4 v5, s[16:19], s31 offen lds
    s_add_u32 s31, s31, 0x8000
    s_add_u32 s45, s45, 0x400
    s_mov_b32 m0, s45
    s_nop 0
    buffer_load_dwordx4 v5, s[16:19], s31 offen lds
    s_add_u32 s31, s31, 0x8000
    s_add_u32 s45, s45, 0x400
    s_mov_b32 m0, s45
    s_nop 0
    buffer_load_dwordx4 v5, s[16:19], s31 offen lds
    s_add_u32 s31, s31, 0x8000
    s_add_u32 s45, s45, 0x400
    s_mov_b32 m0, s45
    s_nop 0
    buffer_load_dwordx4 v5, s[16:19], s31 offen lds
    s_add_u32 s31, s31, 0x8000
    s_add_u32 s45, s45, 0x400
    s_mov_b32 m0, s45
    s_nop 0
    buffer_load_dwordx4 v5, s[16:19], s31 offen lds
    s_add_u32 s31, s31, 0x8000
    s_add_u32 s45, s45, 0x400
    s_mov_b32 m0, s45
    s_nop 0
    buffer_load_dwordx4 v5, s[16:19], s31 offen lds
    s_add_u32 s31, s31, 0x8000
    s_add_u32 s45, s45, 0x400
    s_mov_b32 m0, s45
    s_nop 0
    buffer_load_dwordx4 v5, s[16:19], s31 offen lds
    s_add_u32 s31, s31, 0x8000
    s_add_u32 s45, s45, 0x400
    s_mov_b32 m0, s45
    s_nop 0
    buffer_load_dwordx4 v5, s[16:19], s31 offen lds
    s_add_u32 s31, s31, 0x8000
    s_add_u32 s45, s45, 0x400
    s_mov_b32 m0, s45
    s_nop 0
    buffer_load_dwordx4 v5, s[16:19], s31 offen lds
    s_add_u32 s31, s31, 0x8000
    s_add_u32 s45, s45, 0x400
    s_mov_b32 m0, s45
    s_nop 0
    buffer_load_dwordx4 v5, s[16:19], s31 offen lds
    s_add_u32 s31, s31, 0x8000
    s_add_u32 s45, s45, 0x400
    s_mov_b32 m0, s45
    s_nop 0
    buffer_load_dwordx4 v5, s[16:19], s31 offen lds
    s_add_u32 s31, s31, 0x8000
    s_add_u32 s45, s45, 0x400
    s_mov_b32 m0, s45
    s_nop 0
    buffer_load_dwordx4 v5, s[16:19], s31 offen lds
    s_add_u32 s31, s31, 0x8000
    s_add_u32 s45, s45, 0x400
    s_mov_b32 m0, s45
    s_nop 0
    buffer_load_dwordx4 v5, s[16:19], s31 offen lds
    s_add_u32 s31, s31, 0x8000
    s_add_u32 s45, s45, 0x400
    s_mov_b32 m0, s45
    s_nop 0
    buffer_load_dwordx4 v5, s[16:19], s31 offen lds
    s_add_u32 s31, s31, 0x8000
    s_add_u32 s45, s45, 0x400
    s_mov_b32 m0, s45
    s_nop 0
    buffer_load_dwordx4 v5, s[16:19], s31 offen lds
    s_add_u32 s31, s31, 0x8000
    s_add_u32 s45, s45, 0x400
    s_mov_b32 m0, s45
    s_nop 0
    buffer_load_dwordx4 v5, s[16:19], s31 offen lds
    s_add_u32 s31, s31, 0x8000
    s_add_u32 s45, s45, 0x400
    s_mov_b32 m0, s45
    s_nop 0
    buffer_load_dwordx4 v5, s[16:19], s31 offen lds
    s_add_u32 s31, s31, 0x8000
    s_add_u32 s45, s45, 0x400
    s_mov_b32 m0, s45
    s_nop 0
    buffer_load_dwordx4 v5, s[16:19], s31 offen lds
    s_add_u32 s31, s31, 0x8000
    s_add_u32 s45, s45, 0x400
    s_mov_b32 m0, s45
    s_nop 0
    buffer_load_dwordx4 v5, s[16:19], s31 offen lds
    s_add_u32 s31, s31, 0x8000
    s_add_u32 s45, s45, 0x400
    s_mov_b32 m0, s45
    s_nop 0
    buffer_load_dwordx4 v5, s[16:19], s31 offen lds
    s_add_u32 s31, s31, 0x8000
    s_add_u32 s45, s45, 0x400
    s_mov_b32 m0, s45
    s_nop 0
    buffer_load_dwordx4 v5, s[16:19], s31 offen lds
    s_add_u32 s31, s31, 0x8000
    s_add_u32 s45, s45, 0x400
    s_mov_b32 m0, s45
    s_nop 0
    buffer_load_dwordx4 v5, s[16:19], s31 offen lds
    s_add_u32 s31, s31, 0x8000
    s_add_u32 s45, s45, 0x400
    s_mov_b32 m0, s45
    s_nop 0
    buffer_load_dwordx4 v5, s[16:19], s31 offen lds
    s_add_u32 s31, s31, 0x8000
    s_add_u32 s45, s45, 0x400
    s_mov_b32 m0, s45
    s_nop 0
    buffer_load_dwordx4 v5, s[16:19], s31 offen lds
    s_add_u32 s31, s31, 0x8000
    s_add_u32 s45, s45, 0x400
    s_mov_b32 m0, s45
    s_nop 0
    buffer_load_dwordx4 v5, s[16:19], s31 offen lds
    s_add_u32 s31, s31, 0x8000
    s_add_u32 s45, s45, 0x400
    s_mov_b32 m0, s45
    s_nop 0
    buffer_load_dwordx4 v5, s[16:19], s31 offen lds
    s_add_u32 s31, s31, 0x8000
    s_add_u32 s45, s45, 0x400
    s_mov_b32 m0, s45
    s_nop 0
    buffer_load_dwordx4 v5, s[16:19], s31 offen lds
    s_add_u32 s31, s31, 0x8000
    s_add_u32 s45, s45, 0x400
    s_mov_b32 m0, s45
    s_nop 0
    buffer_load_dwordx4 v5, s[16:19], s31 offen lds
    s_add_u32 s31, s31, 0x8000
    s_add_u32 s45, s45, 0x400
    v_mov_b32 v250, 52
L_w_up:
    buffer_load_dword v251, v250, s[12:15], 0 offen sc1
    s_waitcnt vmcnt(0)
    v_cmp_gt_u32 vcc, 112, v251
    s_cbranch_vccz L_w_up_ok
    s_sleep 4
    s_sub_u32 s97, s97, 1
    s_cmp_eq_u32 s97, 0
    s_cbranch_scc0 L_w_up
    s_mov_b32 s31, 13
    s_branch L_babort
L_w_up_ok:
    v_and_b32 v8, 7, v2
    s_mov_b32 s31, 3584
    v_mul_lo_u32 v8, v8, s31
    v_lshl_add_u32 v9, v3, 4, v8
    v_lshlrev_b32 v10, 4, v3
    s_mov_b32 s31, 0x5130040
    buffer_load_dwordx4 v[12:15], v10, s[8:11], s31 offen sc1
    s_mov_b32 s80, 0x5140000
    buffer_load_dwordx4 v[16:19], v9, s[8:11], s80 offen offset:0 sc1
    buffer_load_dwordx4 v[20:23], v9, s[8:11], s80 offen offset:64 sc1
    buffer_load_dwordx4 v[24:27], v9, s[8:11], s80 offen offset:128 sc1
    buffer_load_dwordx4 v[28:31], v9, s[8:11], s80 offen offset:192 sc1
    buffer_load_dwordx4 v[32:35], v9, s[8:11], s80 offen offset:256 sc1
    buffer_load_dwordx4 v[36:39], v9, s[8:11], s80 offen offset:320 sc1
    buffer_load_dwordx4 v[40:43], v9, s[8:11], s80 offen offset:384 sc1
    buffer_load_dwordx4 v[44:47], v9, s[8:11], s80 offen offset:448 sc1
    buffer_load_dwordx4 v[48:51], v9, s[8:11], s80 offen offset:512 sc1
    buffer_load_dwordx4 v[52:55], v9, s[8:11], s80 offen offset:576 sc1
    buffer_load_dwordx4 v[56:59], v9, s[8:11], s80 offen offset:640 sc1
    buffer_load_dwordx4 v[60:63], v9, s[8:11], s80 offen offset:704 sc1
    buffer_load_dwordx4 v[64:67], v9, s[8:11], s80 offen offset:768 sc1
    buffer_load_dwordx4 v[68:71], v9, s[8:11], s80 offen offset:832 sc1
    buffer_load_dwordx4 v[72:75], v9, s[8:11], s80 offen offset:896 sc1
    buffer_load_dwordx4 v[76:79], v9, s[8:11], s80 offen offset:960 sc1
    buffer_load_dwordx4 v[80:83], v9, s[8:11], s80 offen offset:1024 sc1
    buffer_load_dwordx4 v[84:87], v9, s[8:11], s80 offen offset:1088 sc1
    buffer_load_dwordx4 v[88:91], v9, s[8:11], s80 offen offset:1152 sc1
    buffer_load_dwordx4 v[92:95], v9, s[8:11], s80 offen offset:1216 sc1
    buffer_load_dwordx4 v[96:99], v9, s[8:11], s80 offen offset:1280 sc1
    buffer_load_dwordx4 v[100:103], v9, s[8:11], s80 offen offset:1344 sc1
    buffer_load_dwordx4 v[104:107], v9, s[8:11], s80 offen offset:1408 sc1
    buffer_load_dwordx4 v[108:111], v9, s[8:11], s80 offen offset:1472 sc1
    buffer_load_dwordx4 v[112:115], v9, s[8:11], s80 offen offset:1536 sc1
    buffer_load_dwordx4 v[116:119], v9, s[8:11], s80 offen offset:1600 sc1
    buffer_load_dwordx4 v[120:123], v9, s[8:11], s80 offen offset:1664 sc1
    buffer_load_dwordx4 v[124:127], v9, s[8:11], s80 offen offset:1728 sc1
    s_waitcnt vmcnt(0)
    ds_read_b64_tr_b16 v[128:129], v6 offset:0
    ds_read_b64_tr_b16 v[130:131], v6 offset:128
    s_waitcnt lgkmcnt(0)
    v_mfma_f32_16x16x32_bf16 v[136:139], v[16:19], v[128:131], 0
    ds_read_b64_tr_b16 v[132:133], v6 offset:1024
    ds_read_b64_tr_b16 v[134:135], v6 offset:1152
    s_waitcnt lgkmcnt(0)
    v_mfma_f32_16x16x32_bf16 v[136:139], v[20:23], v[132:135], v[136:139]
    ds_read_b64_tr_b16 v[128:129], v6 offset:2048
    ds_read_b64_tr_b16 v[130:131], v6 offset:2176
    s_waitcnt lgkmcnt(0)
    v_mfma_f32_16x16x32_bf16 v[136:139], v[24:27], v[128:131], v[136:139]
    ds_read_b64_tr_b16 v[132:133], v6 offset:3072
    ds_read_b64_tr_b16 v[134:135], v6 offset:3200
    s_waitcnt lgkmcnt(0)
    v_mfma_f32_16x16x32_bf16 v[136:139], v[28:31], v[132:135], v[136:139]
    ds_read_b64_tr_b16 v[128:129], v6 offset:4096
    ds_read_b64_tr_b16 v[130:131], v6 offset:4224
    s_waitcnt lgkmcnt(0)
    v_mfma_f32_16x16x32_bf16 v[136:139], v[32:35], v[128:131], v[136:139]
    ds_read_b64_tr_b16 v[132:133], v6 offset:5120
    ds_read_b64_tr_b16 v[134:135], v6 offset:5248
    s_waitcnt lgkmcnt(0)
    v_mfma_f32_16x16x32_bf16 v[136:139], v[36:39], v[132:135], v[136:139]
    ds_read_b64_tr_b16 v[128:129], v6 offset:6144
    ds_read_b64_tr_b16 v[130:131], v6 offset:6272
    s_waitcnt lgkmcnt(0)
    v_mfma_f32_16x16x32_bf16 v[136:139], v[40:43], v[128:131], v[136:139]
    ds_read_b64_tr_b16 v[132:133], v6 offset:7168
    ds_read_b64_tr_b16 v[134:135], v6 offset:7296
    s_waitcnt lgkmcnt(0)
    v_mfma_f32_16x16x32_bf16 v[136:139], v[44:47], v[132:135], v[136:139]
    ds_read_b64_tr_b16 v[128:129], v6 offset:8192
    ds_read_b64_tr_b16 v[130:131], v6 offset:8320
    s_waitcnt lgkmcnt(0)
    v_mfma_f32_16x16x32_bf16 v[136:139], v[48:51], v[128:131], v[136:139]
    ds_read_b64_tr_b16 v[132:133], v6 offset:9216
    ds_read_b64_tr_b16 v[134:135], v6 offset:9344
    s_waitcnt lgkmcnt(0)
    v_mfma_f32_16x16x32_bf16 v[136:139], v[52:55], v[132:135], v[136:139]
    ds_read_b64_tr_b16 v[128:129], v6 offset:10240
    ds_read_b64_tr_b16 v[130:131], v6 offset:10368
    s_waitcnt lgkmcnt(0)
    v_mfma_f32_16x16x32_bf16 v[136:139], v[56:59], v[128:131], v[136:139]
    ds_read_b64_tr_b16 v[132:133], v6 offset:11264
    ds_read_b64_tr_b16 v[134:135], v6 offset:11392
    s_waitcnt lgkmcnt(0)
    v_mfma_f32_16x16x32_bf16 v[136:139], v[60:63], v[132:135], v[136:139]
    ds_read_b64_tr_b16 v[128:129], v6 offset:12288
    ds_read_b64_tr_b16 v[130:131], v6 offset:12416
    s_waitcnt lgkmcnt(0)
    v_mfma_f32_16x16x32_bf16 v[136:139], v[64:67], v[128:131], v[136:139]
    ds_read_b64_tr_b16 v[132:133], v6 offset:13312
    ds_read_b64_tr_b16 v[134:135], v6 offset:13440
    s_waitcnt lgkmcnt(0)
    v_mfma_f32_16x16x32_bf16 v[136:139], v[68:71], v[132:135], v[136:139]
    ds_read_b64_tr_b16 v[128:129], v6 offset:14336
    ds_read_b64_tr_b16 v[130:131], v6 offset:14464
    s_waitcnt lgkmcnt(0)
    v_mfma_f32_16x16x32_bf16 v[136:139], v[72:75], v[128:131], v[136:139]
    ds_read_b64_tr_b16 v[132:133], v6 offset:15360
    ds_read_b64_tr_b16 v[134:135], v6 offset:15488
    s_waitcnt lgkmcnt(0)
    v_mfma_f32_16x16x32_bf16 v[136:139], v[76:79], v[132:135], v[136:139]
    ds_read_b64_tr_b16 v[128:129], v6 offset:16384
    ds_read_b64_tr_b16 v[130:131], v6 offset:16512
    s_waitcnt lgkmcnt(0)
    v_mfma_f32_16x16x32_bf16 v[136:139], v[80:83], v[128:131], v[136:139]
    ds_read_b64_tr_b16 v[132:133], v6 offset:17408
    ds_read_b64_tr_b16 v[134:135], v6 offset:17536
    s_waitcnt lgkmcnt(0)
    v_mfma_f32_16x16x32_bf16 v[136:139], v[84:87], v[132:135], v[136:139]
    ds_read_b64_tr_b16 v[128:129], v6 offset:18432
    ds_read_b64_tr_b16 v[130:131], v6 offset:18560
    s_waitcnt lgkmcnt(0)
    v_mfma_f32_16x16x32_bf16 v[136:139], v[88:91], v[128:131], v[136:139]
    ds_read_b64_tr_b16 v[132:133], v6 offset:19456
    ds_read_b64_tr_b16 v[134:135], v6 offset:19584
    s_waitcnt lgkmcnt(0)
    v_mfma_f32_16x16x32_bf16 v[136:139], v[92:95], v[132:135], v[136:139]
    ds_read_b64_tr_b16 v[128:129], v6 offset:20480
    ds_read_b64_tr_b16 v[130:131], v6 offset:20608
    s_waitcnt lgkmcnt(0)
    v_mfma_f32_16x16x32_bf16 v[136:139], v[96:99], v[128:131], v[136:139]
    ds_read_b64_tr_b16 v[132:133], v6 offset:21504
    ds_read_b64_tr_b16 v[134:135], v6 offset:21632
    s_waitcnt lgkmcnt(0)
    v_mfma_f32_16x16x32_bf16 v[136:139], v[100:103], v[132:135], v[136:139]
    ds_read_b64_tr_b16 v[128:129], v6 offset:22528
    ds_read_b64_tr_b16 v[130:131], v6 offset:22656
    s_waitcnt lgkmcnt(0)
    v_mfma_f32_16x16x32_bf16 v[136:139], v[104:107], v[128:131], v[136:139]
    ds_read_b64_tr_b16 v[132:133], v6 offset:23552
    ds_read_b64_tr_b16 v[134:135], v6 offset:23680
    s_waitcnt lgkmcnt(0)
    v_mfma_f32_16x16x32_bf16 v[136:139], v[108:111], v[132:135], v[136:139]
    ds_read_b64_tr_b16 v[128:129], v6 offset:24576
    ds_read_b64_tr_b16 v[130:131], v6 offset:24704
    s_waitcnt lgkmcnt(0)
    v_mfma_f32_16x16x32_bf16 v[136:139], v[112:115], v[128:131], v[136:139]
    ds_read_b64_tr_b16 v[132:133], v6 offset:25600
    ds_read_b64_tr_b16 v[134:135], v6 offset:25728
    s_waitcnt lgkmcnt(0)
    v_mfma_f32_16x16x32_bf16 v[136:139], v[116:119], v[132:135], v[136:139]
    ds_read_b64_tr_b16 v[128:129], v6 offset:26624
    ds_read_b64_tr_b16 v[130:131], v6 offset:26752
    s_waitcnt lgkmcnt(0)
    v_mfma_f32_16x16x32_bf16 v[136:139], v[120:123], v[128:131], v[136:139]
    ds_read_b64_tr_b16 v[132:133], v6 offset:27648
    ds_read_b64_tr_b16 v[134:135], v6 offset:27776
    s_waitcnt lgkmcnt(0)
    v_mfma_f32_16x16x32_bf16 v[136:139], v[124:127], v[132:135], v[136:139]
    s_add_u32 s31, s79, 917504
    s_mov_b32 s45, s78
    s_mov_b32 m0, s45
    s_nop 0
    buffer_load_dwordx4 v5, s[16:19], s31 offen lds
    s_add_u32 s31, s31, 0x8000
    s_add_u32 s45, s45, 0x400
    s_mov_b32 m0, s45
    s_nop 0
    buffer_load_dwordx4 v5, s[16:19], s31 offen lds
    s_add_u32 s31, s31, 0x8000
    s_add_u32 s45, s45, 0x400
    s_mov_b32 m0, s45
    s_nop 0
    buffer_load_dwordx4 v5, s[16:19], s31 offen lds
    s_add_u32 s31, s31, 0x8000
    s_add_u32 s45, s45, 0x400
    s_mov_b32 m0, s45
    s_nop 0
    buffer_load_dwordx4 v5, s[16:19], s31 offen lds
    s_add_u32 s31, s31, 0x8000
    s_add_u32 s45, s45, 0x400
    s_mov_b32 m0, s45
    s_nop 0
    buffer_load_dwordx4 v5, s[16:19], s31 offen lds
    s_add_u32 s31, s31, 0x8000
    s_add_u32 s45, s45, 0x400
    s_mov_b32 m0, s45
    s_nop 0
    buffer_load_dwordx4 v5, s[16:19], s31 offen lds
    s_add_u32 s31, s31, 0x8000
    s_add_u32 s45, s45, 0x400
    s_mov_b32 m0, s45
    s_nop 0
    buffer_load_dwordx4 v5, s[16:19], s31 offen lds
    s_add_u32 s31, s31, 0x8000
    s_add_u32 s45, s45, 0x400
    s_mov_b32 m0, s45
    s_nop 0
    buffer_load_dwordx4 v5, s[16:19], s31 offen lds
    s_add_u32 s31, s31, 0x8000
    s_add_u32 s45, s45, 0x400
    s_mov_b32 m0, s45
    s_nop 0
    buffer_load_dwordx4 v5, s[16:19], s31 offen lds
    s_add_u32 s31, s31, 0x8000
    s_add_u32 s45, s45, 0x400
    s_mov_b32 m0, s45
    s_nop 0
    buffer_load_dwordx4 v5, s[16:19], s31 offen lds
    s_add_u32 s31, s31, 0x8000
    s_add_u32 s45, s45, 0x400
    s_mov_b32 m0, s45
    s_nop 0
    buffer_load_dwordx4 v5, s[16:19], s31 offen lds
    s_add_u32 s31, s31, 0x8000
    s_add_u32 s45, s45, 0x400
    s_mov_b32 m0, s45
    s_nop 0
    buffer_load_dwordx4 v5, s[16:19], s31 offen lds
    s_add_u32 s31, s31, 0x8000
    s_add_u32 s45, s45, 0x400
    s_mov_b32 m0, s45
    s_nop 0
    buffer_load_dwordx4 v5, s[16:19], s31 offen lds
    s_add_u32 s31, s31, 0x8000
    s_add_u32 s45, s45, 0x400
    s_mov_b32 m0, s45
    s_nop 0
    buffer_load_dwordx4 v5, s[16:19], s31 offen lds
    s_add_u32 s31, s31, 0x8000
    s_add_u32 s45, s45, 0x400
    s_mov_b32 m0, s45
    s_nop 0
    buffer_load_dwordx4 v5, s[16:19], s31 offen lds
    s_add_u32 s31, s31, 0x8000
    s_add_u32 s45, s45, 0x400
    s_mov_b32 m0, s45
    s_nop 0
    buffer_load_dwordx4 v5, s[16:19], s31 offen lds
    s_add_u32 s31, s31, 0x8000
    s_add_u32 s45, s45, 0x400
    s_mov_b32 m0, s45
    s_nop 0
    buffer_load_dwordx4 v5, s[16:19], s31 offen lds
    s_add_u32 s31, s31, 0x8000
    s_add_u32 s45, s45, 0x400
    s_mov_b32 m0, s45
    s_nop 0
    buffer_load_dwordx4 v5, s[16:19], s31 offen lds
    s_add_u32 s31, s31, 0x8000
    s_add_u32 s45, s45, 0x400
    s_mov_b32 m0, s45
    s_nop 0
    buffer_load_dwordx4 v5, s[16:19], s31 offen lds
    s_add_u32 s31, s31, 0x8000
    s_add_u32 s45, s45, 0x400
    s_mov_b32 m0, s45
    s_nop 0
    buffer_load_dwordx4 v5, s[16:19], s31 offen lds
    s_add_u32 s31, s31, 0x8000
    s_add_u32 s45, s45, 0x400
    s_mov_b32 m0, s45
    s_nop 0
    buffer_load_dwordx4 v5, s[16:19], s31 offen lds
    s_add_u32 s31, s31, 0x8000
    s_add_u32 s45, s45, 0x400
    s_mov_b32 m0, s45
    s_nop 0
    buffer_load_dwordx4 v5, s[16:19], s31 offen lds
    s_add_u32 s31, s31, 0x8000
    s_add_u32 s45, s45, 0x400
    s_mov_b32 m0, s45
    s_nop 0
    buffer_load_dwordx4 v5, s[16:19], s31 offen lds
    s_add_u32 s31, s31, 0x8000
    s_add_u32 s45, s45, 0x400
    s_mov_b32 m0, s45
    s_nop 0
    buffer_load_dwordx4 v5, s[16:19], s31 offen lds
    s_add_u32 s31, s31, 0x8000
    s_add_u32 s45, s45, 0x400
    s_mov_b32 m0, s45
    s_nop 0
    buffer_load_dwordx4 v5, s[16:19], s31 offen lds
    s_add_u32 s31, s31, 0x8000
    s_add_u32 s45, s45, 0x400
    s_mov_b32 m0, s45
    s_nop 0
    buffer_load_dwordx4 v5, s[16:19], s31 offen lds
    s_add_u32 s31, s31, 0x8000
    s_add_u32 s45, s45, 0x400
    s_mov_b32 m0, s45
    s_nop 0
    buffer_load_dwordx4 v5, s[16:19], s31 offen lds
    s_add_u32 s31, s31, 0x8000
    s_add_u32 s45, s45, 0x400
    s_mov_b32 m0, s45
    s_nop 0
    buffer_load_dwordx4 v5, s[16:19], s31 offen lds
    s_add_u32 s31, s31, 0x8000
    s_add_u32 s45, s45, 0x400
    s_mov_b32 s80, 0x5140700
    buffer_load_dwordx4 v[16:19], v9, s[8:11], s80 offen offset:0 sc1
    buffer_load_dwordx4 v[20:23], v9, s[8:11], s80 offen offset:64 sc1
    buffer_load_dwordx4 v[24:27], v9, s[8:11], s80 offen offset:128 sc1
    buffer_load_dwordx4 v[28:31], v9, s[8:11], s80 offen offset:192 sc1
    buffer_load_dwordx4 v[32:35], v9, s[8:11], s80 offen offset:256 sc1
    buffer_load_dwordx4 v[36:39], v9, s[8:11], s80 offen offset:320 sc1
    buffer_load_dwordx4 v[40:43], v9, s[8:11], s80 offen offset:384 sc1
    buffer_load_dwordx4 v[44:47], v9, s[8:11], s80 offen offset:448 sc1
    buffer_load_dwordx4 v[48:51], v9, s[8:11], s80 offen offset:512 sc1
    buffer_load_dwordx4 v[52:55], v9, s[8:11], s80 offen offset:576 sc1
    buffer_load_dwordx4 v[56:59], v9, s[8:11], s80 offen offset:640 sc1
    buffer_load_dwordx4 v[60:63], v9, s[8:11], s80 offen offset:704 sc1
    buffer_load_dwordx4 v[64:67], v9, s[8:11], s80 offen offset:768 sc1
    buffer_load_dwordx4 v[68:71], v9, s[8:11], s80 offen offset:832 sc1
    buffer_load_dwordx4 v[72:75], v9, s[8:11], s80 offen offset:896 sc1
    buffer_load_dwordx4 v[76:79], v9, s[8:11], s80 offen offset:960 sc1
    buffer_load_dwordx4 v[80:83], v9, s[8:11], s80 offen offset:1024 sc1
    buffer_load_dwordx4 v[84:87], v9, s[8:11], s80 offen offset:1088 sc1
    buffer_load_dwordx4 v[88:91], v9, s[8:11], s80 offen offset:1152 sc1
    buffer_load_dwordx4 v[92:95], v9, s[8:11], s80 offen offset:1216 sc1
    buffer_load_dwordx4 v[96:99], v9, s[8:11], s80 offen offset:1280 sc1
    buffer_load_dwordx4 v[100:103], v9, s[8:11], s80 offen offset:1344 sc1
    buffer_load_dwordx4 v[104:107], v9, s[8:11], s80 offen offset:1408 sc1
    buffer_load_dwordx4 v[108:111], v9, s[8:11], s80 offen offset:1472 sc1
    buffer_load_dwordx4 v[112:115], v9, s[8:11], s80 offen offset:1536 sc1
    buffer_load_dwordx4 v[116:119], v9, s[8:11], s80 offen offset:1600 sc1
    buffer_load_dwordx4 v[120:123], v9, s[8:11], s80 offen offset:1664 sc1
    buffer_load_dwordx4 v[124:127], v9, s[8:11], s80 offen offset:1728 sc1
    s_waitcnt vmcnt(0)
    ds_read_b64_tr_b16 v[128:129], v6 offset:0
    ds_read_b64_tr_b16 v[130:131], v6 offset:128
    s_waitcnt lgkmcnt(0)
    v_mfma_f32_16x16x32_bf16 v[136:139], v[16:19], v[128:131], v[136:139]
    ds_read_b64_tr_b16 v[132:133], v6 offset:1024
    ds_read_b64_tr_b16 v[134:135], v6 offset:1152
    s_waitcnt lgkmcnt(0)
    v_mfma_f32_16x16x32_bf16 v[136:139], v[20:23], v[132:135], v[136:139]
    ds_read_b64_tr_b16 v[128:129], v6 offset:2048
    ds_read_b64_tr_b16 v[130:131], v6 offset:2176
    s_waitcnt lgkmcnt(0)
    v_mfma_f32_16x16x32_bf16 v[136:139], v[24:27], v[128:131], v[136:139]
    ds_read_b64_tr_b16 v[132:133], v6 offset:3072
    ds_read_b64_tr_b16 v[134:135], v6 offset:3200
    s_waitcnt lgkmcnt(0)
    v_mfma_f32_16x16x32_bf16 v[136:139], v[28:31], v[132:135], v[136:139]
    ds_read_b64_tr_b16 v[128:129], v6 offset:4096
    ds_read_b64_tr_b16 v[130:131], v6 offset:4224
    s_waitcnt lgkmcnt(0)
    v_mfma_f32_16x16x32_bf16 v[136:139], v[32:35], v[128:131], v[136:139]
    ds_read_b64_tr_b16 v[132:133], v6 offset:5120
    ds_read_b64_tr_b16 v[134:135], v6 offset:5248
    s_waitcnt lgkmcnt(0)
    v_mfma_f32_16x16x32_bf16 v[136:139], v[36:39], v[132:135], v[136:139]
    ds_read_b64_tr_b16 v[128:129], v6 offset:6144
    ds_read_b64_tr_b16 v[130:131], v6 offset:6272
    s_waitcnt lgkmcnt(0)
    v_mfma_f32_16x16x32_bf16 v[136:139], v[40:43], v[128:131], v[136:139]
    ds_read_b64_tr_b16 v[132:133], v6 offset:7168
    ds_read_b64_tr_b16 v[134:135], v6 offset:7296
    s_waitcnt lgkmcnt(0)
    v_mfma_f32_16x16x32_bf16 v[136:139], v[44:47], v[132:135], v[136:139]
    ds_read_b64_tr_b16 v[128:129], v6 offset:8192
    ds_read_b64_tr_b16 v[130:131], v6 offset:8320
    s_waitcnt lgkmcnt(0)
    v_mfma_f32_16x16x32_bf16 v[136:139], v[48:51], v[128:131], v[136:139]
    ds_read_b64_tr_b16 v[132:133], v6 offset:9216
    ds_read_b64_tr_b16 v[134:135], v6 offset:9344
    s_waitcnt lgkmcnt(0)
    v_mfma_f32_16x16x32_bf16 v[136:139], v[52:55], v[132:135], v[136:139]
    ds_read_b64_tr_b16 v[128:129], v6 offset:10240
    ds_read_b64_tr_b16 v[130:131], v6 offset:10368
    s_waitcnt lgkmcnt(0)
    v_mfma_f32_16x16x32_bf16 v[136:139], v[56:59], v[128:131], v[136:139]
    ds_read_b64_tr_b16 v[132:133], v6 offset:11264
    ds_read_b64_tr_b16 v[134:135], v6 offset:11392
    s_waitcnt lgkmcnt(0)
    v_mfma_f32_16x16x32_bf16 v[136:139], v[60:63], v[132:135], v[136:139]
    ds_read_b64_tr_b16 v[128:129], v6 offset:12288
    ds_read_b64_tr_b16 v[130:131], v6 offset:12416
    s_waitcnt lgkmcnt(0)
    v_mfma_f32_16x16x32_bf16 v[136:139], v[64:67], v[128:131], v[136:139]
    ds_read_b64_tr_b16 v[132:133], v6 offset:13312
    ds_read_b64_tr_b16 v[134:135], v6 offset:13440
    s_waitcnt lgkmcnt(0)
    v_mfma_f32_16x16x32_bf16 v[136:139], v[68:71], v[132:135], v[136:139]
    ds_read_b64_tr_b16 v[128:129], v6 offset:14336
    ds_read_b64_tr_b16 v[130:131], v6 offset:14464
    s_waitcnt lgkmcnt(0)
    v_mfma_f32_16x16x32_bf16 v[136:139], v[72:75], v[128:131], v[136:139]
    ds_read_b64_tr_b16 v[132:133], v6 offset:15360
    ds_read_b64_tr_b16 v[134:135], v6 offset:15488
    s_waitcnt lgkmcnt(0)
    v_mfma_f32_16x16x32_bf16 v[136:139], v[76:79], v[132:135], v[136:139]
    ds_read_b64_tr_b16 v[128:129], v6 offset:16384
    ds_read_b64_tr_b16 v[130:131], v6 offset:16512
    s_waitcnt lgkmcnt(0)
    v_mfma_f32_16x16x32_bf16 v[136:139], v[80:83], v[128:131], v[136:139]
    ds_read_b64_tr_b16 v[132:133], v6 offset:17408
    ds_read_b64_tr_b16 v[134:135], v6 offset:17536
    s_waitcnt lgkmcnt(0)
    v_mfma_f32_16x16x32_bf16 v[136:139], v[84:87], v[132:135], v[136:139]
    ds_read_b64_tr_b16 v[128:129], v6 offset:18432
    ds_read_b64_tr_b16 v[130:131], v6 offset:18560
    s_waitcnt lgkmcnt(0)
    v_mfma_f32_16x16x32_bf16 v[136:139], v[88:91], v[128:131], v[136:139]
    ds_read_b64_tr_b16 v[132:133], v6 offset:19456
    ds_read_b64_tr_b16 v[134:135], v6 offset:19584
    s_waitcnt lgkmcnt(0)
    v_mfma_f32_16x16x32_bf16 v[136:139], v[92:95], v[132:135], v[136:139]
    ds_read_b64_tr_b16 v[128:129], v6 offset:20480
    ds_read_b64_tr_b16 v[130:131], v6 offset:20608
    s_waitcnt lgkmcnt(0)
    v_mfma_f32_16x16x32_bf16 v[136:139], v[96:99], v[128:131], v[136:139]
    ds_read_b64_tr_b16 v[132:133], v6 offset:21504
    ds_read_b64_tr_b16 v[134:135], v6 offset:21632
    s_waitcnt lgkmcnt(0)
    v_mfma_f32_16x16x32_bf16 v[136:139], v[100:103], v[132:135], v[136:139]
    ds_read_b64_tr_b16 v[128:129], v6 offset:22528
    ds_read_b64_tr_b16 v[130:131], v6 offset:22656
    s_waitcnt lgkmcnt(0)
    v_mfma_f32_16x16x32_bf16 v[136:139], v[104:107], v[128:131], v[136:139]
    ds_read_b64_tr_b16 v[132:133], v6 offset:23552
    ds_read_b64_tr_b16 v[134:135], v6 offset:23680
    s_waitcnt lgkmcnt(0)
    v_mfma_f32_16x16x32_bf16 v[136:139], v[108:111], v[132:135], v[136:139]
    ds_read_b64_tr_b16 v[128:129], v6 offset:24576
    ds_read_b64_tr_b16 v[130:131], v6 offset:24704
    s_waitcnt lgkmcnt(0)
    v_mfma_f32_16x16x32_bf16 v[136:139], v[112:115], v[128:131], v[136:139]
    ds_read_b64_tr_b16 v[132:133], v6 offset:25600
    ds_read_b64_tr_b16 v[134:135], v6 offset:25728
    s_waitcnt lgkmcnt(0)
    v_mfma_f32_16x16x32_bf16 v[136:139], v[116:119], v[132:135], v[136:139]
    ds_read_b64_tr_b16 v[128:129], v6 offset:26624
    ds_read_b64_tr_b16 v[130:131], v6 offset:26752
    s_waitcnt lgkmcnt(0)
    v_mfma_f32_16x16x32_bf16 v[136:139], v[120:123], v[128:131], v[136:139]
    ds_read_b64_tr_b16 v[132:133], v6 offset:27648
    ds_read_b64_tr_b16 v[134:135], v6 offset:27776
    s_waitcnt lgkmcnt(0)
    v_mfma_f32_16x16x32_bf16 v[136:139], v[124:127], v[132:135], v[136:139]
    s_nop 7
    v_cvt_pk_bf16_f32 v8, v136, v137
    v_lshlrev_b32 v136, 16, v8
    v_and_b32 v137, 0xffff0000, v8
    v_cvt_pk_bf16_f32 v8, v138, v139
    v_lshlrev_b32 v138, 16, v8
    v_and_b32 v139, 0xffff0000, v8
    v_pk_mul_f32 v[136:137], v[136:137], v[12:13]
    v_pk_mul_f32 v[138:139], v[138:139], v[14:15]
    v_cvt_pk_bf16_f32 v8, v136, v137
    v_lshlrev_b32 v136, 16, v8
    v_and_b32 v137, 0xffff0000, v8
    v_cvt_pk_bf16_f32 v8, v138, v139
    v_lshlrev_b32 v138, 16, v8
    v_and_b32 v139, 0xffff0000, v8
    v_lshlrev_b32 v8, 13, v3
    v_lshl_add_u32 v8, v2, 2, v8
    s_lshl_b32 s31, s79, 1
    s_add_u32 s31, s31, 0x5150000
    s_mov_b64 exec, 0xffffffff
    buffer_store_dword v136, v8, s[8:11], s31 offen sc1
    s_add_u32 s31, s31, 2048
    buffer_store_dword v137, v8, s[8:11], s31 offen sc1
    s_add_u32 s31, s31, 2048
    buffer_store_dword v138, v8, s[8:11], s31 offen sc1
    s_add_u32 s31, s31, 2048
    buffer_store_dword v139, v8, s[8:11], s31 offen sc1
    s_add_u32 s31, s31, 2048
    s_mov_b64 exec, -1
    s_waitcnt vmcnt(0)
    s_add_u32 s76, s76, 1
    s_add_u32 s77, s77, 1
    s_cmp_lt_u32 s77, 2
    s_nop 11
    s_cbranch_scc1 L_down_loop
    v_mov_b32 v250, 56
    v_mov_b32 v251, 1
    s_mov_b64 exec, 1
    buffer_atomic_add v251, v250, s[12:15], 0 offen
    s_mov_b64 exec, -1
L_attn:
    s_nop 11
    s_waitcnt vmcnt(0) lgkmcnt(0)
    s_barrier
    v_and_b32 v1, 63, v0
    v_and_b32 v2, 15, v0
    v_bfe_u32 v3, v0, 4, 2
    v_lshlrev_b32 v4, 4, v1
    s_lshl_b32 s31, s25, 12
    s_add_u32 s31, s31, 0
    v_lshrrev_b32 v8, 2, v2
    v_xor_b32 v8, v8, v3
    v_lshlrev_b32 v8, 3, v8
    v_lshl_add_u32 v8, v2, 5, v8
    v_add_u32 v5, s31, v8
    v_lshrrev_b32 v8, 2, v2
    v_lshl_add_u32 v8, v3, 2, v8
    v_lshlrev_b32 v8, 5, v8
    v_and_b32 v9, 3, v2
    v_xor_b32 v9, v9, v3
    v_lshl_add_u32 v8, v9, 3, v8
    v_add_u32 v6, s31, v8
    v_lshlrev_b32 v8, 2, v3
    v_add_u32 v8, 0, v8
    v_cmp_gt_u32 s[86:87], v8, v2
    v_lshlrev_b32 v8, 2, v3
    v_add_u32 v8, 1, v8
    v_cmp_gt_u32 s[88:89], v8, v2
    v_lshlrev_b32 v8, 2, v3
    v_add_u32 v8, 2, v8
    v_cmp_gt_u32 s[90:91], v8, v2
    v_lshlrev_b32 v8, 2, v3
    v_add_u32 v8, 3, v8
    v_cmp_gt_u32 s[92:93], v8, v2
    s_mov_b32 s94, 0x3db504f3
    s_mov_b32 s95, 0x3db504f3
    s_mov_b32 s96, 0x3fb8aa3b
    v_mov_b32 v7, 0xce6e6b28
    v_mov_b32 v177, 0
    v_mov_b32 v179, 0
    v_mov_b32 v181, 0
    v_mov_b32 v183, 0
    v_mov_b32 v185, 0
    v_mov_b32 v187, 0
    v_mov_b32 v189, 0
    v_mov_b32 v191, 0
    v_mov_b32 v173, 0
    v_mov_b32 v175, 0
    v_mov_b32 v166, 0
    v_mov_b32 v167, 0
    v_mov_b32 v250, 60
L_a_frdy:
    buffer_load_dword v251, v250, s[12:15], 0 offen sc1
    s_waitcnt vmcnt(0)
    v_cmp_gt_u32 vcc, 1, v251
    s_cbranch_vccz L_a_frdy_ok
    s_sleep 4
    s_sub_u32 s97, s97, 1
    s_cmp_eq_u32 s97, 0
    s_cbranch_scc0 L_a_frdy
    s_mov_b32 s31, 14
    s_branch L_babort
L_a_frdy_ok:
    s_lshl_b32 s31, s99, 2
    s_add_u32 s31, s31, s25
    s_and_b32 s77, s31, 31
    s_lshr_b32 s76, s31, 5
    v_min_u32 v10, 5, v1
    v_lshlrev_b32 v10, 4, v10
    v_mov_b32 v11, 0
    v_mov_b32 v12, 1
L_attn_loop:
    s_lshl_b32 s81, s77, 7
    s_and_b32 s31, s76, 3
    s_lshl_b32 s31, s31, 2
    s_add_u32 s81, s81, s31
    s_add_u32 s81, s81, 0x5202000
    s_lshr_b32 s82, s76, 2
L_a_wg:
    buffer_load_dword v13, v10, s[8:11], s81 offen sc1
    s_waitcnt vmcnt(0)
    v_cmp_ge_u32 vcc, s82, v13
    s_cbranch_vccz L_a_wg_ok
    s_sleep 4
    s_sub_u32 s97, s97, 1
    s_cmp_eq_u32 s97, 0
    s_cbranch_scc0 L_a_wg
    s_mov_b32 s31, 15
    s_branch L_babort
L_a_wg_ok:
    s_lshl_b32 s78, s76, 18
    s_lshl_b32 s31, s77, 13
    s_add_u32 s78, s78, s31
    s_add_u32 s31, s78, 0x0
    s_add_u32 s45, s31, 4096
    buffer_load_dwordx4 v[16:19], v4, s[8:11], s31 offen offset:0 sc1
    buffer_load_dwordx4 v[20:23], v4, s[8:11], s31 offen offset:1024 sc1
    buffer_load_dwordx4 v[24:27], v4, s[8:11], s31 offen offset:2048 sc1
    buffer_load_dwordx4 v[28:31], v4, s[8:11], s31 offen offset:3072 sc1
    buffer_load_dwordx4 v[32:35], v4, s[8:11], s45 offen offset:0 sc1
    buffer_load_dwordx4 v[36:39], v4, s[8:11], s45 offen offset:1024 sc1
    buffer_load_dwordx4 v[40:43], v4, s[8:11], s45 offen offset:2048 sc1
    buffer_load_dwordx4 v[44:47], v4, s[8:11], s45 offen offset:3072 sc1
    s_add_u32 s31, s78, 0x1000000
    s_add_u32 s45, s31, 4096
    buffer_load_dwordx4 v[48:51], v4, s[8:11], s31 offen offset:0 sc1
    buffer_load_dwordx4 v[52:55], v4, s[8:11], s31 offen offset:1024 sc1
    buffer_load_dwordx4 v[56:59], v4, s[8:11], s31 offen offset:2048 sc1
    buffer_load_dwordx4 v[60:63], v4, s[8:11], s31 offen offset:3072 sc1
    buffer_load_dwordx4 v[64:67], v4, s[8:11], s45 offen offset:0 sc1
    buffer_load_dwordx4 v[68:71], v4, s[8:11], s45 offen offset:1024 sc1
    buffer_load_dwordx4 v[72:75], v4, s[8:11], s45 offen offset:2048 sc1
    buffer_load_dwordx4 v[76:79], v4, s[8:11], s45 offen offset:3072 sc1
    s_add_u32 s31, s78, 0x2000000
    s_add_u32 s45, s31, 4096
    buffer_load_dwordx4 v[80:83], v4, s[8:11], s31 offen offset:0 sc1
    buffer_load_dwordx4 v[84:87], v4, s[8:11], s31 offen offset:1024 sc1
    buffer_load_dwordx4 v[88:91], v4, s[8:11], s31 offen offset:2048 sc1
    buffer_load_dwordx4 v[92:95], v4, s[8:11], s31 offen offset:3072 sc1
    buffer_load_dwordx4 v[96:99], v4, s[8:11], s45 offen offset:0 sc1
    buffer_load_dwordx4 v[100:103], v4, s[8:11], s45 offen offset:1024 sc1
    buffer_load_dwordx4 v[104:107], v4, s[8:11], s45 offen offset:2048 sc1
    buffer_load_dwordx4 v[108:111], v4, s[8:11], s45 offen offset:3072 sc1
    s_lshl_b32 s81, s77, 8
    s_add_u32 s81, s81, 0x5200000
L_a_wr:
    buffer_load_dword v13, v11, s[8:11], s81 offen sc1
    s_waitcnt vmcnt(0)
    v_cmp_ge_u32 vcc, s76, v13
    s_cbranch_vccz L_a_wr_ok
    s_sleep 2
    s_sub_u32 s97, s97, 1
    s_cmp_eq_u32 s97, 0
    s_cbranch_scc0 L_a_wr
    s_mov_b32 s31, 16
    s_branch L_babort
L_a_wr_ok:
    s_lshl_b32 s31, s76, 17
    s_lshl_b32 s45, s77, 12
    s_add_u32 s31, s31, s45
    s_add_u32 s31, s31, 0x3000000
    buffer_load_dwordx4 v[112:115], v4, s[8:11], s31 offen offset:0 sc1
    buffer_load_dwordx4 v[116:119], v4, s[8:11], s31 offen offset:1024 sc1
    buffer_load_dwordx4 v[120:123], v4, s[8:11], s31 offen offset:2048 sc1
    buffer_load_dwordx4 v[124:127], v4, s[8:11], s31 offen offset:3072 sc1
    s_lshl_b32 s79, s76, 18
    s_lshl_b32 s45, s77, 12
    s_add_u32 s79, s79, s45
    s_add_u32 s79, s79, 0x4000000
    s_add_u32 s80, s79, 0x20000
    s_waitcnt vmcnt(0)
    ds_write_b32 v5, v112 offset:0
    v_mov_b32 v176, v114
    ds_write_b32 v5, v113 offset:512
    v_mov_b32 v178, v115
    ds_write_b32 v5, v116 offset:1024
    v_mov_b32 v180, v118
    ds_write_b32 v5, v117 offset:1536
    v_mov_b32 v182, v119
    ds_write_b32 v5, v120 offset:2048
    v_mov_b32 v184, v122
    ds_write_b32 v5, v121 offset:2560
    v_mov_b32 v186, v123
    ds_write_b32 v5, v124 offset:3072
    v_mov_b32 v188, v126
    ds_write_b32 v5, v125 offset:3584
    v_mov_b32 v190, v127
    v_mfma_f32_16x16x32_bf16 v[148:151], v[48:51], v[16:19], 0
    v_mfma_f32_16x16x32_bf16 v[148:151], v[52:55], v[20:23], v[148:151]
    v_mfma_f32_16x16x32_bf16 v[148:151], v[56:59], v[24:27], v[148:151]
    v_mfma_f32_16x16x32_bf16 v[148:151], v[60:63], v[28:31], v[148:151]
    s_waitcnt lgkmcnt(0)
    ds_read_b64_tr_b16 v[128:129], v6 offset:0
    ds_read_b64_tr_b16 v[130:131], v6 offset:512
    ds_read_b64_tr_b16 v[132:133], v6 offset:1024
    ds_read_b64_tr_b16 v[134:135], v6 offset:1536
    ds_read_b64_tr_b16 v[136:137], v6 offset:2048
    ds_read_b64_tr_b16 v[138:139], v6 offset:2560
    ds_read_b64_tr_b16 v[140:141], v6 offset:3072
    ds_read_b64_tr_b16 v[142:143], v6 offset:3584
    v_mfma_f32_16x16x32_bf16 v[156:159], v[48:51], v[32:35], 0
    v_mfma_f32_16x16x32_bf16 v[156:159], v[52:55], v[36:39], v[156:159]
    v_mfma_f32_16x16x32_bf16 v[156:159], v[56:59], v[40:43], v[156:159]
    v_mfma_f32_16x16x32_bf16 v[156:159], v[60:63], v[44:47], v[156:159]
    v_mfma_f32_16x16x32_bf16 v[160:163], v[64:67], v[32:35], 0
    v_mfma_f32_16x16x32_bf16 v[160:163], v[68:71], v[36:39], v[160:163]
    v_mfma_f32_16x16x32_bf16 v[160:163], v[72:75], v[40:43], v[160:163]
    v_mfma_f32_16x16x32_bf16 v[160:163], v[76:79], v[44:47], v[160:163]
    s_waitcnt lgkmcnt(0)
    v_mfma_f32_16x16x32_bf16 v[144:147], v[128:131], v[16:19], 0
    v_mfma_f32_16x16x32_bf16 v[144:147], v[132:135], v[20:23], v[144:147]
    v_mfma_f32_16x16x32_bf16 v[144:147], v[136:139], v[24:27], v[144:147]
    v_mfma_f32_16x16x32_bf16 v[144:147], v[140:143], v[28:31], v[144:147]
    v_mfma_f32_16x16x32_bf16 v[152:155], v[128:131], v[32:35], 0
    v_mfma_f32_16x16x32_bf16 v[152:155], v[132:135], v[36:39], v[152:155]
    v_mfma_f32_16x16x32_bf16 v[152:155], v[136:139], v[40:43], v[152:155]
    v_mfma_f32_16x16x32_bf16 v[152:155], v[140:143], v[44:47], v[152:155]
    v_cvt_pk_bf16_f32 v208, v148, v149
    v_lshlrev_b32 v148, 16, v208
    v_and_b32 v149, 0xffff0000, v208
    v_pk_mul_f32 v[148:149], v[148:149], s[94:95]
    v_cvt_pk_bf16_f32 v208, v148, v149
    v_lshlrev_b32 v148, 16, v208
    v_and_b32 v149, 0xffff0000, v208
    v_cvt_pk_bf16_f32 v208, v150, v151
    v_lshlrev_b32 v150, 16, v208
    v_and_b32 v151, 0xffff0000, v208
    v_pk_mul_f32 v[150:151], v[150:151], s[94:95]
    v_cvt_pk_bf16_f32 v208, v150, v151
    v_lshlrev_b32 v150, 16, v208
    v_and_b32 v151, 0xffff0000, v208
    v_cvt_pk_bf16_f32 v208, v144, v145
    v_lshlrev_b32 v144, 16, v208
    v_and_b32 v145, 0xffff0000, v208
    v_pk_mul_f32 v[144:145], v[144:145], s[94:95]
    v_cvt_pk_bf16_f32 v208, v144, v145
    v_lshlrev_b32 v144, 16, v208
    v_and_b32 v145, 0xffff0000, v208
    v_cndmask_b32 v148, v148, v7, s[86:87]
    v_cndmask_b32 v149, v149, v7, s[88:89]
    v_cndmask_b32 v150, v150, v7, s[90:91]
    v_cndmask_b32 v151, v151, v7, s[92:93]
    v_max_f32 v209, v148, v149
    v_max3_f32 v209, v209, v150, v151
    v_max3_f32 v209, v209, v144, v145
    v_mov_b32 v210, v209
    s_nop 1
    v_permlane32_swap_b32 v209, v210
    v_max_f32 v209, v209, v210
    v_mov_b32 v210, v209
    s_nop 1
    v_permlane16_swap_b32 v209, v210
    v_max_f32 v209, v209, v210
    v_sub_f32 v148, v148, v209
    v_mul_f32 v148, s96, v148
    v_sub_f32 v149, v149, v209
    v_mul_f32 v149, s96, v149
    v_sub_f32 v150, v150, v209
    v_mul_f32 v150, s96, v150
    v_sub_f32 v151, v151, v209
    v_mul_f32 v151, s96, v151
    v_sub_f32 v144, v144, v209
    v_mul_f32 v144, s96, v144
    v_sub_f32 v145, v145, v209
    v_mul_f32 v145, s96, v145
    v_exp_f32 v148, v148
    v_exp_f32 v149, v149
    v_exp_f32 v150, v150
    v_exp_f32 v151, v151
    v_exp_f32 v144, v144
    v_exp_f32 v145, v145
    v_add_f32 v212, v148, v149
    v_add_f32 v212, v212, v150
    v_add_f32 v212, v212, v151
    v_add_f32 v212, v212, v144
    v_add_f32 v212, v212, v145
    v_mov_b32 v210, v212
    s_nop 1
    v_permlane32_swap_b32 v212, v210
    v_add_f32 v212, v212, v210
    v_mov_b32 v210, v212
    s_nop 1
    v_permlane16_swap_b32 v212, v210
    v_add_f32 v212, v212, v210
    v_rcp_f32 v212, v212
    s_nop 0
    v_pk_mul_f32 v[148:149], v[148:149], v[212:213] op_sel_hi:[1,0]
    v_pk_mul_f32 v[150:151], v[150:151], v[212:213] op_sel_hi:[1,0]
    v_pk_mul_f32 v[144:145], v[144:145], v[212:213] op_sel_hi:[1,0]
    v_cvt_pk_bf16_f32 v164, v148, v149
    v_cvt_pk_bf16_f32 v165, v150, v151
    v_cvt_pk_bf16_f32 v172, v144, v145
    v_cvt_pk_bf16_f32 v208, v156, v157
    v_lshlrev_b32 v156, 16, v208
    v_and_b32 v157, 0xffff0000, v208
    v_pk_mul_f32 v[156:157], v[156:157], s[94:95]
    v_cvt_pk_bf16_f32 v208, v156, v157
    v_lshlrev_b32 v156, 16, v208
    v_and_b32 v157, 0xffff0000, v208
    v_cvt_pk_bf16_f32 v208, v158, v159
    v_lshlrev_b32 v158, 16, v208
    v_and_b32 v159, 0xffff0000, v208
    v_pk_mul_f32 v[158:159], v[158:159], s[94:95]
    v_cvt_pk_bf16_f32 v208, v158, v159
    v_lshlrev_b32 v158, 16, v208
    v_and_b32 v159, 0xffff0000, v208
    v_cvt_pk_bf16_f32 v208, v160, v161
    v_lshlrev_b32 v160, 16, v208
    v_and_b32 v161, 0xffff0000, v208
    v_pk_mul_f32 v[160:161], v[160:161], s[94:95]
    v_cvt_pk_bf16_f32 v208, v160, v161
    v_lshlrev_b32 v160, 16, v208
    v_and_b32 v161, 0xffff0000, v208
    v_cvt_pk_bf16_f32 v208, v162, v163
    v_lshlrev_b32 v162, 16, v208
    v_and_b32 v163, 0xffff0000, v208
    v_pk_mul_f32 v[162:163], v[162:163], s[94:95]
    v_cvt_pk_bf16_f32 v208, v162, v163
    v_lshlrev_b32 v162, 16, v208
    v_and_b32 v163, 0xffff0000, v208
    v_cvt_pk_bf16_f32 v208, v152, v153
    v_lshlrev_b32 v152, 16, v208
    v_and_b32 v153, 0xffff0000, v208
    v_pk_mul_f32 v[152:153], v[152:153], s[94:95]
    v_cvt_pk_bf16_f32 v208, v152, v153
    v_lshlrev_b32 v152, 16, v208
    v_and_b32 v153, 0xffff0000, v208
    v_cndmask_b32 v160, v160, v7, s[86:87]
    v_cndmask_b32 v161, v161, v7, s[88:89]
    v_cndmask_b32 v162, v162, v7, s[90:91]
    v_cndmask_b32 v163, v163, v7, s[92:93]
    v_max_f32 v209, v156, v157
    v_max3_f32 v209, v209, v158, v159
    v_max3_f32 v209, v209, v160, v161
    v_max3_f32 v209, v209, v162, v163
    v_max3_f32 v209, v209, v152, v153
    v_mov_b32 v210, v209
    s_nop 1
    v_permlane32_swap_b32 v209, v210
    v_max_f32 v209, v209, v210
    v_mov_b32 v210, v209
    s_nop 1
    v_permlane16_swap_b32 v209, v210
    v_max_f32 v209, v209, v210
    v_sub_f32 v156, v156, v209
    v_mul_f32 v156, s96, v156
    v_sub_f32 v157, v157, v209
    v_mul_f32 v157, s96, v157
    v_sub_f32 v158, v158, v209
    v_mul_f32 v158, s96, v158
    v_sub_f32 v159, v159, v209
    v_mul_f32 v159, s96, v159
    v_sub_f32 v160, v160, v209
    v_mul_f32 v160, s96, v160
    v_sub_f32 v161, v161, v209
    v_mul_f32 v161, s96, v161
    v_sub_f32 v162, v162, v209
    v_mul_f32 v162, s96, v162
    v_sub_f32 v163, v163, v209
    v_mul_f32 v163, s96, v163
    v_sub_f32 v152, v152, v209
    v_mul_f32 v152, s96, v152
    v_sub_f32 v153, v153, v209
    v_mul_f32 v153, s96, v153
    v_exp_f32 v156, v156
    v_exp_f32 v157, v157
    v_exp_f32 v158, v158
    v_exp_f32 v159, v159
    v_exp_f32 v160, v160
    v_exp_f32 v161, v161
    v_exp_f32 v162, v162
    v_exp_f32 v163, v163
    v_exp_f32 v152, v152
    v_exp_f32 v153, v153
    v_add_f32 v212, v156, v157
    v_add_f32 v212, v212, v158
    v_add_f32 v212, v212, v159
    v_add_f32 v212, v212, v160
    v_add_f32 v212, v212, v161
    v_add_f32 v212, v212, v162
    v_add_f32 v212, v212, v163
    v_add_f32 v212, v212, v152
    v_add_f32 v212, v212, v153
    v_mov_b32 v210, v212
    s_nop 1
    v_permlane32_swap_b32 v212, v210
    v_add_f32 v212, v212, v210
    v_mov_b32 v210, v212
    s_nop 1
    v_permlane16_swap_b32 v212, v210
    v_add_f32 v212, v212, v210
    v_rcp_f32 v212, v212
    s_nop 0
    v_pk_mul_f32 v[156:157], v[156:157], v[212:213] op_sel_hi:[1,0]
    v_pk_mul_f32 v[158:159], v[158:159], v[212:213] op_sel_hi:[1,0]
    v_pk_mul_f32 v[160:161], v[160:161], v[212:213] op_sel_hi:[1,0]
    v_pk_mul_f32 v[162:163], v[162:163], v[212:213] op_sel_hi:[1,0]
    v_pk_mul_f32 v[152:153], v[152:153], v[212:213] op_sel_hi:[1,0]
    v_cvt_pk_bf16_f32 v168, v156, v157
    v_cvt_pk_bf16_f32 v169, v158, v159
    v_cvt_pk_bf16_f32 v170, v160, v161
    v_cvt_pk_bf16_f32 v171, v162, v163
    v_cvt_pk_bf16_f32 v174, v152, v153
    v_mfma_f32_16x16x32_bf16 v[192:195], v[80:83], v[164:167], 0
    v_mfma_f32_16x16x32_bf16 v[196:199], v[84:87], v[164:167], 0
    v_mfma_f32_16x16x16_bf16 v[192:195], v[176:177], v[172:173], v[192:195]
    v_mfma_f32_16x16x16_bf16 v[196:199], v[178:179], v[172:173], v[196:199]
    v_mfma_f32_16x16x32_bf16 v[216:219], v[88:91], v[164:167], 0
    v_mfma_f32_16x16x32_bf16 v[220:223], v[92:95], v[164:167], 0
    v_mfma_f32_16x16x16_bf16 v[216:219], v[180:181], v[172:173], v[216:219]
    v_mfma_f32_16x16x16_bf16 v[220:223], v[182:183], v[172:173], v[220:223]
    v_cvt_pk_bf16_f32 v200, v192, v193
    v_cvt_pk_bf16_f32 v201, v194, v195
    v_cvt_pk_bf16_f32 v202, v196, v197
    v_cvt_pk_bf16_f32 v203, v198, v199
    buffer_store_dwordx4 v[200:203], v4, s[8:11], s79 offen offset:0 sc1
    v_mfma_f32_16x16x32_bf16 v[192:195], v[96:99], v[164:167], 0
    v_mfma_f32_16x16x32_bf16 v[196:199], v[100:103], v[164:167], 0
    v_mfma_f32_16x16x16_bf16 v[192:195], v[184:185], v[172:173], v[192:195]
    v_mfma_f32_16x16x16_bf16 v[196:199], v[186:187], v[172:173], v[196:199]
    v_cvt_pk_bf16_f32 v204, v216, v217
    v_cvt_pk_bf16_f32 v205, v218, v219
    v_cvt_pk_bf16_f32 v206, v220, v221
    v_cvt_pk_bf16_f32 v207, v222, v223
    buffer_store_dwordx4 v[204:207], v4, s[8:11], s79 offen offset:1024 sc1
    v_mfma_f32_16x16x32_bf16 v[216:219], v[104:107], v[164:167], 0
    v_mfma_f32_16x16x32_bf16 v[220:223], v[108:111], v[164:167], 0
    v_mfma_f32_16x16x16_bf16 v[216:219], v[188:189], v[172:173], v[216:219]
    v_mfma_f32_16x16x16_bf16 v[220:223], v[190:191], v[172:173], v[220:223]
    v_cvt_pk_bf16_f32 v200, v192, v193
    v_cvt_pk_bf16_f32 v201, v194, v195
    v_cvt_pk_bf16_f32 v202, v196, v197
    v_cvt_pk_bf16_f32 v203, v198, v199
    buffer_store_dwordx4 v[200:203], v4, s[8:11], s79 offen offset:2048 sc1
    v_mfma_f32_16x16x32_bf16 v[192:195], v[80:83], v[168:171], 0
    v_mfma_f32_16x16x32_bf16 v[196:199], v[84:87], v[168:171], 0
    v_mfma_f32_16x16x16_bf16 v[192:195], v[176:177], v[174:175], v[192:195]
    v_mfma_f32_16x16x16_bf16 v[196:199], v[178:179], v[174:175], v[196:199]
    v_cvt_pk_bf16_f32 v204, v216, v217
    v_cvt_pk_bf16_f32 v205, v218, v219
    v_cvt_pk_bf16_f32 v206, v220, v221
    v_cvt_pk_bf16_f32 v207, v222, v223
    buffer_store_dwordx4 v[204:207], v4, s[8:11], s79 offen offset:3072 sc1
    v_mfma_f32_16x16x32_bf16 v[216:219], v[88:91], v[168:171], 0
    v_mfma_f32_16x16x32_bf16 v[220:223], v[92:95], v[168:171], 0
    v_mfma_f32_16x16x16_bf16 v[216:219], v[180:181], v[174:175], v[216:219]
    v_mfma_f32_16x16x16_bf16 v[220:223], v[182:183], v[174:175], v[220:223]
    v_cvt_pk_bf16_f32 v200, v192, v193
    v_cvt_pk_bf16_f32 v201, v194, v195
    v_cvt_pk_bf16_f32 v202, v196, v197
    v_cvt_pk_bf16_f32 v203, v198, v199
    buffer_store_dwordx4 v[200:203], v4, s[8:11], s80 offen offset:0 sc1
    v_mfma_f32_16x16x32_bf16 v[192:195], v[96:99], v[168:171], 0
    v_mfma_f32_16x16x32_bf16 v[196:199], v[100:103], v[168:171], 0
    v_mfma_f32_16x16x16_bf16 v[192:195], v[184:185], v[174:175], v[192:195]
    v_mfma_f32_16x16x16_bf16 v[196:199], v[186:187], v[174:175], v[196:199]
    v_cvt_pk_bf16_f32 v204, v216, v217
    v_cvt_pk_bf16_f32 v205, v218, v219
    v_cvt_pk_bf16_f32 v206, v220, v221
    v_cvt_pk_bf16_f32 v207, v222, v223
    buffer_store_dwordx4 v[204:207], v4, s[8:11], s80 offen offset:1024 sc1
    v_mfma_f32_16x16x32_bf16 v[216:219], v[104:107], v[168:171], 0
    v_mfma_f32_16x16x32_bf16 v[220:223], v[108:111], v[168:171], 0
    v_mfma_f32_16x16x16_bf16 v[216:219], v[188:189], v[174:175], v[216:219]
    v_mfma_f32_16x16x16_bf16 v[220:223], v[190:191], v[174:175], v[220:223]
    v_cvt_pk_bf16_f32 v200, v192, v193
    v_cvt_pk_bf16_f32 v201, v194, v195
    v_cvt_pk_bf16_f32 v202, v196, v197
    v_cvt_pk_bf16_f32 v203, v198, v199
    buffer_store_dwordx4 v[200:203], v4, s[8:11], s80 offen offset:2048 sc1
    v_cvt_pk_bf16_f32 v204, v216, v217
    v_cvt_pk_bf16_f32 v205, v218, v219
    s_nop 0
    v_cvt_pk_bf16_f32 v206, v220, v221
    v_cvt_pk_bf16_f32 v207, v222, v223
    buffer_store_dwordx4 v[204:207], v4, s[8:11], s80 offen offset:3072 sc1
    s_lshl_b32 s81, s76, 7
    s_lshl_b32 s31, s77, 2
    s_add_u32 s81, s81, s31
    s_add_u32 s81, s81, 0x5203000
    s_waitcnt vmcnt(0)
    s_mov_b64 exec, 1
    buffer_store_dword v12, v11, s[8:11], s81 offen sc1
    s_mov_b64 exec, -1
    s_add_u32 s76, s76, 8
    s_cmp_lt_u32 s76, 64
    s_nop 11
    s_cbranch_scc1 L_attn_loop
    s_branch L_end
L_oproj:
    s_nop 11
    s_waitcnt vmcnt(0) lgkmcnt(0)
    s_and_b32 s77, s99, 15
    v_and_b32 v1, 63, v0
    v_and_b32 v2, 15, v0
    v_bfe_u32 v3, v0, 4, 2
    v_lshlrev_b32 v4, 4, v1
    s_mov_b32 s16, s62
    s_and_b32 s17, s63, 0xffff
    s_mov_b32 s18, 0x400000
    s_mov_b32 s19, 0x20000
    v_lshrrev_b32 v10, 2, v1
    v_lshlrev_b32 v10, 10, v10
    v_and_b32 v11, 3, v1
    v_lshl_add_u32 v5, v11, 4, v10
    v_lshrrev_b32 v10, 2, v2
    v_lshl_add_u32 v10, v3, 2, v10
    v_lshlrev_b32 v10, 6, v10
    v_and_b32 v11, 3, v2
    v_lshl_add_u32 v10, v11, 4, v10
    s_lshl_b32 s78, s25, 14
    v_add_u32 v6, s78, v10
    s_lshl_b32 s79, s25, 20
    s_lshl_b32 s31, s77, 6
    s_add_u32 s79, s79, s31
    s_barrier
    s_add_u32 s45, s78, 0
    s_mov_b32 m0, s45
    s_nop 0
    buffer_load_dwordx4 v5, s[16:19], s79 offen lds
    s_add_u32 s79, s79, 0x4000
    s_add_u32 s45, s45, 0x400
    s_mov_b32 m0, s45
    s_nop 0
    buffer_load_dwordx4 v5, s[16:19], s79 offen lds
    s_add_u32 s79, s79, 0x4000
    s_add_u32 s45, s45, 0x400
    s_mov_b32 m0, s45
    s_nop 0
    buffer_load_dwordx4 v5, s[16:19], s79 offen lds
    s_add_u32 s79, s79, 0x4000
    s_add_u32 s45, s45, 0x400
    s_mov_b32 m0, s45
    s_nop 0
    buffer_load_dwordx4 v5, s[16:19], s79 offen lds
    s_add_u32 s79, s79, 0x4000
    s_add_u32 s45, s45, 0x400
    s_mov_b32 m0, s45
    s_nop 0
    buffer_load_dwordx4 v5, s[16:19], s79 offen lds
    s_add_u32 s79, s79, 0x4000
    s_add_u32 s45, s45, 0x400
    s_mov_b32 m0, s45
    s_nop 0
    buffer_load_dwordx4 v5, s[16:19], s79 offen lds
    s_add_u32 s79, s79, 0x4000
    s_add_u32 s45, s45, 0x400
    s_mov_b32 m0, s45
    s_nop 0
    buffer_load_dwordx4 v5, s[16:19], s79 offen lds
    s_add_u32 s79, s79, 0x4000
    s_add_u32 s45, s45, 0x400
    s_mov_b32 m0, s45
    s_nop 0
    buffer_load_dwordx4 v5, s[16:19], s79 offen lds
    s_add_u32 s79, s79, 0x4000
    s_add_u32 s45, s45, 0x400
    s_add_u32 s45, s78, 8192
    s_mov_b32 m0, s45
    s_nop 0
    buffer_load_dwordx4 v5, s[16:19], s79 offen lds
    s_add_u32 s79, s79, 0x4000
    s_add_u32 s45, s45, 0x400
    s_mov_b32 m0, s45
    s_nop 0
    buffer_load_dwordx4 v5, s[16:19], s79 offen lds
    s_add_u32 s79, s79, 0x4000
    s_add_u32 s45, s45, 0x400
    s_mov_b32 m0, s45
    s_nop 0
    buffer_load_dwordx4 v5, s[16:19], s79 offen lds
    s_add_u32 s79, s79, 0x4000
    s_add_u32 s45, s45, 0x400
    s_mov_b32 m0, s45
    s_nop 0
    buffer_load_dwordx4 v5, s[16:19], s79 offen lds
    s_add_u32 s79, s79, 0x4000
    s_add_u32 s45, s45, 0x400
    s_mov_b32 m0, s45
    s_nop 0
    buffer_load_dwordx4 v5, s[16:19], s79 offen lds
    s_add_u32 s79, s79, 0x4000
    s_add_u32 s45, s45, 0x400
    s_mov_b32 m0, s45
    s_nop 0
    buffer_load_dwordx4 v5, s[16:19], s79 offen lds
    s_add_u32 s79, s79, 0x4000
    s_add_u32 s45, s45, 0x400
    s_mov_b32 m0, s45
    s_nop 0
    buffer_load_dwordx4 v5, s[16:19], s79 offen lds
    s_add_u32 s79, s79, 0x4000
    s_add_u32 s45, s45, 0x400
    s_mov_b32 m0, s45
    s_nop 0
    buffer_load_dwordx4 v5, s[16:19], s79 offen lds
    s_add_u32 s79, s79, 0x4000
    s_add_u32 s45, s45, 0x400
    s_waitcnt vmcnt(8)
    ds_read_b64_tr_b16 a[0:1], v6 offset:0
    ds_read_b64_tr_b16 a[2:3], v6 offset:1024
    ds_read_b64_tr_b16 a[4:5], v6 offset:8
    ds_read_b64_tr_b16 a[6:7], v6 offset:1032
    ds_read_b64_tr_b16 a[8:9], v6 offset:2048
    ds_read_b64_tr_b16 a[10:11], v6 offset:3072
    ds_read_b64_tr_b16 a[12:13], v6 offset:2056
    ds_read_b64_tr_b16 a[14:15], v6 offset:3080
    ds_read_b64_tr_b16 a[16:17], v6 offset:4096
    ds_read_b64_tr_b16 a[18:19], v6 offset:5120
    ds_read_b64_tr_b16 a[20:21], v6 offset:4104
    ds_read_b64_tr_b16 a[22:23], v6 offset:5128
    s_waitcnt lgkmcnt(4)
    ds_read_b64_tr_b16 a[24:25], v6 offset:6144
    ds_read_b64_tr_b16 a[26:27], v6 offset:7168
    ds_read_b64_tr_b16 a[28:29], v6 offset:6152
    ds_read_b64_tr_b16 a[30:31], v6 offset:7176
    s_waitcnt lgkmcnt(0)
    s_add_u32 s45, s78, 0
    s_mov_b32 m0, s45
    s_nop 0
    buffer_load_dwordx4 v5, s[16:19], s79 offen lds
    s_add_u32 s79, s79, 0x4000
    s_add_u32 s45, s45, 0x400
    s_mov_b32 m0, s45
    s_nop 0
    buffer_load_dwordx4 v5, s[16:19], s79 offen lds
    s_add_u32 s79, s79, 0x4000
    s_add_u32 s45, s45, 0x400
    s_mov_b32 m0, s45
    s_nop 0
    buffer_load_dwordx4 v5, s[16:19], s79 offen lds
    s_add_u32 s79, s79, 0x4000
    s_add_u32 s45, s45, 0x400
    s_mov_b32 m0, s45
    s_nop 0
    buffer_load_dwordx4 v5, s[16:19], s79 offen lds
    s_add_u32 s79, s79, 0x4000
    s_add_u32 s45, s45, 0x400
    s_mov_b32 m0, s45
    s_nop 0
    buffer_load_dwordx4 v5, s[16:19], s79 offen lds
    s_add_u32 s79, s79, 0x4000
    s_add_u32 s45, s45, 0x400
    s_mov_b32 m0, s45
    s_nop 0
    buffer_load_dwordx4 v5, s[16:19], s79 offen lds
    s_add_u32 s79, s79, 0x4000
    s_add_u32 s45, s45, 0x400
    s_mov_b32 m0, s45
    s_nop 0
    buffer_load_dwordx4 v5, s[16:19], s79 offen lds
    s_add_u32 s79, s79, 0x4000
    s_add_u32 s45, s45, 0x400
    s_mov_b32 m0, s45
    s_nop 0
    buffer_load_dwordx4 v5, s[16:19], s79 offen lds
    s_add_u32 s79, s79, 0x4000
    s_add_u32 s45, s45, 0x400
    s_waitcnt vmcnt(8)
    ds_read_b64_tr_b16 a[32:33], v6 offset:8192
    ds_read_b64_tr_b16 a[34:35], v6 offset:9216
    ds_read_b64_tr_b16 a[36:37], v6 offset:8200
    ds_read_b64_tr_b16 a[38:39], v6 offset:9224
    ds_read_b64_tr_b16 a[40:41], v6 offset:10240
    ds_read_b64_tr_b16 a[42:43], v6 offset:11264
    ds_read_b64_tr_b16 a[44:45], v6 offset:10248
    ds_read_b64_tr_b16 a[46:47], v6 offset:11272
    ds_read_b64_tr_b16 a[48:49], v6 offset:12288
    ds_read_b64_tr_b16 a[50:51], v6 offset:13312
    ds_read_b64_tr_b16 a[52:53], v6 offset:12296
    ds_read_b64_tr_b16 a[54:55], v6 offset:13320
    s_waitcnt lgkmcnt(4)
    ds_read_b64_tr_b16 a[56:57], v6 offset:14336
    ds_read_b64_tr_b16 a[58:59], v6 offset:15360
    ds_read_b64_tr_b16 a[60:61], v6 offset:14344
    ds_read_b64_tr_b16 a[62:63], v6 offset:15368
    s_waitcnt lgkmcnt(0)
    s_add_u32 s45, s78, 8192
    s_mov_b32 m0, s45
    s_nop 0
    buffer_load_dwordx4 v5, s[16:19], s79 offen lds
    s_add_u32 s79, s79, 0x4000
    s_add_u32 s45, s45, 0x400
    s_mov_b32 m0, s45
    s_nop 0
    buffer_load_dwordx4 v5, s[16:19], s79 offen lds
    s_add_u32 s79, s79, 0x4000
    s_add_u32 s45, s45, 0x400
    s_mov_b32 m0, s45
    s_nop 0
    buffer_load_dwordx4 v5, s[16:19], s79 offen lds
    s_add_u32 s79, s79, 0x4000
    s_add_u32 s45, s45, 0x400
    s_mov_b32 m0, s45
    s_nop 0
    buffer_load_dwordx4 v5, s[16:19], s79 offen lds
    s_add_u32 s79, s79, 0x4000
    s_add_u32 s45, s45, 0x400
    s_mov_b32 m0, s45
    s_nop 0
    buffer_load_dwordx4 v5, s[16:19], s79 offen lds
    s_add_u32 s79, s79, 0x4000
    s_add_u32 s45, s45, 0x400
    s_mov_b32 m0, s45
    s_nop 0
    buffer_load_dwordx4 v5, s[16:19], s79 offen lds
    s_add_u32 s79, s79, 0x4000
    s_add_u32 s45, s45, 0x400
    s_mov_b32 m0, s45
    s_nop 0
    buffer_load_dwordx4 v5, s[16:19], s79 offen lds
    s_add_u32 s79, s79, 0x4000
    s_add_u32 s45, s45, 0x400
    s_mov_b32 m0, s45
    s_nop 0
    buffer_load_dwordx4 v5, s[16:19], s79 offen lds
    s_add_u32 s79, s79, 0x4000
    s_add_u32 s45, s45, 0x400
    s_waitcnt vmcnt(8)
    ds_read_b64_tr_b16 a[64:65], v6 offset:0
    ds_read_b64_tr_b16 a[66:67], v6 offset:1024
    ds_read_b64_tr_b16 a[68:69], v6 offset:8
    ds_read_b64_tr_b16 a[70:71], v6 offset:1032
    ds_read_b64_tr_b16 a[72:73], v6 offset:2048
    ds_read_b64_tr_b16 a[74:75], v6 offset:3072
    ds_read_b64_tr_b16 a[76:77], v6 offset:2056
    ds_read_b64_tr_b16 a[78:79], v6 offset:3080
    ds_read_b64_tr_b16 a[80:81], v6 offset:4096
    ds_read_b64_tr_b16 a[82:83], v6 offset:5120
    ds_read_b64_tr_b16 a[84:85], v6 offset:4104
    ds_read_b64_tr_b16 a[86:87], v6 offset:5128
    s_waitcnt lgkmcnt(4)
    ds_read_b64_tr_b16 a[88:89], v6 offset:6144
    ds_read_b64_tr_b16 a[90:91], v6 offset:7168
    ds_read_b64_tr_b16 a[92:93], v6 offset:6152
    ds_read_b64_tr_b16 a[94:95], v6 offset:7176
    s_waitcnt lgkmcnt(0)
    s_add_u32 s45, s78, 0
    s_mov_b32 m0, s45
    s_nop 0
    buffer_load_dwordx4 v5, s[16:19], s79 offen lds
    s_add_u32 s79, s79, 0x4000
    s_add_u32 s45, s45, 0x400
    s_mov_b32 m0, s45
    s_nop 0
    buffer_load_dwordx4 v5, s[16:19], s79 offen lds
    s_add_u32 s79, s79, 0x4000
    s_add_u32 s45, s45, 0x400
    s_mov_b32 m0, s45
    s_nop 0
    buffer_load_dwordx4 v5, s[16:19], s79 offen lds
    s_add_u32 s79, s79, 0x4000
    s_add_u32 s45, s45, 0x400
    s_mov_b32 m0, s45
    s_nop 0
    buffer_load_dwordx4 v5, s[16:19], s79 offen lds
    s_add_u32 s79, s79, 0x4000
    s_add_u32 s45, s45, 0x400
    s_mov_b32 m0, s45
    s_nop 0
    buffer_load_dwordx4 v5, s[16:19], s79 offen lds
    s_add_u32 s79, s79, 0x4000
    s_add_u32 s45, s45, 0x400
    s_mov_b32 m0, s45
    s_nop 0
    buffer_load_dwordx4 v5, s[16:19], s79 offen lds
    s_add_u32 s79, s79, 0x4000
    s_add_u32 s45, s45, 0x400
    s_mov_b32 m0, s45
    s_nop 0
    buffer_load_dwordx4 v5, s[16:19], s79 offen lds
    s_add_u32 s79, s79, 0x4000
    s_add_u32 s45, s45, 0x400
    s_mov_b32 m0, s45
    s_nop 0
    buffer_load_dwordx4 v5, s[16:19], s79 offen lds
    s_add_u32 s79, s79, 0x4000
    s_add_u32 s45, s45, 0x400
    s_waitcnt vmcnt(8)
    ds_read_b64_tr_b16 a[96:97], v6 offset:8192
    ds_read_b64_tr_b16 a[98:99], v6 offset:9216
    ds_read_b64_tr_b16 a[100:101], v6 offset:8200
    ds_read_b64_tr_b16 a[102:103], v6 offset:9224
    ds_read_b64_tr_b16 a[104:105], v6 offset:10240
    ds_read_b64_tr_b16 a[106:107], v6 offset:11264
    ds_read_b64_tr_b16 a[108:109], v6 offset:10248
    ds_read_b64_tr_b16 a[110:111], v6 offset:11272
    ds_read_b64_tr_b16 a[112:113], v6 offset:12288
    ds_read_b64_tr_b16 a[114:115], v6 offset:13312
    ds_read_b64_tr_b16 a[116:117], v6 offset:12296
    ds_read_b64_tr_b16 a[118:119], v6 offset:13320
    s_waitcnt lgkmcnt(4)
    ds_read_b64_tr_b16 a[120:121], v6 offset:14336
    ds_read_b64_tr_b16 a[122:123], v6 offset:15360
    ds_read_b64_tr_b16 a[124:125], v6 offset:14344
    ds_read_b64_tr_b16 a[126:127], v6 offset:15368
    s_waitcnt lgkmcnt(0)
    s_add_u32 s45, s78, 8192
    s_mov_b32 m0, s45
    s_nop 0
    buffer_load_dwordx4 v5, s[16:19], s79 offen lds
    s_add_u32 s79, s79, 0x4000
    s_add_u32 s45, s45, 0x400
    s_mov_b32 m0, s45
    s_nop 0
    buffer_load_dwordx4 v5, s[16:19], s79 offen lds
    s_add_u32 s79, s79, 0x4000
    s_add_u32 s45, s45, 0x400
    s_mov_b32 m0, s45
    s_nop 0
    buffer_load_dwordx4 v5, s[16:19], s79 offen lds
    s_add_u32 s79, s79, 0x4000
    s_add_u32 s45, s45, 0x400
    s_mov_b32 m0, s45
    s_nop 0
    buffer_load_dwordx4 v5, s[16:19], s79 offen lds
    s_add_u32 s79, s79, 0x4000
    s_add_u32 s45, s45, 0x400
    s_mov_b32 m0, s45
    s_nop 0
    buffer_load_dwordx4 v5, s[16:19], s79 offen lds
    s_add_u32 s79, s79, 0x4000
    s_add_u32 s45, s45, 0x400
    s_mov_b32 m0, s45
    s_nop 0
    buffer_load_dwordx4 v5, s[16:19], s79 offen lds
    s_add_u32 s79, s79, 0x4000
    s_add_u32 s45, s45, 0x400
    s_mov_b32 m0, s45
    s_nop 0
    buffer_load_dwordx4 v5, s[16:19], s79 offen lds
    s_add_u32 s79, s79, 0x4000
    s_add_u32 s45, s45, 0x400
    s_mov_b32 m0, s45
    s_nop 0
    buffer_load_dwordx4 v5, s[16:19], s79 offen lds
    s_add_u32 s79, s79, 0x4000
    s_add_u32 s45, s45, 0x400
    s_waitcnt vmcnt(8)
    ds_read_b64_tr_b16 a[128:129], v6 offset:0
    ds_read_b64_tr_b16 a[130:131], v6 offset:1024
    ds_read_b64_tr_b16 a[132:133], v6 offset:8
    ds_read_b64_tr_b16 a[134:135], v6 offset:1032
    ds_read_b64_tr_b16 a[136:137], v6 offset:2048
    ds_read_b64_tr_b16 a[138:139], v6 offset:3072
    ds_read_b64_tr_b16 a[140:141], v6 offset:2056
    ds_read_b64_tr_b16 a[142:143], v6 offset:3080
    ds_read_b64_tr_b16 a[144:145], v6 offset:4096
    ds_read_b64_tr_b16 a[146:147], v6 offset:5120
    ds_read_b64_tr_b16 a[148:149], v6 offset:4104
    ds_read_b64_tr_b16 a[150:151], v6 offset:5128
    s_waitcnt lgkmcnt(4)
    ds_read_b64_tr_b16 a[152:153], v6 offset:6144
    ds_read_b64_tr_b16 a[154:155], v6 offset:7168
    ds_read_b64_tr_b16 a[156:157], v6 offset:6152
    ds_read_b64_tr_b16 a[158:159], v6 offset:7176
    s_waitcnt lgkmcnt(0)
    s_add_u32 s45, s78, 0
    s_mov_b32 m0, s45
    s_nop 0
    buffer_load_dwordx4 v5, s[16:19], s79 offen lds
    s_add_u32 s79, s79, 0x4000
    s_add_u32 s45, s45, 0x400
    s_mov_b32 m0, s45
    s_nop 0
    buffer_load_dwordx4 v5, s[16:19], s79 offen lds
    s_add_u32 s79, s79, 0x4000
    s_add_u32 s45, s45, 0x400
    s_mov_b32 m0, s45
    s_nop 0
    buffer_load_dwordx4 v5, s[16:19], s79 offen lds
    s_add_u32 s79, s79, 0x4000
    s_add_u32 s45, s45, 0x400
    s_mov_b32 m0, s45
    s_nop 0
    buffer_load_dwordx4 v5, s[16:19], s79 offen lds
    s_add_u32 s79, s79, 0x4000
    s_add_u32 s45, s45, 0x400
    s_mov_b32 m0, s45
    s_nop 0
    buffer_load_dwordx4 v5, s[16:19], s79 offen lds
    s_add_u32 s79, s79, 0x4000
    s_add_u32 s45, s45, 0x400
    s_mov_b32 m0, s45
    s_nop 0
    buffer_load_dwordx4 v5, s[16:19], s79 offen lds
    s_add_u32 s79, s79, 0x4000
    s_add_u32 s45, s45, 0x400
    s_mov_b32 m0, s45
    s_nop 0
    buffer_load_dwordx4 v5, s[16:19], s79 offen lds
    s_add_u32 s79, s79, 0x4000
    s_add_u32 s45, s45, 0x400
    s_mov_b32 m0, s45
    s_nop 0
    buffer_load_dwordx4 v5, s[16:19], s79 offen lds
    s_add_u32 s79, s79, 0x4000
    s_add_u32 s45, s45, 0x400
    s_waitcnt vmcnt(8)
    ds_read_b64_tr_b16 a[160:161], v6 offset:8192
    ds_read_b64_tr_b16 a[162:163], v6 offset:9216
    ds_read_b64_tr_b16 a[164:165], v6 offset:8200
    ds_read_b64_tr_b16 a[166:167], v6 offset:9224
    ds_read_b64_tr_b16 a[168:169], v6 offset:10240
    ds_read_b64_tr_b16 a[170:171], v6 offset:11264
    ds_read_b64_tr_b16 a[172:173], v6 offset:10248
    ds_read_b64_tr_b16 a[174:175], v6 offset:11272
    ds_read_b64_tr_b16 a[176:177], v6 offset:12288
    ds_read_b64_tr_b16 a[178:179], v6 offset:13312
    ds_read_b64_tr_b16 a[180:181], v6 offset:12296
    ds_read_b64_tr_b16 a[182:183], v6 offset:13320
    s_waitcnt lgkmcnt(4)
    ds_read_b64_tr_b16 a[184:185], v6 offset:14336
    ds_read_b64_tr_b16 a[186:187], v6 offset:15360
    ds_read_b64_tr_b16 a[188:189], v6 offset:14344
    ds_read_b64_tr_b16 a[190:191], v6 offset:15368
    s_waitcnt lgkmcnt(0)
    s_add_u32 s45, s78, 8192
    s_mov_b32 m0, s45
    s_nop 0
    buffer_load_dwordx4 v5, s[16:19], s79 offen lds
    s_add_u32 s79, s79, 0x4000
    s_add_u32 s45, s45, 0x400
    s_mov_b32 m0, s45
    s_nop 0
    buffer_load_dwordx4 v5, s[16:19], s79 offen lds
    s_add_u32 s79, s79, 0x4000
    s_add_u32 s45, s45, 0x400
    s_mov_b32 m0, s45
    s_nop 0
    buffer_load_dwordx4 v5, s[16:19], s79 offen lds
    s_add_u32 s79, s79, 0x4000
    s_add_u32 s45, s45, 0x400
    s_mov_b32 m0, s45
    s_nop 0
    buffer_load_dwordx4 v5, s[16:19], s79 offen lds
    s_add_u32 s79, s79, 0x4000
    s_add_u32 s45, s45, 0x400
    s_mov_b32 m0, s45
    s_nop 0
    buffer_load_dwordx4 v5, s[16:19], s79 offen lds
    s_add_u32 s79, s79, 0x4000
    s_add_u32 s45, s45, 0x400
    s_mov_b32 m0, s45
    s_nop 0
    buffer_load_dwordx4 v5, s[16:19], s79 offen lds
    s_add_u32 s79, s79, 0x4000
    s_add_u32 s45, s45, 0x400
    s_mov_b32 m0, s45
    s_nop 0
    buffer_load_dwordx4 v5, s[16:19], s79 offen lds
    s_add_u32 s79, s79, 0x4000
    s_add_u32 s45, s45, 0x400
    s_mov_b32 m0, s45
    s_nop 0
    buffer_load_dwordx4 v5, s[16:19], s79 offen lds
    s_add_u32 s79, s79, 0x4000
    s_add_u32 s45, s45, 0x400
    s_waitcnt vmcnt(8)
    ds_read_b64_tr_b16 a[192:193], v6 offset:0
    ds_read_b64_tr_b16 a[194:195], v6 offset:1024
    ds_read_b64_tr_b16 a[196:197], v6 offset:8
    ds_read_b64_tr_b16 a[198:199], v6 offset:1032
    ds_read_b64_tr_b16 a[200:201], v6 offset:2048
    ds_read_b64_tr_b16 a[202:203], v6 offset:3072
    ds_read_b64_tr_b16 a[204:205], v6 offset:2056
    ds_read_b64_tr_b16 a[206:207], v6 offset:3080
    ds_read_b64_tr_b16 a[208:209], v6 offset:4096
    ds_read_b64_tr_b16 a[210:211], v6 offset:5120
    ds_read_b64_tr_b16 a[212:213], v6 offset:4104
    ds_read_b64_tr_b16 a[214:215], v6 offset:5128
    s_waitcnt lgkmcnt(4)
    ds_read_b64_tr_b16 a[216:217], v6 offset:6144
    ds_read_b64_tr_b16 a[218:219], v6 offset:7168
    ds_read_b64_tr_b16 a[220:221], v6 offset:6152
    ds_read_b64_tr_b16 a[222:223], v6 offset:7176
    s_waitcnt lgkmcnt(0)
    s_waitcnt vmcnt(0)
    ds_read_b64_tr_b16 a[224:225], v6 offset:8192
    ds_read_b64_tr_b16 a[226:227], v6 offset:9216
    ds_read_b64_tr_b16 a[228:229], v6 offset:8200
    ds_read_b64_tr_b16 a[230:231], v6 offset:9224
    ds_read_b64_tr_b16 a[232:233], v6 offset:10240
    ds_read_b64_tr_b16 a[234:235], v6 offset:11264
    ds_read_b64_tr_b16 a[236:237], v6 offset:10248
    ds_read_b64_tr_b16 a[238:239], v6 offset:11272
    ds_read_b64_tr_b16 a[240:241], v6 offset:12288
    ds_read_b64_tr_b16 a[242:243], v6 offset:13312
    ds_read_b64_tr_b16 a[244:245], v6 offset:12296
    ds_read_b64_tr_b16 a[246:247], v6 offset:13320
    s_waitcnt lgkmcnt(4)
    ds_read_b64_tr_b16 a[248:249], v6 offset:14336
    ds_read_b64_tr_b16 a[250:251], v6 offset:15360
    ds_read_b64_tr_b16 a[252:253], v6 offset:14344
    ds_read_b64_tr_b16 a[254:255], v6 offset:15368
    s_waitcnt lgkmcnt(0)
    s_and_b32 s31, s25, 1
    s_lshl_b32 s31, s31, 11
    s_lshr_b32 s45, s25, 1
    s_lshl_b32 s45, s45, 10
    s_add_u32 s31, s31, s45
    s_add_u32 s31, s31, 65536
    v_add_u32 v7, s31, v4
    s_lshl_b32 s31, s25, 12
    s_add_u32 s31, s31, 65536
    v_add_u32 v8, s31, v4
    s_and_b32 s31, s25, 1
    s_lshl_b32 s31, s31, 4
    v_add_u32 v10, s31, v2
    v_lshlrev_b32 v12, 2, v10
    s_lshl_b32 s31, s77, 5
    s_lshr_b32 s45, s25, 1
    s_lshl_b32 s45, s45, 2
    s_add_u32 s31, s31, s45
    v_lshlrev_b32 v11, 3, v3
    v_add_u32 v11, s31, v11
    v_lshlrev_b32 v13, 2, v11
    v_lshlrev_b32 v10, 10, v10
    v_lshl_add_u32 v9, v11, 1, v10
    v_mov_b32 v250, 56
L_o_dn:
    buffer_load_dword v251, v250, s[12:15], 0 offen sc1
    s_waitcnt vmcnt(0)
    v_cmp_gt_u32 vcc, 16, v251
    s_cbranch_vccz L_o_dn_ok
    s_sleep 4
    s_sub_u32 s97, s97, 1
    s_cmp_eq_u32 s97, 0
    s_cbranch_scc0 L_o_dn
    s_mov_b32 s31, 17
    s_branch L_babort
L_o_dn_ok:
    s_lshr_b32 s76, s99, 4
    v_and_b32 v14, 31, v1
    v_lshlrev_b32 v14, 2, v14
L_o_loop:
    s_lshl_b32 s81, s76, 7
    s_add_u32 s81, s81, 0x5203000
L_o_w:
    buffer_load_dword v15, v14, s[8:11], s81 offen sc1
    s_waitcnt vmcnt(0)
    v_cmp_eq_u32 vcc, 0, v15
    s_cbranch_vccz L_o_w_ok
    s_sleep 2
    s_sub_u32 s97, s97, 1
    s_cmp_eq_u32 s97, 0
    s_cbranch_scc0 L_o_w
    s_mov_b32 s31, 18
    s_branch L_babort
L_o_w_ok:
    s_lshl_b32 s78, s76, 18
    s_lshl_b32 s31, s25, 15
    s_add_u32 s78, s78, s31
    s_add_u32 s78, s78, 0x4000000
    s_lshl_b32 s79, s76, 7
    s_add_u32 s31, s79, 0x5100000
    buffer_load_dword v192, v12, s[8:11], s31 offen sc1
    s_add_u32 s31, s79, 0x5120000
    buffer_load_dword v193, v12, s[8:11], s31 offen sc1
    s_lshl_b32 s80, s76, 15
    buffer_load_dwordx2 v[194:195], v9, s[20:23], s80 offen
    s_add_u32 s81, s78, 0x0
    buffer_load_dwordx4 v[32:35], v4, s[8:11], s81 offen offset:0 sc1
    buffer_load_dwordx4 v[36:39], v4, s[8:11], s81 offen offset:1024 sc1
    buffer_load_dwordx4 v[40:43], v4, s[8:11], s81 offen offset:2048 sc1
    buffer_load_dwordx4 v[44:47], v4, s[8:11], s81 offen offset:3072 sc1
    s_add_u32 s81, s78, 0x1000
    buffer_load_dwordx4 v[48:51], v4, s[8:11], s81 offen offset:0 sc1
    buffer_load_dwordx4 v[52:55], v4, s[8:11], s81 offen offset:1024 sc1
    buffer_load_dwordx4 v[56:59], v4, s[8:11], s81 offen offset:2048 sc1
    buffer_load_dwordx4 v[60:63], v4, s[8:11], s81 offen offset:3072 sc1
    s_add_u32 s81, s78, 0x2000
    buffer_load_dwordx4 v[64:67], v4, s[8:11], s81 offen offset:0 sc1
    buffer_load_dwordx4 v[68:71], v4, s[8:11], s81 offen offset:1024 sc1
    buffer_load_dwordx4 v[72:75], v4, s[8:11], s81 offen offset:2048 sc1
    buffer_load_dwordx4 v[76:79], v4, s[8:11], s81 offen offset:3072 sc1
    s_add_u32 s81, s78, 0x3000
    buffer_load_dwordx4 v[80:83], v4, s[8:11], s81 offen offset:0 sc1
    buffer_load_dwordx4 v[84:87], v4, s[8:11], s81 offen offset:1024 sc1
    buffer_load_dwordx4 v[88:91], v4, s[8:11], s81 offen offset:2048 sc1
    buffer_load_dwordx4 v[92:95], v4, s[8:11], s81 offen offset:3072 sc1
    s_add_u32 s81, s78, 0x4000
    buffer_load_dwordx4 v[96:99], v4, s[8:11], s81 offen offset:0 sc1
    buffer_load_dwordx4 v[100:103], v4, s[8:11], s81 offen offset:1024 sc1
    buffer_load_dwordx4 v[104:107], v4, s[8:11], s81 offen offset:2048 sc1
    buffer_load_dwordx4 v[108:111], v4, s[8:11], s81 offen offset:3072 sc1
    s_add_u32 s81, s78, 0x5000
    buffer_load_dwordx4 v[112:115], v4, s[8:11], s81 offen offset:0 sc1
    buffer_load_dwordx4 v[116:119], v4, s[8:11], s81 offen offset:1024 sc1
    buffer_load_dwordx4 v[120:123], v4, s[8:11], s81 offen offset:2048 sc1
    buffer_load_dwordx4 v[124:127], v4, s[8:11], s81 offen offset:3072 sc1
    s_add_u32 s81, s78, 0x6000
    buffer_load_dwordx4 v[128:131], v4, s[8:11], s81 offen offset:0 sc1
    buffer_load_dwordx4 v[132:135], v4, s[8:11], s81 offen offset:1024 sc1
    buffer_load_dwordx4 v[136:139], v4, s[8:11], s81 offen offset:2048 sc1
    buffer_load_dwordx4 v[140:143], v4, s[8:11], s81 offen offset:3072 sc1
    s_add_u32 s81, s78, 0x7000
    buffer_load_dwordx4 v[144:147], v4, s[8:11], s81 offen offset:0 sc1
    buffer_load_dwordx4 v[148:151], v4, s[8:11], s81 offen offset:1024 sc1
    buffer_load_dwordx4 v[152:155], v4, s[8:11], s81 offen offset:2048 sc1
    buffer_load_dwordx4 v[156:159], v4, s[8:11], s81 offen offset:3072 sc1
    s_waitcnt vmcnt(31)
    v_mfma_f32_16x16x32_bf16 v[16:19], a[0:3], v[32:35], 0
    v_mfma_f32_16x16x32_bf16 v[20:23], a[4:7], v[32:35], 0
    s_add_u32 s81, s78, 0x20000
    buffer_load_dwordx4 v[32:35], v4, s[8:11], s81 offen offset:0 sc1
    s_waitcnt vmcnt(31)
    v_mfma_f32_16x16x32_bf16 v[16:19], a[8:11], v[36:39], v[16:19]
    v_mfma_f32_16x16x32_bf16 v[20:23], a[12:15], v[36:39], v[20:23]
    buffer_load_dwordx4 v[36:39], v4, s[8:11], s81 offen offset:1024 sc1
    s_waitcnt vmcnt(31)
    v_mfma_f32_16x16x32_bf16 v[16:19], a[16:19], v[40:43], v[16:19]
    v_mfma_f32_16x16x32_bf16 v[20:23], a[20:23], v[40:43], v[20:23]
    buffer_load_dwordx4 v[40:43], v4, s[8:11], s81 offen offset:2048 sc1
    s_waitcnt vmcnt(31)
    v_mfma_f32_16x16x32_bf16 v[16:19], a[24:27], v[44:47], v[16:19]
    v_mfma_f32_16x16x32_bf16 v[20:23], a[28:31], v[44:47], v[20:23]
    buffer_load_dwordx4 v[44:47], v4, s[8:11], s81 offen offset:3072 sc1
    s_waitcnt vmcnt(31)
    v_mfma_f32_16x16x32_bf16 v[16:19], a[32:35], v[48:51], v[16:19]
    v_mfma_f32_16x16x32_bf16 v[20:23], a[36:39], v[48:51], v[20:23]
    s_add_u32 s81, s78, 0x21000
    buffer_load_dwordx4 v[48:51], v4, s[8:11], s81 offen offset:0 sc1
    s_waitcnt vmcnt(31)
    v_mfma_f32_16x16x32_bf16 v[16:19], a[40:43], v[52:55], v[16:19]
    v_mfma_f32_16x16x32_bf16 v[20:23], a[44:47], v[52:55], v[20:23]
    buffer_load_dwordx4 v[52:55], v4, s[8:11], s81 offen offset:1024 sc1
    s_waitcnt vmcnt(31)
    v_mfma_f32_16x16x32_bf16 v[16:19], a[48:51], v[56:59], v[16:19]
    v_mfma_f32_16x16x32_bf16 v[20:23], a[52:55], v[56:59], v[20:23]
    buffer_load_dwordx4 v[56:59], v4, s[8:11], s81 offen offset:2048 sc1
    s_waitcnt vmcnt(31)
    v_mfma_f32_16x16x32_bf16 v[16:19], a[56:59], v[60:63], v[16:19]
    v_mfma_f32_16x16x32_bf16 v[20:23], a[60:63], v[60:63], v[20:23]
    buffer_load_dwordx4 v[60:63], v4, s[8:11], s81 offen offset:3072 sc1
    s_waitcnt vmcnt(31)
    v_mfma_f32_16x16x32_bf16 v[16:19], a[64:67], v[64:67], v[16:19]
    v_mfma_f32_16x16x32_bf16 v[20:23], a[68:71], v[64:67], v[20:23]
    s_add_u32 s81, s78, 0x22000
    buffer_load_dwordx4 v[64:67], v4, s[8:11], s81 offen offset:0 sc1
    s_waitcnt vmcnt(31)
    v_mfma_f32_16x16x32_bf16 v[16:19], a[72:75], v[68:71], v[16:19]
    v_mfma_f32_16x16x32_bf16 v[20:23], a[76:79], v[68:71], v[20:23]
    buffer_load_dwordx4 v[68:71], v4, s[8:11], s81 offen offset:1024 sc1
    s_waitcnt vmcnt(31)
    v_mfma_f32_16x16x32_bf16 v[16:19], a[80:83], v[72:75], v[16:19]
    v_mfma_f32_16x16x32_bf16 v[20:23], a[84:87], v[72:75], v[20:23]
    buffer_load_dwordx4 v[72:75], v4, s[8:11], s81 offen offset:2048 sc1
    s_waitcnt vmcnt(31)
    v_mfma_f32_16x16x32_bf16 v[16:19], a[88:91], v[76:79], v[16:19]
    v_mfma_f32_16x16x32_bf16 v[20:23], a[92:95], v[76:79], v[20:23]
    buffer_load_dwordx4 v[76:79], v4, s[8:11], s81 offen offset:3072 sc1
    s_waitcnt vmcnt(31)
    v_mfma_f32_16x16x32_bf16 v[16:19], a[96:99], v[80:83], v[16:19]
    v_mfma_f32_16x16x32_bf16 v[20:23], a[100:103], v[80:83], v[20:23]
    s_add_u32 s81, s78, 0x23000
    buffer_load_dwordx4 v[80:83], v4, s[8:11], s81 offen offset:0 sc1
    s_waitcnt vmcnt(31)
    v_mfma_f32_16x16x32_bf16 v[16:19], a[104:107], v[84:87], v[16:19]
    v_mfma_f32_16x16x32_bf16 v[20:23], a[108:111], v[84:87], v[20:23]
    buffer_load_dwordx4 v[84:87], v4, s[8:11], s81 offen offset:1024 sc1
    s_waitcnt vmcnt(31)
    v_mfma_f32_16x16x32_bf16 v[16:19], a[112:115], v[88:91], v[16:19]
    v_mfma_f32_16x16x32_bf16 v[20:23], a[116:119], v[88:91], v[20:23]
    buffer_load_dwordx4 v[88:91], v4, s[8:11], s81 offen offset:2048 sc1
    s_waitcnt vmcnt(31)
    v_mfma_f32_16x16x32_bf16 v[16:19], a[120:123], v[92:95], v[16:19]
    v_mfma_f32_16x16x32_bf16 v[20:23], a[124:127], v[92:95], v[20:23]
    buffer_load_dwordx4 v[92:95], v4, s[8:11], s81 offen offset:3072 sc1
    s_waitcnt vmcnt(31)
    v_mfma_f32_16x16x32_bf16 v[16:19], a[128:131], v[96:99], v[16:19]
    v_mfma_f32_16x16x32_bf16 v[20:23], a[132:135], v[96:99], v[20:23]
    s_add_u32 s81, s78, 0x24000
    buffer_load_dwordx4 v[96:99], v4, s[8:11], s81 offen offset:0 sc1
    s_waitcnt vmcnt(31)
    v_mfma_f32_16x16x32_bf16 v[16:19], a[136:139], v[100:103], v[16:19]
    v_mfma_f32_16x16x32_bf16 v[20:23], a[140:143], v[100:103], v[20:23]
    buffer_load_dwordx4 v[100:103], v4, s[8:11], s81 offen offset:1024 sc1
    s_waitcnt vmcnt(31)
    v_mfma_f32_16x16x32_bf16 v[16:19], a[144:147], v[104:107], v[16:19]
    v_mfma_f32_16x16x32_bf16 v[20:23], a[148:151], v[104:107], v[20:23]
    buffer_load_dwordx4 v[104:107], v4, s[8:11], s81 offen offset:2048 sc1
    s_waitcnt vmcnt(31)
    v_mfma_f32_16x16x32_bf16 v[16:19], a[152:155], v[108:111], v[16:19]
    v_mfma_f32_16x16x32_bf16 v[20:23], a[156:159], v[108:111], v[20:23]
    buffer_load_dwordx4 v[108:111], v4, s[8:11], s81 offen offset:3072 sc1
    s_waitcnt vmcnt(31)
    v_mfma_f32_16x16x32_bf16 v[16:19], a[160:163], v[112:115], v[16:19]
    v_mfma_f32_16x16x32_bf16 v[20:23], a[164:167], v[112:115], v[20:23]
    s_add_u32 s81, s78, 0x25000
    buffer_load_dwordx4 v[112:115], v4, s[8:11], s81 offen offset:0 sc1
    s_waitcnt vmcnt(31)
    v_mfma_f32_16x16x32_bf16 v[16:19], a[168:171], v[116:119], v[16:19]
    v_mfma_f32_16x16x32_bf16 v[20:23], a[172:175], v[116:119], v[20:23]
    buffer_load_dwordx4 v[116:119], v4, s[8:11], s81 offen offset:1024 sc1
    s_waitcnt vmcnt(31)
    v_mfma_f32_16x16x32_bf16 v[16:19], a[176:179], v[120:123], v[16:19]
    v_mfma_f32_16x16x32_bf16 v[20:23], a[180:183], v[120:123], v[20:23]
    buffer_load_dwordx4 v[120:123], v4, s[8:11], s81 offen offset:2048 sc1
    s_waitcnt vmcnt(31)
    v_mfma_f32_16x16x32_bf16 v[16:19], a[184:187], v[124:127], v[16:19]
    v_mfma_f32_16x16x32_bf16 v[20:23], a[188:191], v[124:127], v[20:23]
    buffer_load_dwordx4 v[124:127], v4, s[8:11], s81 offen offset:3072 sc1
    s_waitcnt vmcnt(31)
    v_mfma_f32_16x16x32_bf16 v[16:19], a[192:195], v[128:131], v[16:19]
    v_mfma_f32_16x16x32_bf16 v[20:23], a[196:199], v[128:131], v[20:23]
    s_add_u32 s81, s78, 0x26000
    buffer_load_dwordx4 v[128:131], v4, s[8:11], s81 offen offset:0 sc1
    s_waitcnt vmcnt(31)
    v_mfma_f32_16x16x32_bf16 v[16:19], a[200:203], v[132:135], v[16:19]
    v_mfma_f32_16x16x32_bf16 v[20:23], a[204:207], v[132:135], v[20:23]
    buffer_load_dwordx4 v[132:135], v4, s[8:11], s81 offen offset:1024 sc1
    s_waitcnt vmcnt(31)
    v_mfma_f32_16x16x32_bf16 v[16:19], a[208:211], v[136:139], v[16:19]
    v_mfma_f32_16x16x32_bf16 v[20:23], a[212:215], v[136:139], v[20:23]
    buffer_load_dwordx4 v[136:139], v4, s[8:11], s81 offen offset:2048 sc1
    s_waitcnt vmcnt(31)
    v_mfma_f32_16x16x32_bf16 v[16:19], a[216:219], v[140:143], v[16:19]
    v_mfma_f32_16x16x32_bf16 v[20:23], a[220:223], v[140:143], v[20:23]
    buffer_load_dwordx4 v[140:143], v4, s[8:11], s81 offen offset:3072 sc1
    s_waitcnt vmcnt(31)
    v_mfma_f32_16x16x32_bf16 v[16:19], a[224:227], v[144:147], v[16:19]
    v_mfma_f32_16x16x32_bf16 v[20:23], a[228:231], v[144:147], v[20:23]
    s_add_u32 s81, s78, 0x27000
    buffer_load_dwordx4 v[144:147], v4, s[8:11], s81 offen offset:0 sc1
    s_waitcnt vmcnt(31)
    v_mfma_f32_16x16x32_bf16 v[16:19], a[232:235], v[148:151], v[16:19]
    v_mfma_f32_16x16x32_bf16 v[20:23], a[236:239], v[148:151], v[20:23]
    buffer_load_dwordx4 v[148:151], v4, s[8:11], s81 offen offset:1024 sc1
    s_waitcnt vmcnt(31)
    v_mfma_f32_16x16x32_bf16 v[16:19], a[240:243], v[152:155], v[16:19]
    v_mfma_f32_16x16x32_bf16 v[20:23], a[244:247], v[152:155], v[20:23]
    buffer_load_dwordx4 v[152:155], v4, s[8:11], s81 offen offset:2048 sc1
    s_waitcnt vmcnt(31)
    v_mfma_f32_16x16x32_bf16 v[16:19], a[248:251], v[156:159], v[16:19]
    v_mfma_f32_16x16x32_bf16 v[20:23], a[252:255], v[156:159], v[20:23]
    buffer_load_dwordx4 v[156:159], v4, s[8:11], s81 offen offset:3072 sc1
    s_waitcnt vmcnt(31)
    v_mfma_f32_16x16x32_bf16 v[24:27], a[0:3], v[32:35], 0
    v_mfma_f32_16x16x32_bf16 v[28:31], a[4:7], v[32:35], 0
    s_waitcnt vmcnt(30)
    v_mfma_f32_16x16x32_bf16 v[24:27], a[8:11], v[36:39], v[24:27]
    v_mfma_f32_16x16x32_bf16 v[28:31], a[12:15], v[36:39], v[28:31]
    s_waitcnt vmcnt(29)
    v_mfma_f32_16x16x32_bf16 v[24:27], a[16:19], v[40:43], v[24:27]
    v_mfma_f32_16x16x32_bf16 v[28:31], a[20:23], v[40:43], v[28:31]
    s_waitcnt vmcnt(28)
    v_mfma_f32_16x16x32_bf16 v[24:27], a[24:27], v[44:47], v[24:27]
    v_mfma_f32_16x16x32_bf16 v[28:31], a[28:31], v[44:47], v[28:31]
    s_waitcnt vmcnt(27)
    v_mfma_f32_16x16x32_bf16 v[24:27], a[32:35], v[48:51], v[24:27]
    v_mfma_f32_16x16x32_bf16 v[28:31], a[36:39], v[48:51], v[28:31]
    s_waitcnt vmcnt(26)
    v_mfma_f32_16x16x32_bf16 v[24:27], a[40:43], v[52:55], v[24:27]
    v_mfma_f32_16x16x32_bf16 v[28:31], a[44:47], v[52:55], v[28:31]
    s_waitcnt vmcnt(25)
    v_mfma_f32_16x16x32_bf16 v[24:27], a[48:51], v[56:59], v[24:27]
    v_mfma_f32_16x16x32_bf16 v[28:31], a[52:55], v[56:59], v[28:31]
    s_waitcnt vmcnt(24)
    v_mfma_f32_16x16x32_bf16 v[24:27], a[56:59], v[60:63], v[24:27]
    v_mfma_f32_16x16x32_bf16 v[28:31], a[60:63], v[60:63], v[28:31]
    s_waitcnt vmcnt(23)
    v_mfma_f32_16x16x32_bf16 v[24:27], a[64:67], v[64:67], v[24:27]
    v_mfma_f32_16x16x32_bf16 v[28:31], a[68:71], v[64:67], v[28:31]
    s_waitcnt vmcnt(22)
    v_mfma_f32_16x16x32_bf16 v[24:27], a[72:75], v[68:71], v[24:27]
    v_mfma_f32_16x16x32_bf16 v[28:31], a[76:79], v[68:71], v[28:31]
    s_waitcnt vmcnt(21)
    v_mfma_f32_16x16x32_bf16 v[24:27], a[80:83], v[72:75], v[24:27]
    v_mfma_f32_16x16x32_bf16 v[28:31], a[84:87], v[72:75], v[28:31]
    s_waitcnt vmcnt(20)
    v_mfma_f32_16x16x32_bf16 v[24:27], a[88:91], v[76:79], v[24:27]
    v_mfma_f32_16x16x32_bf16 v[28:31], a[92:95], v[76:79], v[28:31]
    s_waitcnt vmcnt(19)
    v_mfma_f32_16x16x32_bf16 v[24:27], a[96:99], v[80:83], v[24:27]
    v_mfma_f32_16x16x32_bf16 v[28:31], a[100:103], v[80:83], v[28:31]
    s_waitcnt vmcnt(18)
    v_mfma_f32_16x16x32_bf16 v[24:27], a[104:107], v[84:87], v[24:27]
    v_mfma_f32_16x16x32_bf16 v[28:31], a[108:111], v[84:87], v[28:31]
    s_waitcnt vmcnt(17)
    v_mfma_f32_16x16x32_bf16 v[24:27], a[112:115], v[88:91], v[24:27]
    v_mfma_f32_16x16x32_bf16 v[28:31], a[116:119], v[88:91], v[28:31]
    s_waitcnt vmcnt(16)
    v_mfma_f32_16x16x32_bf16 v[24:27], a[120:123], v[92:95], v[24:27]
    v_mfma_f32_16x16x32_bf16 v[28:31], a[124:127], v[92:95], v[28:31]
    s_waitcnt vmcnt(15)
    v_mfma_f32_16x16x32_bf16 v[24:27], a[128:131], v[96:99], v[24:27]
    v_mfma_f32_16x16x32_bf16 v[28:31], a[132:135], v[96:99], v[28:31]
    s_waitcnt vmcnt(14)
    v_mfma_f32_16x16x32_bf16 v[24:27], a[136:139], v[100:103], v[24:27]
    v_mfma_f32_16x16x32_bf16 v[28:31], a[140:143], v[100:103], v[28:31]
    s_waitcnt vmcnt(13)
    v_mfma_f32_16x16x32_bf16 v[24:27], a[144:147], v[104:107], v[24:27]
    v_mfma_f32_16x16x32_bf16 v[28:31], a[148:151], v[104:107], v[28:31]
    s_waitcnt vmcnt(12)
    v_mfma_f32_16x16x32_bf16 v[24:27], a[152:155], v[108:111], v[24:27]
    v_mfma_f32_16x16x32_bf16 v[28:31], a[156:159], v[108:111], v[28:31]
    s_waitcnt vmcnt(11)
    v_mfma_f32_16x16x32_bf16 v[24:27], a[160:163], v[112:115], v[24:27]
    v_mfma_f32_16x16x32_bf16 v[28:31], a[164:167], v[112:115], v[28:31]
    s_waitcnt vmcnt(10)
    v_mfma_f32_16x16x32_bf16 v[24:27], a[168:171], v[116:119], v[24:27]
    v_mfma_f32_16x16x32_bf16 v[28:31], a[172:175], v[116:119], v[28:31]
    s_waitcnt vmcnt(9)
    v_mfma_f32_16x16x32_bf16 v[24:27], a[176:179], v[120:123], v[24:27]
    v_mfma_f32_16x16x32_bf16 v[28:31], a[180:183], v[120:123], v[28:31]
    s_waitcnt vmcnt(8)
    v_mfma_f32_16x16x32_bf16 v[24:27], a[184:187], v[124:127], v[24:27]
    v_mfma_f32_16x16x32_bf16 v[28:31], a[188:191], v[124:127], v[28:31]
    s_waitcnt vmcnt(7)
    v_mfma_f32_16x16x32_bf16 v[24:27], a[192:195], v[128:131], v[24:27]
    v_mfma_f32_16x16x32_bf16 v[28:31], a[196:199], v[128:131], v[28:31]
    s_waitcnt vmcnt(6)
    v_mfma_f32_16x16x32_bf16 v[24:27], a[200:203], v[132:135], v[24:27]
    v_mfma_f32_16x16x32_bf16 v[28:31], a[204:207], v[132:135], v[28:31]
    s_waitcnt vmcnt(5)
    v_mfma_f32_16x16x32_bf16 v[24:27], a[208:211], v[136:139], v[24:27]
    v_mfma_f32_16x16x32_bf16 v[28:31], a[212:215], v[136:139], v[28:31]
    s_waitcnt vmcnt(4)
    v_mfma_f32_16x16x32_bf16 v[24:27], a[216:219], v[140:143], v[24:27]
    v_mfma_f32_16x16x32_bf16 v[28:31], a[220:223], v[140:143], v[28:31]
    s_waitcnt vmcnt(3)
    v_mfma_f32_16x16x32_bf16 v[24:27], a[224:227], v[144:147], v[24:27]
    v_mfma_f32_16x16x32_bf16 v[28:31], a[228:231], v[144:147], v[28:31]
    s_waitcnt vmcnt(2)
    v_mfma_f32_16x16x32_bf16 v[24:27], a[232:235], v[148:151], v[24:27]
    v_mfma_f32_16x16x32_bf16 v[28:31], a[236:239], v[148:151], v[28:31]
    s_waitcnt vmcnt(1)
    v_mfma_f32_16x16x32_bf16 v[24:27], a[240:243], v[152:155], v[24:27]
    v_mfma_f32_16x16x32_bf16 v[28:31], a[244:247], v[152:155], v[28:31]
    s_waitcnt vmcnt(0)
    v_mfma_f32_16x16x32_bf16 v[24:27], a[248:251], v[156:159], v[24:27]
    v_mfma_f32_16x16x32_bf16 v[28:31], a[252:255], v[156:159], v[28:31]
    v_cmp_ne_u32 vcc, 0, v193
    v_lshl_add_u32 v196, v193, 11, v13
    v_mov_b32 v200, 0
    v_mov_b32 v201, 0
    v_mov_b32 v202, 0
    v_mov_b32 v203, 0
    s_and_saveexec_b64 s[46:47], vcc
    s_cbranch_execz L_o_noy
    s_mov_b32 s31, 0x514f800
    buffer_load_dwordx4 v[200:203], v196, s[8:11], s31 offen sc1
L_o_noy:
    s_mov_b64 exec, -1
    ds_write_b128 v8, v[16:19] offset:0
    ds_write_b128 v8, v[20:23] offset:1024
    ds_write_b128 v8, v[24:27] offset:2048
    ds_write_b128 v8, v[28:31] offset:3072
    s_waitcnt lgkmcnt(0)
    s_barrier
    ds_read_b128 v[32:35], v7 offset:0
    ds_read_b128 v[36:39], v7 offset:4096
    ds_read_b128 v[40:43], v7 offset:8192
    ds_read_b128 v[44:47], v7 offset:12288
    v_xor_b32 v7, 0x4000, v7
    v_xor_b32 v8, 0x4000, v8
    s_waitcnt vmcnt(0)
    v_lshlrev_b32 v204, 16, v194
    v_and_b32 v205, 0xffff0000, v194
    v_lshlrev_b32 v206, 16, v195
    v_and_b32 v207, 0xffff0000, v195
    v_pk_add_f32 v[204:205], v[204:205], v[200:201]
    v_pk_add_f32 v[206:207], v[206:207], v[202:203]
    v_cvt_pk_bf16_f32 v197, v204, v205
    v_lshlrev_b32 v204, 16, v197
    v_and_b32 v205, 0xffff0000, v197
    v_cvt_pk_bf16_f32 v197, v206, v207
    v_lshlrev_b32 v206, 16, v197
    v_and_b32 v207, 0xffff0000, v197
    v_sub_f32 v198, 1.0, v192
    v_cvt_pk_bf16_f32 v198, v198, v198
    v_lshlrev_b32 v198, 16, v198
    v_pk_mul_f32 v[204:205], v[204:205], v[198:199] op_sel_hi:[1,0]
    v_pk_mul_f32 v[206:207], v[206:207], v[198:199] op_sel_hi:[1,0]
    v_cvt_pk_bf16_f32 v197, v204, v205
    v_lshlrev_b32 v204, 16, v197
    v_and_b32 v205, 0xffff0000, v197
    v_cvt_pk_bf16_f32 v197, v206, v207
    v_lshlrev_b32 v206, 16, v197
    v_and_b32 v207, 0xffff0000, v197
    s_waitcnt lgkmcnt(0)
    v_pk_add_f32 v[32:33], v[32:33], v[36:37]
    v_pk_add_f32 v[40:41], v[40:41], v[44:45]
    v_pk_add_f32 v[34:35], v[34:35], v[38:39]
    v_pk_add_f32 v[42:43], v[42:43], v[46:47]
    v_pk_add_f32 v[32:33], v[32:33], v[40:41]
    v_pk_add_f32 v[34:35], v[34:35], v[42:43]
    v_cvt_pk_bf16_f32 v197, v32, v33
    v_lshlrev_b32 v32, 16, v197
    v_and_b32 v33, 0xffff0000, v197
    v_cvt_pk_bf16_f32 v197, v34, v35
    v_lshlrev_b32 v34, 16, v197
    v_and_b32 v35, 0xffff0000, v197
    v_pk_mul_f32 v[32:33], v[32:33], v[192:193] op_sel_hi:[1,0]
    v_pk_mul_f32 v[34:35], v[34:35], v[192:193] op_sel_hi:[1,0]
    v_cvt_pk_bf16_f32 v197, v32, v33
    v_lshlrev_b32 v32, 16, v197
    v_and_b32 v33, 0xffff0000, v197
    v_cvt_pk_bf16_f32 v197, v34, v35
    v_lshlrev_b32 v34, 16, v197
    v_and_b32 v35, 0xffff0000, v197
    v_pk_add_f32 v[32:33], v[32:33], v[204:205]
    v_pk_add_f32 v[34:35], v[34:35], v[206:207]
    v_cvt_pk_bf16_f32 v208, v32, v33
    v_cvt_pk_bf16_f32 v209, v34, v35
    buffer_store_dwordx2 v[208:209], v9, s[72:75], s80 offen
    s_add_u32 s76, s76, 10
    s_cmp_lt_u32 s76, 64
    s_nop 11
    s_cbranch_scc1 L_o_loop
L_end:
    s_waitcnt vmcnt(0)
    s_waitcnt vmcnt(0)
    s_endpgm
L_babort:
    v_mov_b32 v16, s31
    v_mov_b32 v17, 36
    s_mov_b64 exec, 1
    buffer_store_dword v16, v17, s[12:15], 0 offen sc1
    s_waitcnt vmcnt(0)
    s_endpgm
.section .rodata,"a"
.p2align 6
.amdhsa_kernel gated_mix__memory_aug_recurrent_mem_tr__moe_arch_mod__prompt_kernel
  .amdhsa_next_free_vgpr 512
  .amdhsa_next_free_sgpr 102
  .amdhsa_accum_offset 256
  .amdhsa_group_segment_fixed_size 0
  .amdhsa_kernarg_size 128
  .amdhsa_user_sgpr_count 2
  .amdhsa_user_sgpr_kernarg_segment_ptr 1
  .amdhsa_system_sgpr_workgroup_id_x 1
  .amdhsa_float_denorm_mode_32 3
.end_amdhsa_kernel
.text
```
